```python
import torch

def _softmax(x, axis=-1):
    return torch.softmax(x, dim=axis)

def _gelu(x):
    return torch.nn.functional.gelu(x, approximate='tanh')

def _silu(x):
    return torch.nn.functional.silu(x)

def _sigmoid(x):
    return torch.sigmoid(x)

def _layernorm(x, axis=-1, eps=1e-05):
    m = x.mean(dim=axis, keepdim=True)
    v = x.var(dim=axis, keepdim=True, unbiased=False)
    return (x - m) / torch.sqrt(v + eps)

def _scatter_add(tgt, idx, src, axis=0):
    return tgt.clone().index_add_(axis, idx, src)

def _segment_sum(src, seg, n):
    out = torch.zeros((n,) + src.shape[1:], dtype=src.dtype)
    return out.index_add_(0, seg, src)

def _pad(x, pw):
    flat = tuple((v for pair in reversed(pw) for v in pair))
    return torch.nn.functional.pad(x, flat)
kernel_name = 'parallel_sum__memory_aug_recurrent_mem_tr__dense_activation_relu__prompt'

def setup_inputs():

    _w = lambda a: (lambda t: t.to(torch.bfloat16) if t.is_floating_point() else t)(torch.as_tensor(a))

    def _A_setup():
        B, S, Dm = (1, 2048, 512)
        H, Dh = (32, 128)
        M, seg = (8, 32)
        seg = min(seg, S)
        S = S // seg * seg
        return {'x': _w((lambda *s: torch.randn(*s, dtype=torch.bfloat16) * 0.05)(B, S, Dm)), 'mem0': _w((lambda *s: torch.randn(*s, dtype=torch.bfloat16) * 1.6)(B, M, Dm)), 'Wq': _w((lambda *s: torch.randn(*s, dtype=torch.bfloat16) * 0.8)(Dm, H, Dh) * Dm ** (-0.5)), 'Wk': _w((lambda *s: torch.randn(*s, dtype=torch.bfloat16) * 0.8)(Dm, H, Dh) * Dm ** (-0.5)), 'Wv': _w((lambda *s: torch.randn(*s, dtype=torch.bfloat16) * 1.6)(Dm, H, Dh) * Dm ** (-0.5)), 'Wo': _w((lambda *s: torch.randn(*s, dtype=torch.bfloat16) * 1.6)(H, Dh, Dm) * (H * Dh) ** (-0.5)), 'seg_len': seg}
    _A_in = _A_setup()

    def _B_setup():
        B, S, D, Dff = (1, 2048, 512, 1792)
        return {'x': _w((lambda *s: torch.randn(*s, dtype=torch.bfloat16) * 0.05)(B, S, D)), 'w1': _w((lambda *s: torch.randn(*s, dtype=torch.bfloat16) * 0.05)(D, Dff)), 'w2': _w((lambda *s: torch.randn(*s, dtype=torch.bfloat16) * 0.05)(Dff, D))}
    _B_in = _B_setup()
    return {'A_x': _A_in['x'], 'A_mem0': _A_in['mem0'], 'A_Wq': _A_in['Wq'], 'A_Wk': _A_in['Wk'], 'A_Wv': _A_in['Wv'], 'A_Wo': _A_in['Wo'], 'A_seg_len': _A_in['seg_len'], 'B_x': _B_in['x'], 'B_w1': _B_in['w1'], 'B_w2': _B_in['w2']}

def reference(A_x, A_mem0, A_Wq, A_Wk, A_Wv, A_Wo, A_seg_len, B_x, B_w1, B_w2):

    def _A_ref(x, mem0, Wq, Wk, Wv, Wo, seg_len):
        B, S, Dm = x.shape
        H, Dh = (Wq.shape[1], Wq.shape[2])
        M = mem0.shape[1]
        scale = Dh ** (-0.5)
        n_seg = S // seg_len
        L = M + seg_len
        idx = torch.arange(L)
        mask = (idx[:, None] < M) | (idx[:, None] >= idx[None, :])
        mem = mem0
        outs = []
        for s in range(n_seg):
            xs = x[:, s * seg_len:(s + 1) * seg_len, :].clone()
            h = torch.concatenate([mem, xs], axis=1)
            q = torch.einsum('btd,dhe->bhte', h, Wq)
            k = torch.einsum('btd,dhe->bhte', h, Wk)
            v = torch.einsum('btd,dhe->bhte', h, Wv)
            scores = torch.einsum('bhqe,bhke->bhqk', q, k) * scale
            scores = torch.where(mask[None, None], scores, -1000000000.0)
            p = _softmax(scores, axis=-1)
            o = torch.einsum('bhqk,bhke->bhqe', p, v)
            o = torch.einsum('bhte,hed->btd', o, Wo)
            mem = o[:, :M, :].clone()
            outs.append(o[:, M:, :])
        return torch.concatenate(outs, axis=1)

    def _B_ref(x, w1, w2):
        h = torch.einsum('bsd,df->bsf', x, w1)
        zero = torch.zeros_like(h)
        h = torch.maximum(h, zero)
        return torch.einsum('bsf,fd->bsd', h, w2)
    x = A_x
    xn = _layernorm(x, axis=-1)
    return x + _A_ref(xn, A_mem0, A_Wq, A_Wk, A_Wv, A_Wo, A_seg_len) + _B_ref(xn, B_w1, B_w2)
```

```asm
; @launch grid=(256,1,1) block=(256,1,1) lds=163840
.amdgcn_target "amdgcn-amd-amdhsa--gfx950"
.text
.p2alignl 12, 0xbf810000
.fill 832, 4, 0xbf810000
.globl parallel_sum__memory_aug_recurrent_mem_tr__dense_activation_relu__prompt_kernel
.p2align 8
.type parallel_sum__memory_aug_recurrent_mem_tr__dense_activation_relu__prompt_kernel,@function
parallel_sum__memory_aug_recurrent_mem_tr__dense_activation_relu__prompt_kernel:
s_cmp_ge_u32 s2, 256
s_cbranch_scc1 L_end
s_getreg_b32 s40, hwreg(HW_REG_XCC_ID, 0, 4)
v_lshrrev_b32 v1, 6, v0
v_and_b32 v0, 63, v0
s_xor_b32 s40, s40, 1
v_readfirstlane_b32 s38, v1
s_cmp_eq_u32 s38, 0
s_cbranch_scc1 L_v0
s_getreg_b32 s61, hwreg(HW_REG_HW_ID, 8, 8)
s_and_b32 s59, s61, 206
s_cmp_lg_u32 s59, 2
s_cbranch_scc1 L_v0
s_getpc_b64 s[56:57]
L_pc1:
s_sub_u32 s58, s38, 1
s_and_b32 s59, s61, 1
s_mul_i32 s59, s59, 3
s_add_u32 s58, s58, s59
s_lshl_b32 s58, s58, 13
s_mov_b32 s60, L_worker-L_pc1
s_cmp_eq_u32 s40, 0
s_cselect_b32 s59, 64, s60
s_cselect_b32 s60, s60, L_end-L_pc1
s_add_u32 s58, s58, s59
v_lshl_add_u32 v2, v0, 7, s58
v_min_u32 v2, s60, v2
v_mov_b32 v3, s57
v_add_co_u32 v2, vcc, s56, v2
s_nop 1
v_addc_co_u32 v3, vcc, 0, v3, vcc
global_load_dword v192, v[2:3], off
L_v0:
s_load_dwordx2 s[8:9], s[0:1], 0
s_load_dwordx2 s[32:33], s[0:1], 8
s_load_dwordx8 s[44:51], s[0:1], 16
s_load_dwordx4 s[52:55], s[0:1], 64
s_load_dwordx2 s[12:13], s[0:1], 80
s_load_dwordx2 s[36:37], s[0:1], 88
s_load_dwordx2 s[4:5], s[0:1], 96
s_mov_b32 s6, 0x10000000
s_mov_b32 s7, 0x20000
s_mov_b32 s10, 0x200000
s_mov_b32 s11, 0x20000
s_mov_b32 s14, 0x200000
s_mov_b32 s15, 0x20000
s_mov_b32 s34, 0x2000
s_mov_b32 s35, 0x20000
s_waitcnt lgkmcnt(0)
s_cmp_eq_u32 s38, 0
s_cbranch_scc1 L_early1
s_mov_b32 s16, s44
s_mov_b32 s17, s45
s_mov_b32 s18, 0x400000
s_mov_b32 s19, 0x20000
s_mul_i32 s56, s2, 3
s_add_u32 s56, s56, s38
s_sub_u32 s56, s56, 1
s_lshl_b32 s56, s56, 10
v_lshlrev_b32 v6, 4, v0
v_add_u32 v6, s56, v6
s_mov_b32 s56, 0x8000
v_add_u32 v7, 0x0, v6
v_and_b32 v8, 0x7fff, v7
v_lshrrev_b32 v7, 15, v7
v_lshl_add_u32 v7, v7, 16, v8
buffer_load_dwordx4 v[72:75], v7, s[16:19], 0 offen
v_add_u32 v7, 0xc0000, v6
v_and_b32 v8, 0x7fff, v7
v_lshrrev_b32 v7, 15, v7
v_lshl_add_u32 v7, v7, 16, v8
buffer_load_dwordx4 v[72:75], v7, s[16:19], 0 offen
v_add_u32 v7, 0x180000, v6
v_and_b32 v8, 0x7fff, v7
v_lshrrev_b32 v7, 15, v7
v_lshl_add_u32 v7, v7, 16, v8
buffer_load_dwordx4 v[72:75], v7, s[16:19], 0 offen
L_early1:
s_cmp_lg_u32 s38, 0
s_cbranch_scc1 L_elected
s_min_u32 s41, s40, 8
s_lshl_b32 s42, s41, 2
s_cmp_eq_u32 s41, 0
s_cselect_b32 s42, 128, s42
v_mov_b32 v2, s42
v_mov_b32 v3, 1
s_mov_b64 exec, 1
global_atomic_add v4, v2, v3, s[36:37] sc0 sc1
s_waitcnt vmcnt(0)
v_readfirstlane_b32 s43, v4
s_lshl_b32 s39, s41, 5
s_add_u32 s39, s39, s43
s_cmp_lt_u32 s43, 32
s_cselect_b32 s56, s41, 8
s_cmp_lt_u32 s56, 8
s_cbranch_scc0 L_surplus
L_role_ok:
v_mov_b32 v4, s39
v_mov_b32 v2, 0
ds_write_b32 v2, v4
s_waitcnt lgkmcnt(0)
s_mov_b64 exec, -1
L_elected:
s_barrier
v_mov_b32 v2, 0
ds_read_b32 v4, v2
s_waitcnt lgkmcnt(0)
v_readfirstlane_b32 s39, v4
s_barrier
s_cmp_ge_u32 s39, 256
s_cbranch_scc1 L_end
s_cmp_ge_u32 s39, 32
s_cbranch_scc1 L_worker
s_mov_b32 s16, s44
s_mov_b32 s17, s45
s_mov_b32 s18, 0x400000
s_mov_b32 s19, 0x20000
s_mov_b32 s20, s46
s_mov_b32 s21, s47
s_mov_b32 s22, 0x400000
s_mov_b32 s23, 0x20000
s_mov_b32 s24, s48
s_mov_b32 s25, s49
s_mov_b32 s26, 0x400000
s_mov_b32 s27, 0x20000
s_mov_b32 s28, s50
s_mov_b32 s29, s51
s_mov_b32 s30, 0x400000
s_mov_b32 s31, 0x20000
v_and_b32 v1, 15, v0
v_lshrrev_b32 v2, 4, v0
v_lshrrev_b32 v5, 1, v2
v_lshlrev_b32 v5, 19, v5
v_and_b32 v20, 1, v2
v_lshl_add_u32 v20, v20, 17, v5
v_lshlrev_b32 v21, 2, v1
s_lshl_b32 s56, s39, 8
s_lshl_b32 s58, s38, 6
s_add_u32 s56, s56, s58
v_add3_u32 v20, v20, v21, s56
s_lshr_b32 s59, s44, 8
s_add_u32 s59, s59, s39
s_and_b32 s59, s59, 3
s_mov_b32 s56, 0x0
buffer_load_dword v24, v20, s[16:19], s56 offen
s_mov_b32 s56, 0x2000
buffer_load_dword v25, v20, s[16:19], s56 offen
s_mov_b32 s56, 0x100000
buffer_load_dword v26, v20, s[16:19], s56 offen
s_mov_b32 s56, 0x102000
buffer_load_dword v27, v20, s[16:19], s56 offen
s_mov_b32 s56, 0x10000
buffer_load_dword v28, v20, s[16:19], s56 offen
s_mov_b32 s56, 0x12000
buffer_load_dword v29, v20, s[16:19], s56 offen
s_mov_b32 s56, 0x110000
buffer_load_dword v30, v20, s[16:19], s56 offen
s_mov_b32 s56, 0x112000
buffer_load_dword v31, v20, s[16:19], s56 offen
s_mov_b32 s56, 0x4000
buffer_load_dword v32, v20, s[16:19], s56 offen
s_mov_b32 s56, 0x6000
buffer_load_dword v33, v20, s[16:19], s56 offen
s_mov_b32 s56, 0x104000
buffer_load_dword v34, v20, s[16:19], s56 offen
s_mov_b32 s56, 0x106000
buffer_load_dword v35, v20, s[16:19], s56 offen
s_mov_b32 s56, 0x14000
buffer_load_dword v36, v20, s[16:19], s56 offen
s_mov_b32 s56, 0x16000
buffer_load_dword v37, v20, s[16:19], s56 offen
s_mov_b32 s56, 0x114000
buffer_load_dword v38, v20, s[16:19], s56 offen
s_mov_b32 s56, 0x116000
buffer_load_dword v39, v20, s[16:19], s56 offen
s_mov_b32 s56, 0x200000
buffer_load_dword v40, v20, s[16:19], s56 offen
s_mov_b32 s56, 0x202000
buffer_load_dword v41, v20, s[16:19], s56 offen
s_mov_b32 s56, 0x300000
buffer_load_dword v42, v20, s[16:19], s56 offen
s_mov_b32 s56, 0x302000
buffer_load_dword v43, v20, s[16:19], s56 offen
s_mov_b32 s56, 0x210000
buffer_load_dword v44, v20, s[16:19], s56 offen
s_mov_b32 s56, 0x212000
buffer_load_dword v45, v20, s[16:19], s56 offen
s_mov_b32 s56, 0x310000
buffer_load_dword v46, v20, s[16:19], s56 offen
s_mov_b32 s56, 0x312000
buffer_load_dword v47, v20, s[16:19], s56 offen
s_mov_b32 s56, 0x204000
buffer_load_dword v48, v20, s[16:19], s56 offen
s_mov_b32 s56, 0x206000
buffer_load_dword v49, v20, s[16:19], s56 offen
s_mov_b32 s56, 0x304000
buffer_load_dword v50, v20, s[16:19], s56 offen
s_mov_b32 s56, 0x306000
buffer_load_dword v51, v20, s[16:19], s56 offen
s_mov_b32 s56, 0x214000
buffer_load_dword v52, v20, s[16:19], s56 offen
s_mov_b32 s56, 0x216000
buffer_load_dword v53, v20, s[16:19], s56 offen
s_mov_b32 s56, 0x314000
buffer_load_dword v54, v20, s[16:19], s56 offen
s_mov_b32 s56, 0x316000
buffer_load_dword v55, v20, s[16:19], s56 offen
s_mov_b32 s56, 0x40000
buffer_load_dword v240, v20, s[16:19], s56 offen
s_mov_b32 s56, 0x42000
buffer_load_dword v241, v20, s[16:19], s56 offen
s_mov_b32 s56, 0x140000
buffer_load_dword v242, v20, s[16:19], s56 offen
s_mov_b32 s56, 0x142000
buffer_load_dword v243, v20, s[16:19], s56 offen
s_mov_b32 s56, 0x50000
buffer_load_dword v244, v20, s[16:19], s56 offen
s_mov_b32 s56, 0x52000
buffer_load_dword v245, v20, s[16:19], s56 offen
s_mov_b32 s56, 0x150000
buffer_load_dword v246, v20, s[16:19], s56 offen
s_mov_b32 s56, 0x152000
buffer_load_dword v247, v20, s[16:19], s56 offen
s_mov_b32 s56, 0x44000
buffer_load_dword v248, v20, s[16:19], s56 offen
s_mov_b32 s56, 0x46000
buffer_load_dword v249, v20, s[16:19], s56 offen
s_mov_b32 s56, 0x144000
buffer_load_dword v250, v20, s[16:19], s56 offen
s_mov_b32 s56, 0x146000
buffer_load_dword v251, v20, s[16:19], s56 offen
s_mov_b32 s56, 0x54000
buffer_load_dword v252, v20, s[16:19], s56 offen
s_mov_b32 s56, 0x56000
buffer_load_dword v253, v20, s[16:19], s56 offen
s_mov_b32 s56, 0x154000
buffer_load_dword v254, v20, s[16:19], s56 offen
s_mov_b32 s56, 0x156000
buffer_load_dword v255, v20, s[16:19], s56 offen
s_mov_b32 s56, 0x240000
buffer_load_dword v56, v20, s[16:19], s56 offen
s_mov_b32 s56, 0x242000
buffer_load_dword v57, v20, s[16:19], s56 offen
s_mov_b32 s56, 0x340000
buffer_load_dword v58, v20, s[16:19], s56 offen
s_mov_b32 s56, 0x342000
buffer_load_dword v59, v20, s[16:19], s56 offen
s_mov_b32 s56, 0x250000
buffer_load_dword v60, v20, s[16:19], s56 offen
s_mov_b32 s56, 0x252000
buffer_load_dword v61, v20, s[16:19], s56 offen
s_mov_b32 s56, 0x350000
buffer_load_dword v62, v20, s[16:19], s56 offen
s_mov_b32 s56, 0x352000
buffer_load_dword v63, v20, s[16:19], s56 offen
s_mov_b32 s56, 0x244000
buffer_load_dword v64, v20, s[16:19], s56 offen
s_mov_b32 s56, 0x246000
buffer_load_dword v65, v20, s[16:19], s56 offen
s_mov_b32 s56, 0x344000
buffer_load_dword v66, v20, s[16:19], s56 offen
s_mov_b32 s56, 0x346000
buffer_load_dword v67, v20, s[16:19], s56 offen
s_mov_b32 s56, 0x254000
buffer_load_dword v68, v20, s[16:19], s56 offen
s_mov_b32 s56, 0x256000
buffer_load_dword v69, v20, s[16:19], s56 offen
s_mov_b32 s56, 0x354000
buffer_load_dword v70, v20, s[16:19], s56 offen
s_mov_b32 s56, 0x356000
buffer_load_dword v71, v20, s[16:19], s56 offen
v_lshrrev_b32 v5, 1, v2
v_and_b32 v6, 1, v2
v_lshlrev_b32 v7, 13, v5
v_lshlrev_b32 v6, 10, v6
v_lshlrev_b32 v21, 4, v1
v_add3_u32 v21, v21, v7, v6
s_lshl_b32 s56, s39, 17
s_lshl_b32 s58, s38, 8
s_add_u32 s56, s56, s58
v_add_u32 v21, s56, v21
v_lshrrev_b32 v4, 3, v1
v_lshlrev_b32 v98, 4, v0
s_lshl_b32 s56, s38, 11
v_add_u32 v102, s56, v98
s_mul_i32 s56, s38, 38912
s_add_u32 s56, s56, 8192
v_add_u32 v99, s56, v98
v_cmp_lt_u32 vcc, 7, v1
v_mov_b32 v5, 0x40000
s_nop 0
v_cndmask_b32 v103, v102, v5, vcc
v_mov_b32 v5, 0x44444444
v_mov_b32 v7, 0xeeeeeeee
v_cndmask_b32 v106, v5, v7, vcc
v_lshrrev_b32 v3, 1, v2
v_lshlrev_b32 v3, 1, v3
v_add_u32 v3, v3, v4
v_lshlrev_b32 v3, 1, v3
v_and_b32 v5, 1, v2
s_lshl_b32 s56, s38, 3
v_add3_u32 v3, v3, v5, s56
v_lshlrev_b32 v3, 13, v3
v_bfe_u32 v6, v1, 2, 1
v_lshlrev_b32 v6, 11, v6
v_and_b32 v7, 3, v1
v_lshlrev_b32 v7, 4, v7
s_lshl_b32 s56, s39, 6
v_add3_u32 v3, v3, v6, s56
v_add_u32 v96, v3, v7
s_lshl_b32 s56, s38, 11
s_lshr_b32 s58, s39, 4
s_lshl_b32 s58, s58, 10
s_add_u32 s56, s56, s58
s_bfe_u32 s58, s39, 0x20001
s_lshl_b32 s58, s58, 8
s_add_u32 s56, s56, s58
s_bfe_u32 s58, s39, 0x10003
s_lshl_b32 s58, s58, 7
s_add_u32 s56, s56, s58
s_and_b32 s58, s39, 1
s_lshl_b32 s58, s58, 6
s_add_u32 s56, s56, s58
v_and_b32 v5, 12, v1
v_add3_u32 v3, v7, v5, s56
v_cmp_lt_u32 vcc, 15, v0
v_mov_b32 v5, 0x7fffff00
s_nop 0
v_cndmask_b32 v97, v3, v5, vcc
v_and_b32 v6, 7, v1
v_lshlrev_b32 v6, 4, v6
v_and_b32 v5, 1, v2
v_lshlrev_b32 v5, 7, v5
v_add_u32 v109, v103, v5
v_sub_u32 v107, v103, v5
v_lshlrev_b32 v3, 8, v2
v_add3_u32 v3, v3, v5, v6
v_add_u32 v101, 1024, v3
v_lshlrev_b32 v7, 3, v4
s_lshl_b32 s56, s38, 11
v_sub_u32 v8, v3, v7
v_add_u32 v8, 8, v8
v_add_u32 v109, s56, v8
v_add3_u32 v8, v5, v6, v7
v_add_u32 v8, s56, v8
v_add_u32 v8, 512, v8
v_mov_b32 v9, 0x40000
v_cmp_lt_u32 vcc, 1, v2
s_nop 1
v_cndmask_b32 v107, v9, v8, vcc
v_sub_u32 v5, v5, v7
v_add_u32 v5, 1672, v5
v_add_u32 v100, v5, v6
v_lshlrev_b32 v104, 2, v0
s_lshr_b32 s56, s39, 1
s_add_u32 s56, s56, 16
s_lshl_b32 s56, s56, 2
v_and_b32 v5, 1, v0
v_lshlrev_b32 v5, 6, v5
v_bfe_u32 v7, v0, 1, 2
v_min_u32 v7, 2, v7
v_lshlrev_b32 v7, 8, v7
v_add3_u32 v105, s56, v5, v7
v_lshlrev_b32 v5, 2, v0
v_add_u32 v5, 736, v5
v_subrev_u32 v7, 8, v0
v_cmp_gt_u32 vcc, 12, v7
s_nop 1
v_cndmask_b32 v105, v105, v5, vcc
v_and_b32 v5, 3, v0
v_cmp_eq_u32 vcc, 0, v5
s_nop 1
v_cndmask_b32 v111, 0, 1, vcc
v_and_b32 v5, 1, v0
v_cmp_eq_u32 vcc, 0, v5
v_mov_b32 v5, 0xdddddddd
v_mov_b32 v7, 0x88888888
v_cndmask_b32 v110, v5, v7, vcc
s_mov_b32 s86, 0x3f803f80
s_mov_b32 s87, 0x3f803f80
v_mov_b32 v88, 0x3e803e80
v_mov_b32 v89, 0x3e803e80
v_mov_b32 v90, 0x3f803f80
v_mov_b32 v91, 0x3f803f80
v_and_b32 v5, 1, v2
v_lshlrev_b32 v5, 2, v5
v_sub_u32 v5, v1, v5
v_mov_b32 v7, 0x3f80
v_mov_b32 v8, 0x3f800000
v_cmp_eq_u32 vcc, 0, v5
s_nop 1
v_cndmask_b32 v9, 0, v7, vcc
v_cmp_eq_u32 vcc, 1, v5
s_nop 1
v_cndmask_b32 v84, v9, v8, vcc
v_cmp_eq_u32 vcc, 2, v5
s_nop 1
v_cndmask_b32 v9, 0, v7, vcc
v_cmp_eq_u32 vcc, 3, v5
s_nop 1
v_cndmask_b32 v85, v9, v8, vcc
v_cmp_eq_u32 vcc, 8, v5
s_nop 1
v_cndmask_b32 v9, 0, v7, vcc
v_cmp_eq_u32 vcc, 9, v5
s_nop 1
v_cndmask_b32 v86, v9, v8, vcc
v_cmp_eq_u32 vcc, 10, v5
s_nop 1
v_cndmask_b32 v9, 0, v7, vcc
v_cmp_eq_u32 vcc, 11, v5
s_nop 1
v_cndmask_b32 v87, v9, v8, vcc
s_mov_b32 s60, 1048576
s_mov_b32 s61, 1052672
s_lshl_b32 s56, s39, 13
s_lshl_b32 s58, s38, 11
s_add_u32 s62, s56, s58
s_add_u32 s62, s62, 1048576
s_add_u32 s64, s56, 33554432
s_add_u32 s65, s56, 100663296
s_mov_b32 s63, 4194304
s_lshl_b32 s56, s39, 4
s_lshl_b32 s58, s38, 2
s_add_u32 s66, s56, s58
s_cmp_eq_u32 s66, 0
s_cselect_b32 s79, 1, 0
s_add_u32 s66, s66, 4096
s_cmp_lg_u32 s79, 0
s_cselect_b64 s[94:95], 0xffff, 0
s_mov_b64 s[96:97], -1
s_and_b32 s78, s38, 1
s_lshl_b32 s78, s78, 24
s_add_u32 s78, s78, 0x80000
s_mov_b32 s68, 0x0
s_mov_b32 s76, 0
s_mov_b32 s77, 0x42800000
s_mov_b32 s70, 0x5040100
s_mov_b32 s71, 0x7060302
s_mov_b32 s72, 0x3e0293ee
s_mov_b32 s84, 0xff00ff00
s_mov_b32 s85, 0xff00ff00
s_mov_b32 s56, 4194304
buffer_load_dword v13, v97, s[4:7], s56 offen sc1
s_mov_b32 s56, 4202496
buffer_load_dword v13, v97, s[4:7], s56 offen sc1
v_mov_b32 v8, -1
v_mov_b32 v9, -1
v_mov_b32 v10, -1
v_mov_b32 v11, -1
s_mov_b32 s56, 0x100000
buffer_store_dwordx4 v[8:11], v96, s[4:7], s56 offen sc1
s_mov_b32 s56, 0x101000
buffer_store_dwordx4 v[8:11], v96, s[4:7], s56 offen sc1
s_mov_b32 s56, 0x140000
buffer_store_dwordx4 v[8:11], v96, s[4:7], s56 offen sc1
s_mov_b32 s56, 0x141000
buffer_store_dwordx4 v[8:11], v96, s[4:7], s56 offen sc1
s_mov_b32 s56, 4202496
buffer_store_dword v8, v97, s[4:7], s56 offen sc1
s_waitcnt vmcnt(55)
v_perm_b32 v224, v25, v24, s70
v_perm_b32 v225, v27, v26, s70
v_perm_b32 v226, v29, v28, s70
v_perm_b32 v227, v31, v30, s70
v_perm_b32 v228, v33, v32, s70
v_perm_b32 v229, v35, v34, s70
v_perm_b32 v230, v37, v36, s70
v_perm_b32 v231, v39, v38, s70
ds_write_b128 v99, v[224:227] offset:0
ds_write_b128 v99, v[228:231] offset:1024
s_waitcnt lgkmcnt(0)
v_perm_b32 v232, v25, v24, s71
v_accvgpr_write_b32 a0, v232
v_perm_b32 v232, v27, v26, s71
v_accvgpr_write_b32 a1, v232
v_perm_b32 v232, v29, v28, s71
v_accvgpr_write_b32 a2, v232
v_perm_b32 v232, v31, v30, s71
v_accvgpr_write_b32 a3, v232
v_perm_b32 v232, v33, v32, s71
v_accvgpr_write_b32 a4, v232
v_perm_b32 v232, v35, v34, s71
v_accvgpr_write_b32 a5, v232
v_perm_b32 v232, v37, v36, s71
v_accvgpr_write_b32 a6, v232
v_perm_b32 v232, v39, v38, s71
v_accvgpr_write_b32 a7, v232
s_cmp_eq_u32 s59, 1
s_cbranch_scc1 L_thr_1
s_waitcnt vmcnt(32)
L_thr_1:
s_mov_b32 s56, 0x8000
buffer_load_dword v24, v20, s[16:19], s56 offen
s_mov_b32 s56, 0xa000
buffer_load_dword v25, v20, s[16:19], s56 offen
s_mov_b32 s56, 0x108000
buffer_load_dword v26, v20, s[16:19], s56 offen
s_mov_b32 s56, 0x10a000
buffer_load_dword v27, v20, s[16:19], s56 offen
s_mov_b32 s56, 0x18000
buffer_load_dword v28, v20, s[16:19], s56 offen
s_mov_b32 s56, 0x1a000
buffer_load_dword v29, v20, s[16:19], s56 offen
s_mov_b32 s56, 0x118000
buffer_load_dword v30, v20, s[16:19], s56 offen
s_mov_b32 s56, 0x11a000
buffer_load_dword v31, v20, s[16:19], s56 offen
s_mov_b32 s56, 0xc000
buffer_load_dword v32, v20, s[16:19], s56 offen
s_mov_b32 s56, 0xe000
buffer_load_dword v33, v20, s[16:19], s56 offen
s_mov_b32 s56, 0x10c000
buffer_load_dword v34, v20, s[16:19], s56 offen
s_mov_b32 s56, 0x10e000
buffer_load_dword v35, v20, s[16:19], s56 offen
s_mov_b32 s56, 0x1c000
buffer_load_dword v36, v20, s[16:19], s56 offen
s_mov_b32 s56, 0x1e000
buffer_load_dword v37, v20, s[16:19], s56 offen
s_mov_b32 s56, 0x11c000
buffer_load_dword v38, v20, s[16:19], s56 offen
s_mov_b32 s56, 0x11e000
buffer_load_dword v39, v20, s[16:19], s56 offen
s_barrier
s_waitcnt vmcnt(55)
v_perm_b32 v224, v41, v40, s70
v_perm_b32 v225, v43, v42, s70
v_perm_b32 v226, v45, v44, s70
v_perm_b32 v227, v47, v46, s70
v_perm_b32 v228, v49, v48, s70
v_perm_b32 v229, v51, v50, s70
v_perm_b32 v230, v53, v52, s70
v_perm_b32 v231, v55, v54, s70
ds_write_b128 v99, v[224:227] offset:2048
ds_write_b128 v99, v[228:231] offset:3072
s_waitcnt lgkmcnt(0)
v_perm_b32 v232, v41, v40, s71
v_accvgpr_write_b32 a40, v232
v_perm_b32 v232, v43, v42, s71
v_accvgpr_write_b32 a41, v232
v_perm_b32 v232, v45, v44, s71
v_accvgpr_write_b32 a42, v232
v_perm_b32 v232, v47, v46, s71
v_accvgpr_write_b32 a43, v232
v_perm_b32 v232, v49, v48, s71
v_accvgpr_write_b32 a44, v232
v_perm_b32 v232, v51, v50, s71
v_accvgpr_write_b32 a45, v232
v_perm_b32 v232, v53, v52, s71
v_accvgpr_write_b32 a46, v232
v_perm_b32 v232, v55, v54, s71
v_accvgpr_write_b32 a47, v232
s_cmp_eq_u32 s59, 1
s_cbranch_scc1 L_thr_2
s_waitcnt vmcnt(32)
L_thr_2:
s_mov_b32 s56, 0x208000
buffer_load_dword v40, v20, s[16:19], s56 offen
s_mov_b32 s56, 0x20a000
buffer_load_dword v41, v20, s[16:19], s56 offen
s_mov_b32 s56, 0x308000
buffer_load_dword v42, v20, s[16:19], s56 offen
s_mov_b32 s56, 0x30a000
buffer_load_dword v43, v20, s[16:19], s56 offen
s_mov_b32 s56, 0x218000
buffer_load_dword v44, v20, s[16:19], s56 offen
s_mov_b32 s56, 0x21a000
buffer_load_dword v45, v20, s[16:19], s56 offen
s_mov_b32 s56, 0x318000
buffer_load_dword v46, v20, s[16:19], s56 offen
s_mov_b32 s56, 0x31a000
buffer_load_dword v47, v20, s[16:19], s56 offen
s_mov_b32 s56, 0x20c000
buffer_load_dword v48, v20, s[16:19], s56 offen
s_mov_b32 s56, 0x20e000
buffer_load_dword v49, v20, s[16:19], s56 offen
s_mov_b32 s56, 0x30c000
buffer_load_dword v50, v20, s[16:19], s56 offen
s_mov_b32 s56, 0x30e000
buffer_load_dword v51, v20, s[16:19], s56 offen
s_mov_b32 s56, 0x21c000
buffer_load_dword v52, v20, s[16:19], s56 offen
s_mov_b32 s56, 0x21e000
buffer_load_dword v53, v20, s[16:19], s56 offen
s_mov_b32 s56, 0x31c000
buffer_load_dword v54, v20, s[16:19], s56 offen
s_mov_b32 s56, 0x31e000
buffer_load_dword v55, v20, s[16:19], s56 offen
s_barrier
s_waitcnt vmcnt(55)
v_perm_b32 v224, v241, v240, s70
v_perm_b32 v225, v243, v242, s70
v_perm_b32 v226, v245, v244, s70
v_perm_b32 v227, v247, v246, s70
v_perm_b32 v228, v249, v248, s70
v_perm_b32 v229, v251, v250, s70
v_perm_b32 v230, v253, v252, s70
v_perm_b32 v231, v255, v254, s70
ds_write_b128 v99, v[224:227] offset:4096
ds_write_b128 v99, v[228:231] offset:5120
s_waitcnt lgkmcnt(0)
v_perm_b32 v232, v241, v240, s71
v_accvgpr_write_b32 a80, v232
v_perm_b32 v232, v243, v242, s71
v_accvgpr_write_b32 a81, v232
v_perm_b32 v232, v245, v244, s71
v_accvgpr_write_b32 a82, v232
v_perm_b32 v232, v247, v246, s71
v_accvgpr_write_b32 a83, v232
v_perm_b32 v232, v249, v248, s71
v_accvgpr_write_b32 a84, v232
v_perm_b32 v232, v251, v250, s71
v_accvgpr_write_b32 a85, v232
v_perm_b32 v232, v253, v252, s71
v_accvgpr_write_b32 a86, v232
v_perm_b32 v232, v255, v254, s71
v_accvgpr_write_b32 a87, v232
s_cmp_eq_u32 s59, 1
s_cbranch_scc1 L_thr_3
s_waitcnt vmcnt(32)
L_thr_3:
s_mov_b32 s56, 0x48000
buffer_load_dword v240, v20, s[16:19], s56 offen
s_mov_b32 s56, 0x4a000
buffer_load_dword v241, v20, s[16:19], s56 offen
s_mov_b32 s56, 0x148000
buffer_load_dword v242, v20, s[16:19], s56 offen
s_mov_b32 s56, 0x14a000
buffer_load_dword v243, v20, s[16:19], s56 offen
s_mov_b32 s56, 0x58000
buffer_load_dword v244, v20, s[16:19], s56 offen
s_mov_b32 s56, 0x5a000
buffer_load_dword v245, v20, s[16:19], s56 offen
s_mov_b32 s56, 0x158000
buffer_load_dword v246, v20, s[16:19], s56 offen
s_mov_b32 s56, 0x15a000
buffer_load_dword v247, v20, s[16:19], s56 offen
s_mov_b32 s56, 0x4c000
buffer_load_dword v248, v20, s[16:19], s56 offen
s_mov_b32 s56, 0x4e000
buffer_load_dword v249, v20, s[16:19], s56 offen
s_mov_b32 s56, 0x14c000
buffer_load_dword v250, v20, s[16:19], s56 offen
s_mov_b32 s56, 0x14e000
buffer_load_dword v251, v20, s[16:19], s56 offen
s_mov_b32 s56, 0x5c000
buffer_load_dword v252, v20, s[16:19], s56 offen
s_mov_b32 s56, 0x5e000
buffer_load_dword v253, v20, s[16:19], s56 offen
s_mov_b32 s56, 0x15c000
buffer_load_dword v254, v20, s[16:19], s56 offen
s_mov_b32 s56, 0x15e000
buffer_load_dword v255, v20, s[16:19], s56 offen
s_barrier
s_waitcnt vmcnt(55)
v_perm_b32 v224, v57, v56, s70
v_perm_b32 v225, v59, v58, s70
v_perm_b32 v226, v61, v60, s70
v_perm_b32 v227, v63, v62, s70
v_perm_b32 v228, v65, v64, s70
v_perm_b32 v229, v67, v66, s70
v_perm_b32 v230, v69, v68, s70
v_perm_b32 v231, v71, v70, s70
ds_write_b128 v99, v[224:227] offset:6144
ds_write_b128 v99, v[228:231] offset:7168
s_waitcnt lgkmcnt(0)
v_perm_b32 v232, v57, v56, s71
v_accvgpr_write_b32 a120, v232
v_perm_b32 v232, v59, v58, s71
v_accvgpr_write_b32 a121, v232
v_perm_b32 v232, v61, v60, s71
v_accvgpr_write_b32 a122, v232
v_perm_b32 v232, v63, v62, s71
v_accvgpr_write_b32 a123, v232
v_perm_b32 v232, v65, v64, s71
v_accvgpr_write_b32 a124, v232
v_perm_b32 v232, v67, v66, s71
v_accvgpr_write_b32 a125, v232
v_perm_b32 v232, v69, v68, s71
v_accvgpr_write_b32 a126, v232
v_perm_b32 v232, v71, v70, s71
v_accvgpr_write_b32 a127, v232
s_cmp_eq_u32 s59, 1
s_cbranch_scc1 L_thr_4
s_waitcnt vmcnt(32)
L_thr_4:
s_mov_b32 s56, 0x248000
buffer_load_dword v56, v20, s[16:19], s56 offen
s_mov_b32 s56, 0x24a000
buffer_load_dword v57, v20, s[16:19], s56 offen
s_mov_b32 s56, 0x348000
buffer_load_dword v58, v20, s[16:19], s56 offen
s_mov_b32 s56, 0x34a000
buffer_load_dword v59, v20, s[16:19], s56 offen
s_mov_b32 s56, 0x258000
buffer_load_dword v60, v20, s[16:19], s56 offen
s_mov_b32 s56, 0x25a000
buffer_load_dword v61, v20, s[16:19], s56 offen
s_mov_b32 s56, 0x358000
buffer_load_dword v62, v20, s[16:19], s56 offen
s_mov_b32 s56, 0x35a000
buffer_load_dword v63, v20, s[16:19], s56 offen
s_mov_b32 s56, 0x24c000
buffer_load_dword v64, v20, s[16:19], s56 offen
s_mov_b32 s56, 0x24e000
buffer_load_dword v65, v20, s[16:19], s56 offen
s_mov_b32 s56, 0x34c000
buffer_load_dword v66, v20, s[16:19], s56 offen
s_mov_b32 s56, 0x34e000
buffer_load_dword v67, v20, s[16:19], s56 offen
s_mov_b32 s56, 0x25c000
buffer_load_dword v68, v20, s[16:19], s56 offen
s_mov_b32 s56, 0x25e000
buffer_load_dword v69, v20, s[16:19], s56 offen
s_mov_b32 s56, 0x35c000
buffer_load_dword v70, v20, s[16:19], s56 offen
s_mov_b32 s56, 0x35e000
buffer_load_dword v71, v20, s[16:19], s56 offen
s_barrier
s_waitcnt vmcnt(48)
v_perm_b32 v224, v25, v24, s70
v_perm_b32 v225, v27, v26, s70
v_perm_b32 v226, v29, v28, s70
v_perm_b32 v227, v31, v30, s70
v_perm_b32 v228, v33, v32, s70
v_perm_b32 v229, v35, v34, s70
v_perm_b32 v230, v37, v36, s70
v_perm_b32 v231, v39, v38, s70
ds_write_b128 v99, v[224:227] offset:8192
ds_write_b128 v99, v[228:231] offset:9216
s_waitcnt lgkmcnt(0)
v_perm_b32 v112, v25, v24, s71
v_perm_b32 v113, v27, v26, s71
v_perm_b32 v114, v29, v28, s71
v_perm_b32 v115, v31, v30, s71
v_perm_b32 v116, v33, v32, s71
v_perm_b32 v117, v35, v34, s71
v_perm_b32 v118, v37, v36, s71
v_perm_b32 v119, v39, v38, s71
s_mov_b64 exec, 1
v_mov_b32 v5, 132
v_mov_b32 v6, 1
global_atomic_add v5, v6, s[36:37] sc1
s_mov_b64 exec, -1
s_cmp_eq_u32 s59, 1
s_cbranch_scc1 L_thr_5
s_waitcnt vmcnt(32)
L_thr_5:
s_mov_b32 s56, 0x0
buffer_load_dword v24, v20, s[20:23], s56 offen
s_mov_b32 s56, 0x2000
buffer_load_dword v25, v20, s[20:23], s56 offen
s_mov_b32 s56, 0x100000
buffer_load_dword v26, v20, s[20:23], s56 offen
s_mov_b32 s56, 0x102000
buffer_load_dword v27, v20, s[20:23], s56 offen
s_mov_b32 s56, 0x10000
buffer_load_dword v28, v20, s[20:23], s56 offen
s_mov_b32 s56, 0x12000
buffer_load_dword v29, v20, s[20:23], s56 offen
s_mov_b32 s56, 0x110000
buffer_load_dword v30, v20, s[20:23], s56 offen
s_mov_b32 s56, 0x112000
buffer_load_dword v31, v20, s[20:23], s56 offen
s_mov_b32 s56, 0x4000
buffer_load_dword v32, v20, s[20:23], s56 offen
s_mov_b32 s56, 0x6000
buffer_load_dword v33, v20, s[20:23], s56 offen
s_mov_b32 s56, 0x104000
buffer_load_dword v34, v20, s[20:23], s56 offen
s_mov_b32 s56, 0x106000
buffer_load_dword v35, v20, s[20:23], s56 offen
s_mov_b32 s56, 0x14000
buffer_load_dword v36, v20, s[20:23], s56 offen
s_mov_b32 s56, 0x16000
buffer_load_dword v37, v20, s[20:23], s56 offen
s_mov_b32 s56, 0x114000
buffer_load_dword v38, v20, s[20:23], s56 offen
s_mov_b32 s56, 0x116000
buffer_load_dword v39, v20, s[20:23], s56 offen
s_barrier
s_waitcnt vmcnt(49)
v_perm_b32 v224, v41, v40, s70
v_perm_b32 v225, v43, v42, s70
v_perm_b32 v226, v45, v44, s70
v_perm_b32 v227, v47, v46, s70
v_perm_b32 v228, v49, v48, s70
v_perm_b32 v229, v51, v50, s70
v_perm_b32 v230, v53, v52, s70
v_perm_b32 v231, v55, v54, s70
ds_write_b128 v99, v[224:227] offset:10240
ds_write_b128 v99, v[228:231] offset:11264
s_waitcnt lgkmcnt(0)
v_perm_b32 v120, v41, v40, s71
v_perm_b32 v121, v43, v42, s71
v_perm_b32 v122, v45, v44, s71
v_perm_b32 v123, v47, v46, s71
v_perm_b32 v124, v49, v48, s71
v_perm_b32 v125, v51, v50, s71
v_perm_b32 v126, v53, v52, s71
v_perm_b32 v127, v55, v54, s71
s_cmp_eq_u32 s59, 1
s_cbranch_scc1 L_thr_6
s_waitcnt vmcnt(32)
L_thr_6:
s_mov_b32 s56, 0x200000
buffer_load_dword v40, v20, s[20:23], s56 offen
s_mov_b32 s56, 0x202000
buffer_load_dword v41, v20, s[20:23], s56 offen
s_mov_b32 s56, 0x300000
buffer_load_dword v42, v20, s[20:23], s56 offen
s_mov_b32 s56, 0x302000
buffer_load_dword v43, v20, s[20:23], s56 offen
s_mov_b32 s56, 0x210000
buffer_load_dword v44, v20, s[20:23], s56 offen
s_mov_b32 s56, 0x212000
buffer_load_dword v45, v20, s[20:23], s56 offen
s_mov_b32 s56, 0x310000
buffer_load_dword v46, v20, s[20:23], s56 offen
s_mov_b32 s56, 0x312000
buffer_load_dword v47, v20, s[20:23], s56 offen
s_mov_b32 s56, 0x204000
buffer_load_dword v48, v20, s[20:23], s56 offen
s_mov_b32 s56, 0x206000
buffer_load_dword v49, v20, s[20:23], s56 offen
s_mov_b32 s56, 0x304000
buffer_load_dword v50, v20, s[20:23], s56 offen
s_mov_b32 s56, 0x306000
buffer_load_dword v51, v20, s[20:23], s56 offen
s_mov_b32 s56, 0x214000
buffer_load_dword v52, v20, s[20:23], s56 offen
s_mov_b32 s56, 0x216000
buffer_load_dword v53, v20, s[20:23], s56 offen
s_mov_b32 s56, 0x314000
buffer_load_dword v54, v20, s[20:23], s56 offen
s_mov_b32 s56, 0x316000
buffer_load_dword v55, v20, s[20:23], s56 offen
s_barrier
s_waitcnt vmcnt(49)
v_perm_b32 v224, v241, v240, s70
v_perm_b32 v225, v243, v242, s70
v_perm_b32 v226, v245, v244, s70
v_perm_b32 v227, v247, v246, s70
v_perm_b32 v228, v249, v248, s70
v_perm_b32 v229, v251, v250, s70
v_perm_b32 v230, v253, v252, s70
v_perm_b32 v231, v255, v254, s70
ds_write_b128 v99, v[224:227] offset:12288
ds_write_b128 v99, v[228:231] offset:13312
s_waitcnt lgkmcnt(0)
v_perm_b32 v128, v241, v240, s71
v_perm_b32 v129, v243, v242, s71
v_perm_b32 v130, v245, v244, s71
v_perm_b32 v131, v247, v246, s71
v_perm_b32 v132, v249, v248, s71
v_perm_b32 v133, v251, v250, s71
v_perm_b32 v134, v253, v252, s71
v_perm_b32 v135, v255, v254, s71
s_cmp_eq_u32 s59, 1
s_cbranch_scc1 L_thr_7
s_waitcnt vmcnt(32)
L_thr_7:
s_mov_b32 s56, 0x40000
buffer_load_dword v240, v20, s[20:23], s56 offen
s_mov_b32 s56, 0x42000
buffer_load_dword v241, v20, s[20:23], s56 offen
s_mov_b32 s56, 0x140000
buffer_load_dword v242, v20, s[20:23], s56 offen
s_mov_b32 s56, 0x142000
buffer_load_dword v243, v20, s[20:23], s56 offen
s_mov_b32 s56, 0x50000
buffer_load_dword v244, v20, s[20:23], s56 offen
s_mov_b32 s56, 0x52000
buffer_load_dword v245, v20, s[20:23], s56 offen
s_mov_b32 s56, 0x150000
buffer_load_dword v246, v20, s[20:23], s56 offen
s_mov_b32 s56, 0x152000
buffer_load_dword v247, v20, s[20:23], s56 offen
s_mov_b32 s56, 0x44000
buffer_load_dword v248, v20, s[20:23], s56 offen
s_mov_b32 s56, 0x46000
buffer_load_dword v249, v20, s[20:23], s56 offen
s_mov_b32 s56, 0x144000
buffer_load_dword v250, v20, s[20:23], s56 offen
s_mov_b32 s56, 0x146000
buffer_load_dword v251, v20, s[20:23], s56 offen
s_mov_b32 s56, 0x54000
buffer_load_dword v252, v20, s[20:23], s56 offen
s_mov_b32 s56, 0x56000
buffer_load_dword v253, v20, s[20:23], s56 offen
s_mov_b32 s56, 0x154000
buffer_load_dword v254, v20, s[20:23], s56 offen
s_mov_b32 s56, 0x156000
buffer_load_dword v255, v20, s[20:23], s56 offen
s_barrier
s_waitcnt vmcnt(49)
v_perm_b32 v224, v57, v56, s70
v_perm_b32 v225, v59, v58, s70
v_perm_b32 v226, v61, v60, s70
v_perm_b32 v227, v63, v62, s70
v_perm_b32 v228, v65, v64, s70
v_perm_b32 v229, v67, v66, s70
v_perm_b32 v230, v69, v68, s70
v_perm_b32 v231, v71, v70, s70
ds_write_b128 v99, v[224:227] offset:18432
ds_write_b128 v99, v[228:231] offset:19456
s_waitcnt lgkmcnt(0)
v_perm_b32 v136, v57, v56, s71
v_perm_b32 v137, v59, v58, s71
v_perm_b32 v138, v61, v60, s71
v_perm_b32 v139, v63, v62, s71
v_perm_b32 v140, v65, v64, s71
v_perm_b32 v141, v67, v66, s71
v_perm_b32 v142, v69, v68, s71
v_perm_b32 v143, v71, v70, s71
s_cmp_eq_u32 s59, 1
s_cbranch_scc1 L_thr_8
s_waitcnt vmcnt(32)
L_thr_8:
s_mov_b32 s56, 0x240000
buffer_load_dword v56, v20, s[20:23], s56 offen
s_mov_b32 s56, 0x242000
buffer_load_dword v57, v20, s[20:23], s56 offen
s_mov_b32 s56, 0x340000
buffer_load_dword v58, v20, s[20:23], s56 offen
s_mov_b32 s56, 0x342000
buffer_load_dword v59, v20, s[20:23], s56 offen
s_mov_b32 s56, 0x250000
buffer_load_dword v60, v20, s[20:23], s56 offen
s_mov_b32 s56, 0x252000
buffer_load_dword v61, v20, s[20:23], s56 offen
s_mov_b32 s56, 0x350000
buffer_load_dword v62, v20, s[20:23], s56 offen
s_mov_b32 s56, 0x352000
buffer_load_dword v63, v20, s[20:23], s56 offen
s_mov_b32 s56, 0x244000
buffer_load_dword v64, v20, s[20:23], s56 offen
s_mov_b32 s56, 0x246000
buffer_load_dword v65, v20, s[20:23], s56 offen
s_mov_b32 s56, 0x344000
buffer_load_dword v66, v20, s[20:23], s56 offen
s_mov_b32 s56, 0x346000
buffer_load_dword v67, v20, s[20:23], s56 offen
s_mov_b32 s56, 0x254000
buffer_load_dword v68, v20, s[20:23], s56 offen
s_mov_b32 s56, 0x256000
buffer_load_dword v69, v20, s[20:23], s56 offen
s_mov_b32 s56, 0x354000
buffer_load_dword v70, v20, s[20:23], s56 offen
s_mov_b32 s56, 0x356000
buffer_load_dword v71, v20, s[20:23], s56 offen
s_barrier
s_waitcnt vmcnt(48)
v_perm_b32 v224, v25, v24, s70
v_accvgpr_write_b32 a8, v224
v_perm_b32 v224, v27, v26, s70
v_accvgpr_write_b32 a9, v224
v_perm_b32 v224, v29, v28, s70
v_accvgpr_write_b32 a10, v224
v_perm_b32 v224, v31, v30, s70
v_accvgpr_write_b32 a11, v224
v_perm_b32 v224, v33, v32, s70
v_accvgpr_write_b32 a12, v224
v_perm_b32 v224, v35, v34, s70
v_accvgpr_write_b32 a13, v224
v_perm_b32 v224, v37, v36, s70
v_accvgpr_write_b32 a14, v224
v_perm_b32 v224, v39, v38, s70
v_accvgpr_write_b32 a15, v224
v_perm_b32 v232, v25, v24, s71
v_accvgpr_write_b32 a24, v232
v_perm_b32 v232, v27, v26, s71
v_accvgpr_write_b32 a25, v232
v_perm_b32 v232, v29, v28, s71
v_accvgpr_write_b32 a26, v232
v_perm_b32 v232, v31, v30, s71
v_accvgpr_write_b32 a27, v232
v_perm_b32 v232, v33, v32, s71
v_accvgpr_write_b32 a28, v232
v_perm_b32 v232, v35, v34, s71
v_accvgpr_write_b32 a29, v232
v_perm_b32 v232, v37, v36, s71
v_accvgpr_write_b32 a30, v232
v_perm_b32 v232, v39, v38, s71
v_accvgpr_write_b32 a31, v232
s_cmp_eq_u32 s59, 1
s_cbranch_scc1 L_thr_9
s_waitcnt vmcnt(32)
L_thr_9:
s_mov_b32 s56, 0x8000
buffer_load_dword v24, v20, s[20:23], s56 offen
s_mov_b32 s56, 0xa000
buffer_load_dword v25, v20, s[20:23], s56 offen
s_mov_b32 s56, 0x108000
buffer_load_dword v26, v20, s[20:23], s56 offen
s_mov_b32 s56, 0x10a000
buffer_load_dword v27, v20, s[20:23], s56 offen
s_mov_b32 s56, 0x18000
buffer_load_dword v28, v20, s[20:23], s56 offen
s_mov_b32 s56, 0x1a000
buffer_load_dword v29, v20, s[20:23], s56 offen
s_mov_b32 s56, 0x118000
buffer_load_dword v30, v20, s[20:23], s56 offen
s_mov_b32 s56, 0x11a000
buffer_load_dword v31, v20, s[20:23], s56 offen
s_mov_b32 s56, 0xc000
buffer_load_dword v32, v20, s[20:23], s56 offen
s_mov_b32 s56, 0xe000
buffer_load_dword v33, v20, s[20:23], s56 offen
s_mov_b32 s56, 0x10c000
buffer_load_dword v34, v20, s[20:23], s56 offen
s_mov_b32 s56, 0x10e000
buffer_load_dword v35, v20, s[20:23], s56 offen
s_mov_b32 s56, 0x1c000
buffer_load_dword v36, v20, s[20:23], s56 offen
s_mov_b32 s56, 0x1e000
buffer_load_dword v37, v20, s[20:23], s56 offen
s_mov_b32 s56, 0x11c000
buffer_load_dword v38, v20, s[20:23], s56 offen
s_mov_b32 s56, 0x11e000
buffer_load_dword v39, v20, s[20:23], s56 offen
s_barrier
s_waitcnt vmcnt(48)
v_perm_b32 v224, v41, v40, s70
v_accvgpr_write_b32 a48, v224
v_perm_b32 v224, v43, v42, s70
v_accvgpr_write_b32 a49, v224
v_perm_b32 v224, v45, v44, s70
v_accvgpr_write_b32 a50, v224
v_perm_b32 v224, v47, v46, s70
v_accvgpr_write_b32 a51, v224
v_perm_b32 v224, v49, v48, s70
v_accvgpr_write_b32 a52, v224
v_perm_b32 v224, v51, v50, s70
v_accvgpr_write_b32 a53, v224
v_perm_b32 v224, v53, v52, s70
v_accvgpr_write_b32 a54, v224
v_perm_b32 v224, v55, v54, s70
v_accvgpr_write_b32 a55, v224
v_perm_b32 v232, v41, v40, s71
v_accvgpr_write_b32 a64, v232
v_perm_b32 v232, v43, v42, s71
v_accvgpr_write_b32 a65, v232
v_perm_b32 v232, v45, v44, s71
v_accvgpr_write_b32 a66, v232
v_perm_b32 v232, v47, v46, s71
v_accvgpr_write_b32 a67, v232
v_perm_b32 v232, v49, v48, s71
v_accvgpr_write_b32 a68, v232
v_perm_b32 v232, v51, v50, s71
v_accvgpr_write_b32 a69, v232
v_perm_b32 v232, v53, v52, s71
v_accvgpr_write_b32 a70, v232
v_perm_b32 v232, v55, v54, s71
v_accvgpr_write_b32 a71, v232
v_mov_b32 v5, 64
global_load_dword v6, v5, s[36:37] sc1
s_cmp_eq_u32 s59, 1
s_cbranch_scc1 L_thr_10
s_waitcnt vmcnt(32)
L_thr_10:
s_mov_b32 s56, 0x208000
buffer_load_dword v40, v20, s[20:23], s56 offen
s_mov_b32 s56, 0x20a000
buffer_load_dword v41, v20, s[20:23], s56 offen
s_mov_b32 s56, 0x308000
buffer_load_dword v42, v20, s[20:23], s56 offen
s_mov_b32 s56, 0x30a000
buffer_load_dword v43, v20, s[20:23], s56 offen
s_mov_b32 s56, 0x218000
buffer_load_dword v44, v20, s[20:23], s56 offen
s_mov_b32 s56, 0x21a000
buffer_load_dword v45, v20, s[20:23], s56 offen
s_mov_b32 s56, 0x318000
buffer_load_dword v46, v20, s[20:23], s56 offen
s_mov_b32 s56, 0x31a000
buffer_load_dword v47, v20, s[20:23], s56 offen
s_mov_b32 s56, 0x20c000
buffer_load_dword v48, v20, s[20:23], s56 offen
s_mov_b32 s56, 0x20e000
buffer_load_dword v49, v20, s[20:23], s56 offen
s_mov_b32 s56, 0x30c000
buffer_load_dword v50, v20, s[20:23], s56 offen
s_mov_b32 s56, 0x30e000
buffer_load_dword v51, v20, s[20:23], s56 offen
s_mov_b32 s56, 0x21c000
buffer_load_dword v52, v20, s[20:23], s56 offen
s_mov_b32 s56, 0x21e000
buffer_load_dword v53, v20, s[20:23], s56 offen
s_mov_b32 s56, 0x31c000
buffer_load_dword v54, v20, s[20:23], s56 offen
s_mov_b32 s56, 0x31e000
buffer_load_dword v55, v20, s[20:23], s56 offen
s_barrier
s_waitcnt vmcnt(49)
v_perm_b32 v224, v241, v240, s70
v_accvgpr_write_b32 a88, v224
v_perm_b32 v224, v243, v242, s70
v_accvgpr_write_b32 a89, v224
v_perm_b32 v224, v245, v244, s70
v_accvgpr_write_b32 a90, v224
v_perm_b32 v224, v247, v246, s70
v_accvgpr_write_b32 a91, v224
v_perm_b32 v224, v249, v248, s70
v_accvgpr_write_b32 a92, v224
v_perm_b32 v224, v251, v250, s70
v_accvgpr_write_b32 a93, v224
v_perm_b32 v224, v253, v252, s70
v_accvgpr_write_b32 a94, v224
v_perm_b32 v224, v255, v254, s70
v_accvgpr_write_b32 a95, v224
v_perm_b32 v232, v241, v240, s71
v_accvgpr_write_b32 a104, v232
v_perm_b32 v232, v243, v242, s71
v_accvgpr_write_b32 a105, v232
v_perm_b32 v232, v245, v244, s71
v_accvgpr_write_b32 a106, v232
v_perm_b32 v232, v247, v246, s71
v_accvgpr_write_b32 a107, v232
v_perm_b32 v232, v249, v248, s71
v_accvgpr_write_b32 a108, v232
v_perm_b32 v232, v251, v250, s71
v_accvgpr_write_b32 a109, v232
v_perm_b32 v232, v253, v252, s71
v_accvgpr_write_b32 a110, v232
v_perm_b32 v232, v255, v254, s71
v_accvgpr_write_b32 a111, v232
s_cmp_eq_u32 s59, 1
s_cbranch_scc1 L_thr_11
s_waitcnt vmcnt(32)
L_thr_11:
s_mov_b32 s56, 0x48000
buffer_load_dword v240, v20, s[20:23], s56 offen
s_mov_b32 s56, 0x4a000
buffer_load_dword v241, v20, s[20:23], s56 offen
s_mov_b32 s56, 0x148000
buffer_load_dword v242, v20, s[20:23], s56 offen
s_mov_b32 s56, 0x14a000
buffer_load_dword v243, v20, s[20:23], s56 offen
s_mov_b32 s56, 0x58000
buffer_load_dword v244, v20, s[20:23], s56 offen
s_mov_b32 s56, 0x5a000
buffer_load_dword v245, v20, s[20:23], s56 offen
s_mov_b32 s56, 0x158000
buffer_load_dword v246, v20, s[20:23], s56 offen
s_mov_b32 s56, 0x15a000
buffer_load_dword v247, v20, s[20:23], s56 offen
s_mov_b32 s56, 0x4c000
buffer_load_dword v248, v20, s[20:23], s56 offen
s_mov_b32 s56, 0x4e000
buffer_load_dword v249, v20, s[20:23], s56 offen
s_mov_b32 s56, 0x14c000
buffer_load_dword v250, v20, s[20:23], s56 offen
s_mov_b32 s56, 0x14e000
buffer_load_dword v251, v20, s[20:23], s56 offen
s_mov_b32 s56, 0x5c000
buffer_load_dword v252, v20, s[20:23], s56 offen
s_mov_b32 s56, 0x5e000
buffer_load_dword v253, v20, s[20:23], s56 offen
s_mov_b32 s56, 0x15c000
buffer_load_dword v254, v20, s[20:23], s56 offen
s_mov_b32 s56, 0x15e000
buffer_load_dword v255, v20, s[20:23], s56 offen
s_barrier
s_waitcnt vmcnt(49)
v_perm_b32 v224, v57, v56, s70
v_accvgpr_write_b32 a128, v224
v_perm_b32 v224, v59, v58, s70
v_accvgpr_write_b32 a129, v224
v_perm_b32 v224, v61, v60, s70
v_accvgpr_write_b32 a130, v224
v_perm_b32 v224, v63, v62, s70
v_accvgpr_write_b32 a131, v224
v_perm_b32 v224, v65, v64, s70
v_accvgpr_write_b32 a132, v224
v_perm_b32 v224, v67, v66, s70
v_accvgpr_write_b32 a133, v224
v_perm_b32 v224, v69, v68, s70
v_accvgpr_write_b32 a134, v224
v_perm_b32 v224, v71, v70, s70
v_accvgpr_write_b32 a135, v224
v_perm_b32 v232, v57, v56, s71
v_accvgpr_write_b32 a144, v232
v_perm_b32 v232, v59, v58, s71
v_accvgpr_write_b32 a145, v232
v_perm_b32 v232, v61, v60, s71
v_accvgpr_write_b32 a146, v232
v_perm_b32 v232, v63, v62, s71
v_accvgpr_write_b32 a147, v232
v_perm_b32 v232, v65, v64, s71
v_accvgpr_write_b32 a148, v232
v_perm_b32 v232, v67, v66, s71
v_accvgpr_write_b32 a149, v232
v_perm_b32 v232, v69, v68, s71
v_accvgpr_write_b32 a150, v232
v_perm_b32 v232, v71, v70, s71
v_accvgpr_write_b32 a151, v232
s_cmp_eq_u32 s59, 1
s_cbranch_scc1 L_thr_12
s_waitcnt vmcnt(32)
L_thr_12:
s_mov_b32 s56, 0x248000
buffer_load_dword v56, v20, s[20:23], s56 offen
s_mov_b32 s56, 0x24a000
buffer_load_dword v57, v20, s[20:23], s56 offen
s_mov_b32 s56, 0x348000
buffer_load_dword v58, v20, s[20:23], s56 offen
s_mov_b32 s56, 0x34a000
buffer_load_dword v59, v20, s[20:23], s56 offen
s_mov_b32 s56, 0x258000
buffer_load_dword v60, v20, s[20:23], s56 offen
s_mov_b32 s56, 0x25a000
buffer_load_dword v61, v20, s[20:23], s56 offen
s_mov_b32 s56, 0x358000
buffer_load_dword v62, v20, s[20:23], s56 offen
s_mov_b32 s56, 0x35a000
buffer_load_dword v63, v20, s[20:23], s56 offen
s_mov_b32 s56, 0x24c000
buffer_load_dword v64, v20, s[20:23], s56 offen
s_mov_b32 s56, 0x24e000
buffer_load_dword v65, v20, s[20:23], s56 offen
s_mov_b32 s56, 0x34c000
buffer_load_dword v66, v20, s[20:23], s56 offen
s_mov_b32 s56, 0x34e000
buffer_load_dword v67, v20, s[20:23], s56 offen
s_mov_b32 s56, 0x25c000
buffer_load_dword v68, v20, s[20:23], s56 offen
s_mov_b32 s56, 0x25e000
buffer_load_dword v69, v20, s[20:23], s56 offen
s_mov_b32 s56, 0x35c000
buffer_load_dword v70, v20, s[20:23], s56 offen
s_mov_b32 s56, 0x35e000
buffer_load_dword v71, v20, s[20:23], s56 offen
s_barrier
s_waitcnt vmcnt(49)
v_perm_b32 v224, v25, v24, s70
v_accvgpr_write_b32 a160, v224
v_perm_b32 v224, v27, v26, s70
v_accvgpr_write_b32 a161, v224
v_perm_b32 v224, v29, v28, s70
v_accvgpr_write_b32 a162, v224
v_perm_b32 v224, v31, v30, s70
v_accvgpr_write_b32 a163, v224
v_perm_b32 v224, v33, v32, s70
v_accvgpr_write_b32 a164, v224
v_perm_b32 v224, v35, v34, s70
v_accvgpr_write_b32 a165, v224
v_perm_b32 v224, v37, v36, s70
v_accvgpr_write_b32 a166, v224
v_perm_b32 v224, v39, v38, s70
v_accvgpr_write_b32 a167, v224
v_perm_b32 v232, v25, v24, s71
v_accvgpr_write_b32 a176, v232
v_perm_b32 v232, v27, v26, s71
v_accvgpr_write_b32 a177, v232
v_perm_b32 v232, v29, v28, s71
v_accvgpr_write_b32 a178, v232
v_perm_b32 v232, v31, v30, s71
v_accvgpr_write_b32 a179, v232
v_perm_b32 v232, v33, v32, s71
v_accvgpr_write_b32 a180, v232
v_perm_b32 v232, v35, v34, s71
v_accvgpr_write_b32 a181, v232
v_perm_b32 v232, v37, v36, s71
v_accvgpr_write_b32 a182, v232
v_perm_b32 v232, v39, v38, s71
v_accvgpr_write_b32 a183, v232
s_cmp_eq_u32 s59, 1
s_cbranch_scc1 L_thr_13
s_waitcnt vmcnt(32)
L_thr_13:
s_mov_b32 s56, 0x0
buffer_load_dword v24, v20, s[24:27], s56 offen
s_mov_b32 s56, 0x2000
buffer_load_dword v25, v20, s[24:27], s56 offen
s_mov_b32 s56, 0x100000
buffer_load_dword v26, v20, s[24:27], s56 offen
s_mov_b32 s56, 0x102000
buffer_load_dword v27, v20, s[24:27], s56 offen
s_mov_b32 s56, 0x10000
buffer_load_dword v28, v20, s[24:27], s56 offen
s_mov_b32 s56, 0x12000
buffer_load_dword v29, v20, s[24:27], s56 offen
s_mov_b32 s56, 0x110000
buffer_load_dword v30, v20, s[24:27], s56 offen
s_mov_b32 s56, 0x112000
buffer_load_dword v31, v20, s[24:27], s56 offen
s_mov_b32 s56, 0x4000
buffer_load_dword v32, v20, s[24:27], s56 offen
s_mov_b32 s56, 0x6000
buffer_load_dword v33, v20, s[24:27], s56 offen
s_mov_b32 s56, 0x104000
buffer_load_dword v34, v20, s[24:27], s56 offen
s_mov_b32 s56, 0x106000
buffer_load_dword v35, v20, s[24:27], s56 offen
s_mov_b32 s56, 0x14000
buffer_load_dword v36, v20, s[24:27], s56 offen
s_mov_b32 s56, 0x16000
buffer_load_dword v37, v20, s[24:27], s56 offen
s_mov_b32 s56, 0x114000
buffer_load_dword v38, v20, s[24:27], s56 offen
s_mov_b32 s56, 0x116000
buffer_load_dword v39, v20, s[24:27], s56 offen
s_barrier
s_waitcnt vmcnt(48)
v_perm_b32 v224, v41, v40, s70
v_accvgpr_write_b32 a192, v224
v_perm_b32 v224, v43, v42, s70
v_accvgpr_write_b32 a193, v224
v_perm_b32 v224, v45, v44, s70
v_accvgpr_write_b32 a194, v224
v_perm_b32 v224, v47, v46, s70
v_accvgpr_write_b32 a195, v224
v_perm_b32 v224, v49, v48, s70
v_accvgpr_write_b32 a196, v224
v_perm_b32 v224, v51, v50, s70
v_accvgpr_write_b32 a197, v224
v_perm_b32 v224, v53, v52, s70
v_accvgpr_write_b32 a198, v224
v_perm_b32 v224, v55, v54, s70
v_accvgpr_write_b32 a199, v224
v_perm_b32 v232, v41, v40, s71
v_accvgpr_write_b32 a208, v232
v_perm_b32 v232, v43, v42, s71
v_accvgpr_write_b32 a209, v232
v_perm_b32 v232, v45, v44, s71
v_accvgpr_write_b32 a210, v232
v_perm_b32 v232, v47, v46, s71
v_accvgpr_write_b32 a211, v232
v_perm_b32 v232, v49, v48, s71
v_accvgpr_write_b32 a212, v232
v_perm_b32 v232, v51, v50, s71
v_accvgpr_write_b32 a213, v232
v_perm_b32 v232, v53, v52, s71
v_accvgpr_write_b32 a214, v232
v_perm_b32 v232, v55, v54, s71
v_accvgpr_write_b32 a215, v232
v_cmp_gt_u32 vcc, 12, v6
s_cbranch_vccz L_rec_clr
s_mov_b32 s57, 0
v_mov_b32 v5, 64
L_wd_14:
global_load_dword v6, v5, s[36:37] sc1
s_add_u32 s57, s57, 1
s_cmp_ge_u32 s57, 524288
s_cbranch_scc1 L_end
s_waitcnt vmcnt(0)
v_cmp_gt_u32 vcc, 12, v6
s_cbranch_vccnz L_wd_14
L_rec_clr:
s_cmp_eq_u32 s59, 1
s_cbranch_scc1 L_thr_15
s_waitcnt vmcnt(32)
L_thr_15:
s_mov_b32 s56, 0x200000
buffer_load_dword v40, v20, s[24:27], s56 offen
s_mov_b32 s56, 0x202000
buffer_load_dword v41, v20, s[24:27], s56 offen
s_mov_b32 s56, 0x300000
buffer_load_dword v42, v20, s[24:27], s56 offen
s_mov_b32 s56, 0x302000
buffer_load_dword v43, v20, s[24:27], s56 offen
s_mov_b32 s56, 0x210000
buffer_load_dword v44, v20, s[24:27], s56 offen
s_mov_b32 s56, 0x212000
buffer_load_dword v45, v20, s[24:27], s56 offen
s_mov_b32 s56, 0x310000
buffer_load_dword v46, v20, s[24:27], s56 offen
s_mov_b32 s56, 0x312000
buffer_load_dword v47, v20, s[24:27], s56 offen
s_mov_b32 s56, 0x204000
buffer_load_dword v48, v20, s[24:27], s56 offen
s_mov_b32 s56, 0x206000
buffer_load_dword v49, v20, s[24:27], s56 offen
s_mov_b32 s56, 0x304000
buffer_load_dword v50, v20, s[24:27], s56 offen
s_mov_b32 s56, 0x306000
buffer_load_dword v51, v20, s[24:27], s56 offen
s_mov_b32 s56, 0x214000
buffer_load_dword v52, v20, s[24:27], s56 offen
s_mov_b32 s56, 0x216000
buffer_load_dword v53, v20, s[24:27], s56 offen
s_mov_b32 s56, 0x314000
buffer_load_dword v54, v20, s[24:27], s56 offen
s_mov_b32 s56, 0x316000
buffer_load_dword v55, v20, s[24:27], s56 offen
s_barrier
s_waitcnt vmcnt(48)
v_perm_b32 v224, v241, v240, s70
v_accvgpr_write_b32 a224, v224
v_perm_b32 v224, v243, v242, s70
v_accvgpr_write_b32 a225, v224
v_perm_b32 v224, v245, v244, s70
v_accvgpr_write_b32 a226, v224
v_perm_b32 v224, v247, v246, s70
v_accvgpr_write_b32 a227, v224
v_perm_b32 v224, v249, v248, s70
v_accvgpr_write_b32 a228, v224
v_perm_b32 v224, v251, v250, s70
v_accvgpr_write_b32 a229, v224
v_perm_b32 v224, v253, v252, s70
v_accvgpr_write_b32 a230, v224
v_perm_b32 v224, v255, v254, s70
v_accvgpr_write_b32 a231, v224
v_perm_b32 v232, v241, v240, s71
v_accvgpr_write_b32 a232, v232
v_perm_b32 v232, v243, v242, s71
v_accvgpr_write_b32 a233, v232
v_perm_b32 v232, v245, v244, s71
v_accvgpr_write_b32 a234, v232
v_perm_b32 v232, v247, v246, s71
v_accvgpr_write_b32 a235, v232
v_perm_b32 v232, v249, v248, s71
v_accvgpr_write_b32 a236, v232
v_perm_b32 v232, v251, v250, s71
v_accvgpr_write_b32 a237, v232
v_perm_b32 v232, v253, v252, s71
v_accvgpr_write_b32 a238, v232
v_perm_b32 v232, v255, v254, s71
v_accvgpr_write_b32 a239, v232
s_getpc_b64 s[56:57]
L_pc2:
s_lshl_b32 s58, s38, 12
s_add_u32 s58, s58, L_steps-L_pc2
v_lshl_add_u32 v22, v0, 7, s58
v_min_u32 v22, L_worker-L_pc2, v22
v_mov_b32 v23, s57
v_add_co_u32 v22, vcc, s56, v22
s_nop 1
v_addc_co_u32 v23, vcc, 0, v23, vcc
global_load_dword v19, v[22:23], off
s_cmp_eq_u32 s59, 1
s_cbranch_scc1 L_thr_16
s_waitcnt vmcnt(32)
L_thr_16:
s_mov_b32 s56, 0x40000
buffer_load_dword v240, v20, s[24:27], s56 offen
s_mov_b32 s56, 0x42000
buffer_load_dword v241, v20, s[24:27], s56 offen
s_mov_b32 s56, 0x140000
buffer_load_dword v242, v20, s[24:27], s56 offen
s_mov_b32 s56, 0x142000
buffer_load_dword v243, v20, s[24:27], s56 offen
s_mov_b32 s56, 0x50000
buffer_load_dword v244, v20, s[24:27], s56 offen
s_mov_b32 s56, 0x52000
buffer_load_dword v245, v20, s[24:27], s56 offen
s_mov_b32 s56, 0x150000
buffer_load_dword v246, v20, s[24:27], s56 offen
s_mov_b32 s56, 0x152000
buffer_load_dword v247, v20, s[24:27], s56 offen
s_mov_b32 s56, 0x44000
buffer_load_dword v248, v20, s[24:27], s56 offen
s_mov_b32 s56, 0x46000
buffer_load_dword v249, v20, s[24:27], s56 offen
s_mov_b32 s56, 0x144000
buffer_load_dword v250, v20, s[24:27], s56 offen
s_mov_b32 s56, 0x146000
buffer_load_dword v251, v20, s[24:27], s56 offen
s_mov_b32 s56, 0x54000
buffer_load_dword v252, v20, s[24:27], s56 offen
s_mov_b32 s56, 0x56000
buffer_load_dword v253, v20, s[24:27], s56 offen
s_mov_b32 s56, 0x154000
buffer_load_dword v254, v20, s[24:27], s56 offen
s_mov_b32 s56, 0x156000
buffer_load_dword v255, v20, s[24:27], s56 offen
s_barrier
s_waitcnt vmcnt(49)
v_perm_b32 v224, v57, v56, s70
v_accvgpr_write_b32 a240, v224
v_perm_b32 v224, v59, v58, s70
v_accvgpr_write_b32 a241, v224
v_perm_b32 v224, v61, v60, s70
v_accvgpr_write_b32 a242, v224
v_perm_b32 v224, v63, v62, s70
v_accvgpr_write_b32 a243, v224
v_perm_b32 v224, v65, v64, s70
v_accvgpr_write_b32 a244, v224
v_perm_b32 v224, v67, v66, s70
v_accvgpr_write_b32 a245, v224
v_perm_b32 v224, v69, v68, s70
v_accvgpr_write_b32 a246, v224
v_perm_b32 v224, v71, v70, s70
v_accvgpr_write_b32 a247, v224
v_perm_b32 v232, v57, v56, s71
v_accvgpr_write_b32 a248, v232
v_perm_b32 v232, v59, v58, s71
v_accvgpr_write_b32 a249, v232
v_perm_b32 v232, v61, v60, s71
v_accvgpr_write_b32 a250, v232
v_perm_b32 v232, v63, v62, s71
v_accvgpr_write_b32 a251, v232
v_perm_b32 v232, v65, v64, s71
v_accvgpr_write_b32 a252, v232
v_perm_b32 v232, v67, v66, s71
v_accvgpr_write_b32 a253, v232
v_perm_b32 v232, v69, v68, s71
v_accvgpr_write_b32 a254, v232
v_perm_b32 v232, v71, v70, s71
v_accvgpr_write_b32 a255, v232
s_cmp_eq_u32 s59, 1
s_cbranch_scc1 L_thr_17
s_waitcnt vmcnt(32)
L_thr_17:
s_mov_b32 s56, 0x240000
buffer_load_dword v56, v20, s[24:27], s56 offen
s_mov_b32 s56, 0x242000
buffer_load_dword v57, v20, s[24:27], s56 offen
s_mov_b32 s56, 0x340000
buffer_load_dword v58, v20, s[24:27], s56 offen
s_mov_b32 s56, 0x342000
buffer_load_dword v59, v20, s[24:27], s56 offen
s_mov_b32 s56, 0x250000
buffer_load_dword v60, v20, s[24:27], s56 offen
s_mov_b32 s56, 0x252000
buffer_load_dword v61, v20, s[24:27], s56 offen
s_mov_b32 s56, 0x350000
buffer_load_dword v62, v20, s[24:27], s56 offen
s_mov_b32 s56, 0x352000
buffer_load_dword v63, v20, s[24:27], s56 offen
s_mov_b32 s56, 0x244000
buffer_load_dword v64, v20, s[24:27], s56 offen
s_mov_b32 s56, 0x246000
buffer_load_dword v65, v20, s[24:27], s56 offen
s_mov_b32 s56, 0x344000
buffer_load_dword v66, v20, s[24:27], s56 offen
s_mov_b32 s56, 0x346000
buffer_load_dword v67, v20, s[24:27], s56 offen
s_mov_b32 s56, 0x254000
buffer_load_dword v68, v20, s[24:27], s56 offen
s_mov_b32 s56, 0x256000
buffer_load_dword v69, v20, s[24:27], s56 offen
s_mov_b32 s56, 0x354000
buffer_load_dword v70, v20, s[24:27], s56 offen
s_mov_b32 s56, 0x356000
buffer_load_dword v71, v20, s[24:27], s56 offen
s_barrier
s_waitcnt vmcnt(49)
v_perm_b32 v224, v25, v24, s70
v_accvgpr_write_b32 a16, v224
v_perm_b32 v224, v27, v26, s70
v_accvgpr_write_b32 a17, v224
v_perm_b32 v224, v29, v28, s70
v_accvgpr_write_b32 a18, v224
v_perm_b32 v224, v31, v30, s70
v_accvgpr_write_b32 a19, v224
v_perm_b32 v224, v33, v32, s70
v_accvgpr_write_b32 a20, v224
v_perm_b32 v224, v35, v34, s70
v_accvgpr_write_b32 a21, v224
v_perm_b32 v224, v37, v36, s70
v_accvgpr_write_b32 a22, v224
v_perm_b32 v224, v39, v38, s70
v_accvgpr_write_b32 a23, v224
v_perm_b32 v232, v25, v24, s71
v_accvgpr_write_b32 a32, v232
v_perm_b32 v232, v27, v26, s71
v_accvgpr_write_b32 a33, v232
v_perm_b32 v232, v29, v28, s71
v_accvgpr_write_b32 a34, v232
v_perm_b32 v232, v31, v30, s71
v_accvgpr_write_b32 a35, v232
v_perm_b32 v232, v33, v32, s71
v_accvgpr_write_b32 a36, v232
v_perm_b32 v232, v35, v34, s71
v_accvgpr_write_b32 a37, v232
v_perm_b32 v232, v37, v36, s71
v_accvgpr_write_b32 a38, v232
v_perm_b32 v232, v39, v38, s71
v_accvgpr_write_b32 a39, v232
s_cmp_eq_u32 s59, 1
s_cbranch_scc1 L_thr_18
s_waitcnt vmcnt(32)
L_thr_18:
s_mov_b32 s56, 0x8000
buffer_load_dword v24, v20, s[24:27], s56 offen
s_mov_b32 s56, 0xa000
buffer_load_dword v25, v20, s[24:27], s56 offen
s_mov_b32 s56, 0x108000
buffer_load_dword v26, v20, s[24:27], s56 offen
s_mov_b32 s56, 0x10a000
buffer_load_dword v27, v20, s[24:27], s56 offen
s_mov_b32 s56, 0x18000
buffer_load_dword v28, v20, s[24:27], s56 offen
s_mov_b32 s56, 0x1a000
buffer_load_dword v29, v20, s[24:27], s56 offen
s_mov_b32 s56, 0x118000
buffer_load_dword v30, v20, s[24:27], s56 offen
s_mov_b32 s56, 0x11a000
buffer_load_dword v31, v20, s[24:27], s56 offen
s_mov_b32 s56, 0xc000
buffer_load_dword v32, v20, s[24:27], s56 offen
s_mov_b32 s56, 0xe000
buffer_load_dword v33, v20, s[24:27], s56 offen
s_mov_b32 s56, 0x10c000
buffer_load_dword v34, v20, s[24:27], s56 offen
s_mov_b32 s56, 0x10e000
buffer_load_dword v35, v20, s[24:27], s56 offen
s_mov_b32 s56, 0x1c000
buffer_load_dword v36, v20, s[24:27], s56 offen
s_mov_b32 s56, 0x1e000
buffer_load_dword v37, v20, s[24:27], s56 offen
s_mov_b32 s56, 0x11c000
buffer_load_dword v38, v20, s[24:27], s56 offen
s_mov_b32 s56, 0x11e000
buffer_load_dword v39, v20, s[24:27], s56 offen
s_barrier
s_waitcnt vmcnt(49)
v_perm_b32 v224, v41, v40, s70
v_accvgpr_write_b32 a56, v224
v_perm_b32 v224, v43, v42, s70
v_accvgpr_write_b32 a57, v224
v_perm_b32 v224, v45, v44, s70
v_accvgpr_write_b32 a58, v224
v_perm_b32 v224, v47, v46, s70
v_accvgpr_write_b32 a59, v224
v_perm_b32 v224, v49, v48, s70
v_accvgpr_write_b32 a60, v224
v_perm_b32 v224, v51, v50, s70
v_accvgpr_write_b32 a61, v224
v_perm_b32 v224, v53, v52, s70
v_accvgpr_write_b32 a62, v224
v_perm_b32 v224, v55, v54, s70
v_accvgpr_write_b32 a63, v224
v_perm_b32 v232, v41, v40, s71
v_accvgpr_write_b32 a72, v232
v_perm_b32 v232, v43, v42, s71
v_accvgpr_write_b32 a73, v232
v_perm_b32 v232, v45, v44, s71
v_accvgpr_write_b32 a74, v232
v_perm_b32 v232, v47, v46, s71
v_accvgpr_write_b32 a75, v232
v_perm_b32 v232, v49, v48, s71
v_accvgpr_write_b32 a76, v232
v_perm_b32 v232, v51, v50, s71
v_accvgpr_write_b32 a77, v232
v_perm_b32 v232, v53, v52, s71
v_accvgpr_write_b32 a78, v232
v_perm_b32 v232, v55, v54, s71
v_accvgpr_write_b32 a79, v232
s_cmp_eq_u32 s59, 1
s_cbranch_scc1 L_thr_19
s_waitcnt vmcnt(32)
L_thr_19:
s_mov_b32 s56, 0x208000
buffer_load_dword v40, v20, s[24:27], s56 offen
s_mov_b32 s56, 0x20a000
buffer_load_dword v41, v20, s[24:27], s56 offen
s_mov_b32 s56, 0x308000
buffer_load_dword v42, v20, s[24:27], s56 offen
s_mov_b32 s56, 0x30a000
buffer_load_dword v43, v20, s[24:27], s56 offen
s_mov_b32 s56, 0x218000
buffer_load_dword v44, v20, s[24:27], s56 offen
s_mov_b32 s56, 0x21a000
buffer_load_dword v45, v20, s[24:27], s56 offen
s_mov_b32 s56, 0x318000
buffer_load_dword v46, v20, s[24:27], s56 offen
s_mov_b32 s56, 0x31a000
buffer_load_dword v47, v20, s[24:27], s56 offen
s_mov_b32 s56, 0x20c000
buffer_load_dword v48, v20, s[24:27], s56 offen
s_mov_b32 s56, 0x20e000
buffer_load_dword v49, v20, s[24:27], s56 offen
s_mov_b32 s56, 0x30c000
buffer_load_dword v50, v20, s[24:27], s56 offen
s_mov_b32 s56, 0x30e000
buffer_load_dword v51, v20, s[24:27], s56 offen
s_mov_b32 s56, 0x21c000
buffer_load_dword v52, v20, s[24:27], s56 offen
s_mov_b32 s56, 0x21e000
buffer_load_dword v53, v20, s[24:27], s56 offen
s_mov_b32 s56, 0x31c000
buffer_load_dword v54, v20, s[24:27], s56 offen
s_mov_b32 s56, 0x31e000
buffer_load_dword v55, v20, s[24:27], s56 offen
s_barrier
s_waitcnt vmcnt(48)
v_perm_b32 v224, v241, v240, s70
v_accvgpr_write_b32 a96, v224
v_perm_b32 v224, v243, v242, s70
v_accvgpr_write_b32 a97, v224
v_perm_b32 v224, v245, v244, s70
v_accvgpr_write_b32 a98, v224
v_perm_b32 v224, v247, v246, s70
v_accvgpr_write_b32 a99, v224
v_perm_b32 v224, v249, v248, s70
v_accvgpr_write_b32 a100, v224
v_perm_b32 v224, v251, v250, s70
v_accvgpr_write_b32 a101, v224
v_perm_b32 v224, v253, v252, s70
v_accvgpr_write_b32 a102, v224
v_perm_b32 v224, v255, v254, s70
v_accvgpr_write_b32 a103, v224
v_perm_b32 v232, v241, v240, s71
v_accvgpr_write_b32 a112, v232
v_perm_b32 v232, v243, v242, s71
v_accvgpr_write_b32 a113, v232
v_perm_b32 v232, v245, v244, s71
v_accvgpr_write_b32 a114, v232
v_perm_b32 v232, v247, v246, s71
v_accvgpr_write_b32 a115, v232
v_perm_b32 v232, v249, v248, s71
v_accvgpr_write_b32 a116, v232
v_perm_b32 v232, v251, v250, s71
v_accvgpr_write_b32 a117, v232
v_perm_b32 v232, v253, v252, s71
v_accvgpr_write_b32 a118, v232
v_perm_b32 v232, v255, v254, s71
v_accvgpr_write_b32 a119, v232
s_cmp_eq_u32 s59, 1
s_cbranch_scc1 L_thr_20
s_waitcnt vmcnt(32)
L_thr_20:
s_mov_b32 s56, 0x48000
buffer_load_dword v240, v20, s[24:27], s56 offen
s_mov_b32 s56, 0x4a000
buffer_load_dword v241, v20, s[24:27], s56 offen
s_mov_b32 s56, 0x148000
buffer_load_dword v242, v20, s[24:27], s56 offen
s_mov_b32 s56, 0x14a000
buffer_load_dword v243, v20, s[24:27], s56 offen
s_mov_b32 s56, 0x58000
buffer_load_dword v244, v20, s[24:27], s56 offen
s_mov_b32 s56, 0x5a000
buffer_load_dword v245, v20, s[24:27], s56 offen
s_mov_b32 s56, 0x158000
buffer_load_dword v246, v20, s[24:27], s56 offen
s_mov_b32 s56, 0x15a000
buffer_load_dword v247, v20, s[24:27], s56 offen
s_mov_b32 s56, 0x4c000
buffer_load_dword v248, v20, s[24:27], s56 offen
s_mov_b32 s56, 0x4e000
buffer_load_dword v249, v20, s[24:27], s56 offen
s_mov_b32 s56, 0x14c000
buffer_load_dword v250, v20, s[24:27], s56 offen
s_mov_b32 s56, 0x14e000
buffer_load_dword v251, v20, s[24:27], s56 offen
s_mov_b32 s56, 0x5c000
buffer_load_dword v252, v20, s[24:27], s56 offen
s_mov_b32 s56, 0x5e000
buffer_load_dword v253, v20, s[24:27], s56 offen
s_mov_b32 s56, 0x15c000
buffer_load_dword v254, v20, s[24:27], s56 offen
s_mov_b32 s56, 0x15e000
buffer_load_dword v255, v20, s[24:27], s56 offen
s_barrier
s_waitcnt vmcnt(48)
v_perm_b32 v224, v57, v56, s70
v_accvgpr_write_b32 a136, v224
v_perm_b32 v224, v59, v58, s70
v_accvgpr_write_b32 a137, v224
v_perm_b32 v224, v61, v60, s70
v_accvgpr_write_b32 a138, v224
v_perm_b32 v224, v63, v62, s70
v_accvgpr_write_b32 a139, v224
v_perm_b32 v224, v65, v64, s70
v_accvgpr_write_b32 a140, v224
v_perm_b32 v224, v67, v66, s70
v_accvgpr_write_b32 a141, v224
v_perm_b32 v224, v69, v68, s70
v_accvgpr_write_b32 a142, v224
v_perm_b32 v224, v71, v70, s70
v_accvgpr_write_b32 a143, v224
v_perm_b32 v232, v57, v56, s71
v_accvgpr_write_b32 a152, v232
v_perm_b32 v232, v59, v58, s71
v_accvgpr_write_b32 a153, v232
v_perm_b32 v232, v61, v60, s71
v_accvgpr_write_b32 a154, v232
v_perm_b32 v232, v63, v62, s71
v_accvgpr_write_b32 a155, v232
v_perm_b32 v232, v65, v64, s71
v_accvgpr_write_b32 a156, v232
v_perm_b32 v232, v67, v66, s71
v_accvgpr_write_b32 a157, v232
v_perm_b32 v232, v69, v68, s71
v_accvgpr_write_b32 a158, v232
v_perm_b32 v232, v71, v70, s71
v_accvgpr_write_b32 a159, v232
s_cmp_eq_u32 s59, 1
s_cbranch_scc1 L_thr_21
s_waitcnt vmcnt(32)
L_thr_21:
s_mov_b32 s56, 0x248000
buffer_load_dword v56, v20, s[24:27], s56 offen
s_mov_b32 s56, 0x24a000
buffer_load_dword v57, v20, s[24:27], s56 offen
s_mov_b32 s56, 0x348000
buffer_load_dword v58, v20, s[24:27], s56 offen
s_mov_b32 s56, 0x34a000
buffer_load_dword v59, v20, s[24:27], s56 offen
s_mov_b32 s56, 0x258000
buffer_load_dword v60, v20, s[24:27], s56 offen
s_mov_b32 s56, 0x25a000
buffer_load_dword v61, v20, s[24:27], s56 offen
s_mov_b32 s56, 0x358000
buffer_load_dword v62, v20, s[24:27], s56 offen
s_mov_b32 s56, 0x35a000
buffer_load_dword v63, v20, s[24:27], s56 offen
s_mov_b32 s56, 0x24c000
buffer_load_dword v64, v20, s[24:27], s56 offen
s_mov_b32 s56, 0x24e000
buffer_load_dword v65, v20, s[24:27], s56 offen
s_mov_b32 s56, 0x34c000
buffer_load_dword v66, v20, s[24:27], s56 offen
s_mov_b32 s56, 0x34e000
buffer_load_dword v67, v20, s[24:27], s56 offen
s_mov_b32 s56, 0x25c000
buffer_load_dword v68, v20, s[24:27], s56 offen
s_mov_b32 s56, 0x25e000
buffer_load_dword v69, v20, s[24:27], s56 offen
s_mov_b32 s56, 0x35c000
buffer_load_dword v70, v20, s[24:27], s56 offen
s_mov_b32 s56, 0x35e000
buffer_load_dword v71, v20, s[24:27], s56 offen
s_barrier
s_waitcnt vmcnt(48)
v_perm_b32 v224, v25, v24, s70
v_accvgpr_write_b32 a168, v224
v_perm_b32 v224, v27, v26, s70
v_accvgpr_write_b32 a169, v224
v_perm_b32 v224, v29, v28, s70
v_accvgpr_write_b32 a170, v224
v_perm_b32 v224, v31, v30, s70
v_accvgpr_write_b32 a171, v224
v_perm_b32 v224, v33, v32, s70
v_accvgpr_write_b32 a172, v224
v_perm_b32 v224, v35, v34, s70
v_accvgpr_write_b32 a173, v224
v_perm_b32 v224, v37, v36, s70
v_accvgpr_write_b32 a174, v224
v_perm_b32 v224, v39, v38, s70
v_accvgpr_write_b32 a175, v224
v_perm_b32 v232, v25, v24, s71
v_accvgpr_write_b32 a184, v232
v_perm_b32 v232, v27, v26, s71
v_accvgpr_write_b32 a185, v232
v_perm_b32 v232, v29, v28, s71
v_accvgpr_write_b32 a186, v232
v_perm_b32 v232, v31, v30, s71
v_accvgpr_write_b32 a187, v232
v_perm_b32 v232, v33, v32, s71
v_accvgpr_write_b32 a188, v232
v_perm_b32 v232, v35, v34, s71
v_accvgpr_write_b32 a189, v232
v_perm_b32 v232, v37, v36, s71
v_accvgpr_write_b32 a190, v232
v_perm_b32 v232, v39, v38, s71
v_accvgpr_write_b32 a191, v232
s_barrier
s_waitcnt vmcnt(32)
v_perm_b32 v224, v41, v40, s70
v_accvgpr_write_b32 a200, v224
v_perm_b32 v224, v43, v42, s70
v_accvgpr_write_b32 a201, v224
v_perm_b32 v224, v45, v44, s70
v_accvgpr_write_b32 a202, v224
v_perm_b32 v224, v47, v46, s70
v_accvgpr_write_b32 a203, v224
v_perm_b32 v224, v49, v48, s70
v_accvgpr_write_b32 a204, v224
v_perm_b32 v224, v51, v50, s70
v_accvgpr_write_b32 a205, v224
v_perm_b32 v224, v53, v52, s70
v_accvgpr_write_b32 a206, v224
v_perm_b32 v224, v55, v54, s70
v_accvgpr_write_b32 a207, v224
v_perm_b32 v232, v41, v40, s71
v_accvgpr_write_b32 a216, v232
v_perm_b32 v232, v43, v42, s71
v_accvgpr_write_b32 a217, v232
v_perm_b32 v232, v45, v44, s71
v_accvgpr_write_b32 a218, v232
v_perm_b32 v232, v47, v46, s71
v_accvgpr_write_b32 a219, v232
v_perm_b32 v232, v49, v48, s71
v_accvgpr_write_b32 a220, v232
v_perm_b32 v232, v51, v50, s71
v_accvgpr_write_b32 a221, v232
v_perm_b32 v232, v53, v52, s71
v_accvgpr_write_b32 a222, v232
v_perm_b32 v232, v55, v54, s71
v_accvgpr_write_b32 a223, v232
s_barrier
s_lshr_b32 s56, s50, 8
s_add_u32 s56, s56, s38
s_and_b32 s56, s56, 3
s_cmp_eq_u32 s56, 1
s_cbranch_scc1 L_tho_22
s_waitcnt vmcnt(16)
L_tho_22:
s_mov_b32 s56, 0x8000
buffer_load_dwordx4 v[24:27], v21, s[28:31], s56 offen
s_mov_b32 s56, 0x8800
buffer_load_dwordx4 v[28:31], v21, s[28:31], s56 offen
s_mov_b32 s56, 0x9000
buffer_load_dwordx4 v[32:35], v21, s[28:31], s56 offen
s_mov_b32 s56, 0x9800
buffer_load_dwordx4 v[36:39], v21, s[28:31], s56 offen
s_mov_b32 s56, 0xc000
buffer_load_dwordx4 v[40:43], v21, s[28:31], s56 offen
s_mov_b32 s56, 0xc800
buffer_load_dwordx4 v[44:47], v21, s[28:31], s56 offen
s_mov_b32 s56, 0xd000
buffer_load_dwordx4 v[48:51], v21, s[28:31], s56 offen
s_mov_b32 s56, 0xd800
buffer_load_dwordx4 v[52:55], v21, s[28:31], s56 offen
v_lshrrev_b32 v16, 4, v98
v_and_b32 v17, 7, v16
v_lshlrev_b32 v17, 10, v17
v_bfe_u32 v18, v16, 3, 1
v_lshl_add_u32 v17, v18, 8, v17
v_bfe_u32 v18, v16, 4, 1
v_lshl_add_u32 v17, v18, 7, v17
v_bfe_u32 v18, v16, 5, 1
v_lshl_add_u32 v17, v18, 2, v17
s_and_b32 s56, s38, 1
s_lshl_b32 s56, s56, 6
s_lshr_b32 s58, s38, 1
s_lshl_b32 s58, s58, 3
s_add_u32 s56, s56, s58
buffer_load_dword v216, v17, s[32:35], s56 offen offset:0
buffer_load_dword v217, v17, s[32:35], s56 offen offset:16
buffer_load_dword v218, v17, s[32:35], s56 offen offset:32
buffer_load_dword v219, v17, s[32:35], s56 offen offset:48
buffer_load_dword v220, v17, s[32:35], s56 offen offset:512
buffer_load_dword v221, v17, s[32:35], s56 offen offset:528
buffer_load_dword v222, v17, s[32:35], s56 offen offset:544
buffer_load_dword v223, v17, s[32:35], s56 offen offset:560
s_waitcnt vmcnt(32)
v_perm_b32 v224, v241, v240, s70
v_perm_b32 v225, v243, v242, s70
v_perm_b32 v226, v245, v244, s70
v_perm_b32 v227, v247, v246, s70
v_perm_b32 v228, v249, v248, s70
v_perm_b32 v229, v251, v250, s70
v_perm_b32 v230, v253, v252, s70
v_perm_b32 v231, v255, v254, s70
ds_write_b128 v99, v[224:227] offset:14336
ds_write_b128 v99, v[228:231] offset:15360
s_waitcnt lgkmcnt(0)
v_perm_b32 v232, v241, v240, s71
v_perm_b32 v233, v243, v242, s71
v_perm_b32 v234, v245, v244, s71
v_perm_b32 v235, v247, v246, s71
v_perm_b32 v236, v249, v248, s71
v_perm_b32 v237, v251, v250, s71
v_perm_b32 v238, v253, v252, s71
v_perm_b32 v239, v255, v254, s71
ds_write_b128 v99, v[232:235] offset:16384
ds_write_b128 v99, v[236:239] offset:17408
s_waitcnt lgkmcnt(0)
s_lshr_b32 s56, s50, 8
s_add_u32 s56, s56, s38
s_and_b32 s56, s56, 3
s_cmp_eq_u32 s56, 1
s_cbranch_scc1 L_tho_23
s_waitcnt vmcnt(16)
L_tho_23:
s_mov_b32 s56, 0x0
buffer_load_dwordx4 v[0:3], v21, s[28:31], s56 offen
s_mov_b32 s56, 0x800
buffer_load_dwordx4 v[4:7], v21, s[28:31], s56 offen
s_mov_b32 s56, 0x1000
buffer_load_dwordx4 v[8:11], v21, s[28:31], s56 offen
s_mov_b32 s56, 0x1800
buffer_load_dwordx4 v[12:15], v21, s[28:31], s56 offen
s_mov_b32 s56, 0x4000
buffer_load_dwordx4 v[240:243], v21, s[28:31], s56 offen
s_mov_b32 s56, 0x4800
buffer_load_dwordx4 v[244:247], v21, s[28:31], s56 offen
s_mov_b32 s56, 0x5000
buffer_load_dwordx4 v[248:251], v21, s[28:31], s56 offen
s_mov_b32 s56, 0x5800
buffer_load_dwordx4 v[252:255], v21, s[28:31], s56 offen
s_waitcnt vmcnt(24)
v_perm_b32 v224, v57, v56, s70
v_perm_b32 v225, v59, v58, s70
v_perm_b32 v226, v61, v60, s70
v_perm_b32 v227, v63, v62, s70
v_perm_b32 v228, v65, v64, s70
v_perm_b32 v229, v67, v66, s70
v_perm_b32 v230, v69, v68, s70
v_perm_b32 v231, v71, v70, s70
ds_write_b128 v99, v[224:227] offset:20480
ds_write_b128 v99, v[228:231] offset:21504
s_waitcnt lgkmcnt(0)
v_perm_b32 v232, v57, v56, s71
v_perm_b32 v233, v59, v58, s71
v_perm_b32 v234, v61, v60, s71
v_perm_b32 v235, v63, v62, s71
v_perm_b32 v236, v65, v64, s71
v_perm_b32 v237, v67, v66, s71
v_perm_b32 v238, v69, v68, s71
v_perm_b32 v239, v71, v70, s71
ds_write_b128 v99, v[232:235] offset:22528
ds_write_b128 v99, v[236:239] offset:23552
s_waitcnt lgkmcnt(0)
v_mov_b32 v16, 132
global_load_dwordx2 v[16:17], v16, s[36:37] sc1
buffer_load_dword v108, v105, s[4:7], 0 offen offset:1024 sc1
s_waitcnt vmcnt(18)
v_perm_b32 v224, v28, v24, s70
v_perm_b32 v225, v29, v25, s70
v_perm_b32 v226, v36, v32, s70
v_perm_b32 v227, v37, v33, s70
v_perm_b32 v228, v44, v40, s70
v_perm_b32 v229, v45, v41, s70
v_perm_b32 v230, v52, v48, s70
v_perm_b32 v231, v53, v49, s70
ds_write_b128 v99, v[224:227] offset:26624
ds_write_b128 v99, v[228:231] offset:27648
v_perm_b32 v152, v28, v24, s71
v_perm_b32 v153, v29, v25, s71
v_perm_b32 v154, v36, v32, s71
v_perm_b32 v155, v37, v33, s71
v_perm_b32 v156, v44, v40, s71
v_perm_b32 v157, v45, v41, s71
v_perm_b32 v158, v52, v48, s71
v_perm_b32 v159, v53, v49, s71
v_perm_b32 v184, v30, v26, s70
v_perm_b32 v185, v31, v27, s70
v_perm_b32 v186, v38, v34, s70
v_perm_b32 v187, v39, v35, s70
v_perm_b32 v188, v46, v42, s70
v_perm_b32 v189, v47, v43, s70
v_perm_b32 v190, v54, v50, s70
v_perm_b32 v191, v55, v51, s70
v_perm_b32 v232, v30, v26, s71
v_perm_b32 v233, v31, v27, s71
v_perm_b32 v234, v38, v34, s71
v_perm_b32 v235, v39, v35, s71
v_perm_b32 v236, v46, v42, s71
v_perm_b32 v237, v47, v43, s71
v_perm_b32 v238, v54, v50, s71
v_perm_b32 v239, v55, v51, s71
ds_write_b128 v99, v[232:235] offset:32768
ds_write_b128 v99, v[236:239] offset:33792
s_lshr_b32 s56, s50, 8
s_add_u32 s56, s56, s38
s_and_b32 s56, s56, 3
s_cmp_eq_u32 s56, 1
s_cbranch_scc1 L_tho_24
s_waitcnt vmcnt(16)
L_tho_24:
s_mov_b32 s56, 0x18000
buffer_load_dwordx4 v[24:27], v21, s[28:31], s56 offen
s_mov_b32 s56, 0x18800
buffer_load_dwordx4 v[28:31], v21, s[28:31], s56 offen
s_mov_b32 s56, 0x19000
buffer_load_dwordx4 v[32:35], v21, s[28:31], s56 offen
s_mov_b32 s56, 0x19800
buffer_load_dwordx4 v[36:39], v21, s[28:31], s56 offen
s_mov_b32 s56, 0x1c000
buffer_load_dwordx4 v[40:43], v21, s[28:31], s56 offen
s_mov_b32 s56, 0x1c800
buffer_load_dwordx4 v[44:47], v21, s[28:31], s56 offen
s_mov_b32 s56, 0x1d000
buffer_load_dwordx4 v[48:51], v21, s[28:31], s56 offen
s_mov_b32 s56, 0x1d800
buffer_load_dwordx4 v[52:55], v21, s[28:31], s56 offen
s_waitcnt vmcnt(10)
v_perm_b32 v224, v4, v0, s70
v_perm_b32 v225, v5, v1, s70
v_perm_b32 v226, v12, v8, s70
v_perm_b32 v227, v13, v9, s70
v_perm_b32 v228, v244, v240, s70
v_perm_b32 v229, v245, v241, s70
v_perm_b32 v230, v252, v248, s70
v_perm_b32 v231, v253, v249, s70
ds_write_b128 v99, v[224:227] offset:24576
ds_write_b128 v99, v[228:231] offset:25600
v_perm_b32 v144, v4, v0, s71
v_perm_b32 v145, v5, v1, s71
v_perm_b32 v146, v12, v8, s71
v_perm_b32 v147, v13, v9, s71
v_perm_b32 v148, v244, v240, s71
v_perm_b32 v149, v245, v241, s71
v_perm_b32 v150, v252, v248, s71
v_perm_b32 v151, v253, v249, s71
v_perm_b32 v176, v6, v2, s70
v_perm_b32 v177, v7, v3, s70
v_perm_b32 v178, v14, v10, s70
v_perm_b32 v179, v15, v11, s70
v_perm_b32 v180, v246, v242, s70
v_perm_b32 v181, v247, v243, s70
v_perm_b32 v182, v254, v250, s70
v_perm_b32 v183, v255, v251, s70
v_perm_b32 v208, v6, v2, s71
v_perm_b32 v209, v7, v3, s71
v_perm_b32 v210, v14, v10, s71
v_perm_b32 v211, v15, v11, s71
v_perm_b32 v212, v246, v242, s71
v_perm_b32 v213, v247, v243, s71
v_perm_b32 v214, v254, v250, s71
v_perm_b32 v215, v255, v251, s71
s_lshr_b32 s56, s50, 8
s_add_u32 s56, s56, s38
s_and_b32 s56, s56, 3
s_cmp_eq_u32 s56, 1
s_cbranch_scc1 L_tho_25
s_waitcnt vmcnt(16)
L_tho_25:
s_mov_b32 s56, 0x10000
buffer_load_dwordx4 v[0:3], v21, s[28:31], s56 offen
s_mov_b32 s56, 0x10800
buffer_load_dwordx4 v[4:7], v21, s[28:31], s56 offen
s_mov_b32 s56, 0x11000
buffer_load_dwordx4 v[8:11], v21, s[28:31], s56 offen
s_mov_b32 s56, 0x11800
buffer_load_dwordx4 v[12:15], v21, s[28:31], s56 offen
s_mov_b32 s56, 0x14000
buffer_load_dwordx4 v[240:243], v21, s[28:31], s56 offen
s_mov_b32 s56, 0x14800
buffer_load_dwordx4 v[244:247], v21, s[28:31], s56 offen
s_mov_b32 s56, 0x15000
buffer_load_dwordx4 v[248:251], v21, s[28:31], s56 offen
s_mov_b32 s56, 0x15800
buffer_load_dwordx4 v[252:255], v21, s[28:31], s56 offen
s_waitcnt vmcnt(16)
v_cmp_gt_u32 vcc, 128, v16
v_cmp_ge_u32 s[56:57], 1, v108
s_or_b64 vcc, vcc, s[56:57]
s_cbranch_vccz L_rec_go
s_mov_b32 s57, 0
v_mov_b32 v16, 132
L_wd_26:
global_load_dword v17, v16, s[36:37] sc1
s_add_u32 s57, s57, 1
s_cmp_ge_u32 s57, 524288
s_cbranch_scc1 L_end
s_waitcnt vmcnt(0)
v_cmp_gt_u32 vcc, 128, v17
s_cbranch_vccnz L_wd_26
v_mov_b32 v16, 136
global_load_dword v17, v16, s[36:37] sc1
s_mov_b32 s57, 0
L_wf_27:
buffer_load_dword v108, v105, s[4:7], 0 offen offset:1024 sc1
s_add_u32 s57, s57, 1
s_cmp_ge_u32 s57, 524288
s_cbranch_scc1 L_end
s_waitcnt vmcnt(0)
v_cmp_ge_u32 vcc, 1, v108
s_cbranch_vccnz L_wf_27
L_rec_go:
v_readfirstlane_b32 s69, v17
s_add_u32 s75, s64, 16777216
buffer_load_dwordx4 v[56:59], v102, s[4:7], s64 offen offset:0 sc1
buffer_load_dwordx4 v[60:63], v102, s[4:7], s64 offen offset:1024 sc1
buffer_load_dwordx4 v[64:67], v102, s[4:7], s75 offen offset:0 sc1
buffer_load_dwordx4 v[68:71], v102, s[4:7], s75 offen offset:1024 sc1
s_xor_b32 s56, s62, 0x40000
s_mov_b32 s58, 4202496
buffer_load_dwordx4 v[72:75], v98, s[4:7], s62 offen offset:0 sc1
buffer_load_dwordx4 v[72:75], v98, s[4:7], s62 offen offset:1024 sc1
buffer_load_dwordx4 v[72:75], v98, s[4:7], s56 offen offset:0 sc1
buffer_load_dwordx4 v[72:75], v98, s[4:7], s56 offen offset:1024 sc1
buffer_load_dwordx4 v[72:75], v102, s[4:7], s58 offen offset:0 sc1
buffer_load_dwordx4 v[72:75], v102, s[4:7], s58 offen offset:1024 sc1
buffer_load_dwordx4 v[72:75], v102, s[4:7], s63 offen offset:0 sc1
buffer_load_dwordx4 v[72:75], v102, s[4:7], s63 offen offset:1024 sc1
s_waitcnt vmcnt(20)
v_perm_b32 v224, v28, v24, s70
v_perm_b32 v225, v29, v25, s70
v_perm_b32 v226, v36, v32, s70
v_perm_b32 v227, v37, v33, s70
v_perm_b32 v228, v44, v40, s70
v_perm_b32 v229, v45, v41, s70
v_perm_b32 v230, v52, v48, s70
v_perm_b32 v231, v53, v49, s70
ds_write_b128 v99, v[224:227] offset:30720
ds_write_b128 v99, v[228:231] offset:31744
v_perm_b32 v168, v28, v24, s71
v_perm_b32 v169, v29, v25, s71
v_perm_b32 v170, v36, v32, s71
v_perm_b32 v171, v37, v33, s71
v_perm_b32 v172, v44, v40, s71
v_perm_b32 v173, v45, v41, s71
v_perm_b32 v174, v52, v48, s71
v_perm_b32 v175, v53, v49, s71
v_perm_b32 v200, v30, v26, s70
v_perm_b32 v201, v31, v27, s70
v_perm_b32 v202, v38, v34, s70
v_perm_b32 v203, v39, v35, s70
v_perm_b32 v204, v46, v42, s70
v_perm_b32 v205, v47, v43, s70
v_perm_b32 v206, v54, v50, s70
v_perm_b32 v207, v55, v51, s70
v_perm_b32 v232, v30, v26, s71
v_perm_b32 v233, v31, v27, s71
v_perm_b32 v234, v38, v34, s71
v_perm_b32 v235, v39, v35, s71
v_perm_b32 v236, v46, v42, s71
v_perm_b32 v237, v47, v43, s71
v_perm_b32 v238, v54, v50, s71
v_perm_b32 v239, v55, v51, s71
ds_write_b128 v99, v[232:235] offset:36864
ds_write_b128 v99, v[236:239] offset:37888
s_waitcnt vmcnt(12)
v_perm_b32 v224, v4, v0, s70
v_perm_b32 v225, v5, v1, s70
v_perm_b32 v226, v12, v8, s70
v_perm_b32 v227, v13, v9, s70
v_perm_b32 v228, v244, v240, s70
v_perm_b32 v229, v245, v241, s70
v_perm_b32 v230, v252, v248, s70
v_perm_b32 v231, v253, v249, s70
ds_write_b128 v99, v[224:227] offset:28672
ds_write_b128 v99, v[228:231] offset:29696
v_perm_b32 v160, v4, v0, s71
v_perm_b32 v161, v5, v1, s71
v_perm_b32 v162, v12, v8, s71
v_perm_b32 v163, v13, v9, s71
v_perm_b32 v164, v244, v240, s71
v_perm_b32 v165, v245, v241, s71
v_perm_b32 v166, v252, v248, s71
v_perm_b32 v167, v253, v249, s71
v_perm_b32 v192, v6, v2, s70
v_perm_b32 v193, v7, v3, s70
v_perm_b32 v194, v14, v10, s70
v_perm_b32 v195, v15, v11, s70
v_perm_b32 v196, v246, v242, s70
v_perm_b32 v197, v247, v243, s70
v_perm_b32 v198, v254, v250, s70
v_perm_b32 v199, v255, v251, s70
v_perm_b32 v232, v6, v2, s71
v_perm_b32 v233, v7, v3, s71
v_perm_b32 v234, v14, v10, s71
v_perm_b32 v235, v15, v11, s71
v_perm_b32 v236, v246, v242, s71
v_perm_b32 v237, v247, v243, s71
v_perm_b32 v238, v254, v250, s71
v_perm_b32 v239, v255, v251, s71
ds_write_b128 v99, v[232:235] offset:34816
ds_write_b128 v99, v[236:239] offset:35840
v_lshlrev_b32 v79, 3, v98
ds_read_b128 v[224:227], v99 offset:0
ds_read_b128 v[228:231], v99 offset:1024
ds_read_b128 v[232:235], v99 offset:2048
ds_read_b128 v[236:239], v99 offset:3072
ds_read_b128 v[240:243], v99 offset:4096
ds_read_b128 v[244:247], v99 offset:5120
ds_read_b128 v[248:251], v99 offset:6144
ds_read_b128 v[252:255], v99 offset:7168
v_mov_b64 v[32:33], 0
v_mov_b64 v[34:35], 0
v_mov_b64 v[36:37], 0
v_mov_b64 v[38:39], 0
v_mov_b64 v[40:41], 0
v_mov_b64 v[42:43], 0
v_mov_b64 v[44:45], 0
v_mov_b64 v[46:47], 0
v_mov_b64 v[48:49], 0
v_mov_b64 v[50:51], 0
v_mov_b64 v[52:53], 0
v_mov_b64 v[54:55], 0
s_cmp_lg_u32 s69, 0
s_cselect_b32 s40, 4, s38
s_mov_b32 s82, 0
s_mov_b32 s57, 0
s_waitcnt vmcnt(0)
v_mov_b32 v78, 0
ds_write_b128 v102, v[216:219]
ds_write_b128 v102, v[220:223] offset:1024
s_waitcnt lgkmcnt(0)
s_barrier
ds_read_b128 v[0:3], v98 offset:0
ds_read_b128 v[4:7], v98 offset:1024
ds_read_b128 v[8:11], v98 offset:2048
ds_read_b128 v[12:15], v98 offset:3072
s_cmp_eq_u32 s40, 1
s_cbranch_scc1 L_top1
s_cmp_eq_u32 s40, 2
s_cbranch_scc1 L_top2
s_cmp_eq_u32 s40, 3
s_cbranch_scc1 L_top3
s_cmp_eq_u32 s40, 4
s_cbranch_scc1 L_top4
s_branch L_top0
.p2alignl 12, 0xbf810000
L_steps:
.p2align 6
.fill 3, 4, 0xbf800000
L_top0:
s_waitcnt lgkmcnt(3)
v_smfmac_f32_16x16x64_bf16 v[32:35], v[0:3], v[224:231], v106
ds_read_b128 v[224:227], v99 offset:8192
v_smfmac_f32_16x16x64_bf16 v[36:39], v[0:3], a[0:7], v106
ds_read_b128 v[228:231], v99 offset:9216
v_smfmac_f32_16x16x64_bf16 v[40:43], v[0:3], a[8:15], v106
v_smfmac_f32_16x16x64_bf16 v[44:47], v[0:3], a[24:31], v106
s_waitcnt lgkmcnt(4)
v_smfmac_f32_16x16x64_bf16 v[32:35], v[4:7], v[232:239], v106
ds_read_b128 v[232:235], v99 offset:10240
v_smfmac_f32_16x16x64_bf16 v[36:39], v[4:7], a[40:47], v106
ds_read_b128 v[236:239], v99 offset:11264
v_smfmac_f32_16x16x64_bf16 v[40:43], v[4:7], a[48:55], v106
v_smfmac_f32_16x16x64_bf16 v[44:47], v[4:7], a[64:71], v106
s_mov_b64 exec, s[84:85]
buffer_store_dwordx4 v[72:75], v102, s[4:7], s65 offen sc1
s_mov_b64 exec, -1
s_waitcnt lgkmcnt(5)
v_smfmac_f32_16x16x64_bf16 v[32:35], v[8:11], v[240:247], v106
buffer_store_dwordx4 v[92:95], v102, s[4:7], s65 offen offset:1024 sc1
v_smfmac_f32_16x16x64_bf16 v[36:39], v[8:11], a[80:87], v106
v_smfmac_f32_16x16x64_bf16 v[40:43], v[8:11], a[88:95], v106
s_waitcnt vmcnt(4)
s_barrier
ds_read_b128 v[16:19], v98 offset:4096
v_smfmac_f32_16x16x64_bf16 v[44:47], v[8:11], a[104:111], v106
ds_read_b128 v[20:23], v98 offset:5120
s_waitcnt lgkmcnt(6)
v_smfmac_f32_16x16x64_bf16 v[32:35], v[12:15], v[248:255], v106
ds_read_b128 v[24:27], v98 offset:6144
v_smfmac_f32_16x16x64_bf16 v[36:39], v[12:15], a[120:127], v106
ds_read_b128 v[28:31], v98 offset:7168
v_smfmac_f32_16x16x64_bf16 v[40:43], v[12:15], a[128:135], v106
ds_read_b128 v[240:243], v99 offset:12288
v_smfmac_f32_16x16x64_bf16 v[44:47], v[12:15], a[144:151], v106
ds_read_b128 v[244:247], v99 offset:13312
s_waitcnt lgkmcnt(5)
v_smfmac_f32_16x16x64_bf16 v[32:35], v[16:19], v[224:231], v106
ds_read_b128 v[248:251], v99 offset:18432
s_mov_b64 exec, s[94:95]
buffer_store_dword v78, v79, s[4:7], 0 offen offset:2048 sc1
s_mov_b64 exec, -1
v_smfmac_f32_16x16x64_bf16 v[36:39], v[16:19], v[112:119], v106
ds_read_b128 v[252:255], v99 offset:19456
v_smfmac_f32_16x16x64_bf16 v[40:43], v[16:19], a[160:167], v106
ds_read_b128 v[224:227], v99 offset:14336
v_smfmac_f32_16x16x64_bf16 v[44:47], v[16:19], a[176:183], v106
ds_read_b128 v[228:231], v99 offset:15360
s_waitcnt lgkmcnt(8)
v_smfmac_f32_16x16x64_bf16 v[32:35], v[20:23], v[232:239], v106
ds_read_b128 v[232:235], v99 offset:16384
v_smfmac_f32_16x16x64_bf16 v[36:39], v[20:23], v[120:127], v106
ds_read_b128 v[236:239], v99 offset:17408
v_smfmac_f32_16x16x64_bf16 v[40:43], v[20:23], a[192:199], v106
v_smfmac_f32_16x16x64_bf16 v[44:47], v[20:23], a[208:215], v106
s_waitcnt lgkmcnt(9)
s_waitcnt lgkmcnt(6)
v_smfmac_f32_16x16x64_bf16 v[32:35], v[24:27], v[240:247], v106
ds_read_b128 v[240:243], v99 offset:20480
v_smfmac_f32_16x16x64_bf16 v[40:43], v[24:27], a[224:231], v106
ds_read_b128 v[244:247], v99 offset:21504
s_waitcnt lgkmcnt(6)
v_smfmac_f32_16x16x64_bf16 v[32:35], v[28:31], v[248:255], v106
ds_read_b128 v[248:251], v99 offset:22528
v_smfmac_f32_16x16x64_bf16 v[40:43], v[28:31], a[240:247], v106
ds_read_b128 v[252:255], v99 offset:23552
v_smfmac_f32_16x16x64_bf16 v[36:39], v[24:27], v[128:135], v106
v_cvt_pk_bf16_f32 v32, v32, v33
v_smfmac_f32_16x16x64_bf16 v[44:47], v[24:27], a[232:239], v106
v_cvt_pk_bf16_f32 v33, v34, v35
v_smfmac_f32_16x16x64_bf16 v[36:39], v[28:31], v[136:143], v106
v_cvt_pk_bf16_f32 v34, v40, v41
v_smfmac_f32_16x16x64_bf16 v[44:47], v[28:31], a[248:255], v106
s_barrier
v_cvt_pk_bf16_f32 v35, v42, v43
s_waitcnt lgkmcnt(6)
v_smfmac_f32_16x16x64_bf16 v[48:51], v[24:27], v[224:231], v106
ds_read_b128 v[224:227], v99 offset:24576
v_cvt_pk_bf16_f32 v36, v36, v37
v_mfma_f32_16x16x32_bf16 v[40:43], v[32:35], v[84:87], 0
ds_read_b128 v[228:231], v99 offset:25600
v_cvt_pk_bf16_f32 v37, v38, v39
v_cvt_pk_bf16_f32 v38, v44, v45
s_waitcnt lgkmcnt(6)
v_smfmac_f32_16x16x64_bf16 v[52:55], v[24:27], v[232:239], v106
ds_read_b128 v[232:235], v99 offset:26624
v_cvt_pk_bf16_f32 v39, v46, v47
s_nop 1
v_mfma_f32_16x16x32_bf16 v[44:47], v[36:39], v[84:87], 0
ds_read_b128 v[236:239], v99 offset:27648
v_cvt_pk_bf16_f32 v72, v40, v41
v_cvt_pk_bf16_f32 v73, v42, v43
s_waitcnt lgkmcnt(6)
v_smfmac_f32_16x16x64_bf16 v[48:51], v[28:31], v[240:247], v106
ds_read_b128 v[240:243], v99 offset:28672
s_waitcnt lgkmcnt(5)
v_smfmac_f32_16x16x64_bf16 v[52:55], v[28:31], v[248:255], v106
ds_read_b128 v[244:247], v99 offset:29696
v_cvt_pk_bf16_f32 v74, v44, v45
v_cvt_pk_bf16_f32 v75, v46, v47
s_nop 1
v_mfma_f32_16x16x32_bf16 v[40:43], v[72:75], v[72:75], 0
ds_read_b128 v[248:251], v99 offset:30720
v_mfma_f32_16x16x32_bf16 v[32:35], v[56:59], v[72:75], 0
ds_read_b128 v[252:255], v99 offset:31744
v_mfma_f32_16x16x32_bf16 v[36:39], v[60:63], v[72:75], 0
v_mov_b32_dpp v40, v42 row_ror:8 row_mask:0xf bank_mask:0xc
v_mov_b32_dpp v41, v43 row_ror:8 row_mask:0xf bank_mask:0xc
ds_write_b64 v107, v[40:41] offset:1152
v_smfmac_f32_16x16x64_bf16 v[48:51], v[0:3], a[16:23], v106
s_nop 3
v_mov_b32_dpp v32, v36 row_ror:8 row_mask:0xf bank_mask:0xc
v_mov_b32_dpp v33, v37 row_ror:8 row_mask:0xf bank_mask:0xc
v_mov_b32_dpp v34, v38 row_ror:8 row_mask:0xf bank_mask:0xc
v_mov_b32_dpp v35, v39 row_ror:8 row_mask:0xf bank_mask:0xc
ds_write_b128 v102, v[32:35]
v_smfmac_f32_16x16x64_bf16 v[48:51], v[4:7], a[56:63], v106
s_add_u32 s64, s64, 0x40000
s_add_u32 s75, s64, 16777216
v_smfmac_f32_16x16x64_bf16 v[48:51], v[8:11], a[96:103], v106
buffer_load_dwordx4 v[56:59], v102, s[4:7], s64 offen offset:0 sc1
v_smfmac_f32_16x16x64_bf16 v[48:51], v[12:15], a[136:143], v106
buffer_load_dwordx4 v[60:63], v102, s[4:7], s64 offen offset:1024 sc1
v_smfmac_f32_16x16x64_bf16 v[48:51], v[16:19], a[168:175], v106
s_waitcnt lgkmcnt(0)
s_barrier
ds_read_b64 v[76:77], v100 offset:0
v_smfmac_f32_16x16x64_bf16 v[48:51], v[20:23], a[200:207], v106
ds_read_b64 v[78:79], v100 offset:2048
v_smfmac_f32_16x16x64_bf16 v[52:55], v[0:3], a[32:39], v106
ds_read_b64 v[80:81], v100 offset:4096
v_smfmac_f32_16x16x64_bf16 v[52:55], v[4:7], a[72:79], v106
ds_read_b64 v[82:83], v100 offset:6144
v_smfmac_f32_16x16x64_bf16 v[52:55], v[8:11], a[112:119], v106
v_cvt_pk_bf16_f32 v92, v48, v49
ds_read_b128 v[32:35], v98 offset:0
v_smfmac_f32_16x16x64_bf16 v[52:55], v[12:15], a[152:159], v106
v_cvt_pk_bf16_f32 v93, v50, v51
ds_read_b128 v[36:39], v98 offset:2048
v_smfmac_f32_16x16x64_bf16 v[52:55], v[16:19], a[184:191], v106
ds_read_b128 v[216:219], v98 offset:4096
v_smfmac_f32_16x16x64_bf16 v[52:55], v[20:23], a[216:223], v106
ds_read_b128 v[220:223], v98 offset:6144
s_waitcnt lgkmcnt(6)
v_pk_mul_f32 v[76:77], s[72:73], v[76:77] op_sel_hi:[0,1]
v_pk_fma_f32 v[76:77], s[72:73], v[78:79], v[76:77] op_sel_hi:[0,1,1]
s_waitcnt lgkmcnt(4)
v_pk_fma_f32 v[76:77], s[72:73], v[80:81], v[76:77] op_sel_hi:[0,1,1]
v_pk_fma_f32 v[76:77], s[72:73], v[82:83], v[76:77] op_sel_hi:[0,1,1]
v_exp_f32 v78, v76
v_exp_f32 v79, v77
v_cvt_pk_bf16_f32 v94, v52, v53
v_cvt_pk_bf16_f32 v41, v78, v79
v_cvt_pk_bf16_f32 v95, v54, v55
s_waitcnt lgkmcnt(3)
v_pk_mul_f32 v[32:33], s[72:73], v[32:33] op_sel_hi:[0,1]
v_mov_b32_dpp v40, v41 row_ror:8 row_mask:0xf bank_mask:0xf
v_pk_mul_f32 v[34:35], s[72:73], v[34:35] op_sel_hi:[0,1]
s_waitcnt lgkmcnt(2)
v_pk_fma_f32 v[32:33], s[72:73], v[36:37], v[32:33] op_sel_hi:[0,1,1]
v_pk_fma_f32 v[34:35], s[72:73], v[38:39], v[34:35] op_sel_hi:[0,1,1]
s_waitcnt lgkmcnt(1)
v_pk_fma_f32 v[32:33], s[72:73], v[216:217], v[32:33] op_sel_hi:[0,1,1]
v_pk_fma_f32 v[34:35], s[72:73], v[218:219], v[34:35] op_sel_hi:[0,1,1]
s_waitcnt lgkmcnt(0)
v_pk_fma_f32 v[32:33], s[72:73], v[220:221], v[32:33] op_sel_hi:[0,1,1]
v_pk_fma_f32 v[34:35], s[72:73], v[222:223], v[34:35] op_sel_hi:[0,1,1]
v_mfma_f32_16x16x16_bf16 v[216:219], v[92:93], v[40:41], 0
v_exp_f32 v36, v32
v_exp_f32 v37, v33
v_mfma_f32_16x16x16_bf16 v[220:223], v[94:95], v[40:41], 0
v_exp_f32 v38, v34
v_exp_f32 v39, v35
v_cvt_pk_bf16_f32 v42, v36, v37
v_cvt_pk_bf16_f32 v43, v38, v39
v_max3_f32 v46, |v32|, |v33|, |v34|
v_mov_b32_dpp v44, v42 row_ror:8 row_mask:0xf bank_mask:0xf
v_mov_b32_dpp v45, v43 row_ror:8 row_mask:0xf bank_mask:0xf
v_mfma_f32_16x16x32_bf16 v[80:83], v[88:91], v[40:43], 0
v_max3_f32 v46, v46, |v35|, |v76|
v_max_f32 v46, v46, |v77|
s_waitcnt vmcnt(5)
v_mfma_f32_16x16x32_bf16 v[216:219], v[64:67], v[42:45], v[216:219]
v_cmp_lt_f32 vcc, s77, v46
v_mov_b64 v[16:17], 0
v_mfma_f32_16x16x32_bf16 v[220:223], v[68:71], v[42:45], v[220:223]
v_add_f32_dpp v80, v80, v80 row_ror:8 row_mask:0xf bank_mask:0xf
v_rcp_f32 v80, v80
v_mov_b64 v[18:19], 0
v_mov_b64 v[20:21], 0
v_pk_mul_f32 v[216:217], v[216:217], v[80:81] op_sel_hi:[1,0]
v_pk_mul_f32 v[218:219], v[218:219], v[80:81] op_sel_hi:[1,0]
v_cvt_pk_bf16_f32 v216, v216, v217
v_cvt_pk_bf16_f32 v217, v218, v219
v_pk_mul_f32 v[220:221], v[220:221], v[80:81] op_sel_hi:[1,0]
v_pk_mul_f32 v[222:223], v[222:223], v[80:81] op_sel_hi:[1,0]
v_cvt_pk_bf16_f32 v218, v220, v221
v_cvt_pk_bf16_f32 v219, v222, v223
v_mov_b64 v[22:23], 0
v_mov_b32_dpp v218, v216 row_ror:8 row_mask:0xf bank_mask:0xc
v_mov_b32_dpp v219, v217 row_ror:8 row_mask:0xf bank_mask:0xc
ds_write_b64 v109, v[218:219] offset:1024
s_cbranch_vccnz L_max0
L_pv0:
v_mov_b64 v[24:25], 0
v_mov_b64 v[26:27], 0
v_mov_b64 v[28:29], 0
v_mov_b64 v[30:31], 0
s_waitcnt lgkmcnt(0)
s_barrier
ds_read_b128 v[0:3], v101 offset:0
ds_read_b128 v[4:7], v101 offset:2048
ds_read_b128 v[8:11], v101 offset:4096
ds_read_b128 v[12:15], v101 offset:6144
s_mov_b32 s74, s63
s_xor_b32 s63, s63, 8192
s_waitcnt lgkmcnt(3)
v_smfmac_f32_16x16x64_bf16 v[16:19], v[0:3], v[224:231], v106
v_smfmac_f32_16x16x64_bf16 v[20:23], v[0:3], v[144:151], v106
s_waitcnt lgkmcnt(2)
v_smfmac_f32_16x16x64_bf16 v[16:19], v[4:7], v[232:239], v106
ds_read_b128 v[232:235], v99 offset:32768
v_smfmac_f32_16x16x64_bf16 v[20:23], v[4:7], v[152:159], v106
ds_read_b128 v[236:239], v99 offset:33792
s_waitcnt lgkmcnt(3)
v_smfmac_f32_16x16x64_bf16 v[16:19], v[8:11], v[240:247], v106
ds_read_b128 v[240:243], v99 offset:34816
v_smfmac_f32_16x16x64_bf16 v[20:23], v[8:11], v[160:167], v106
ds_read_b128 v[244:247], v99 offset:35840
s_waitcnt lgkmcnt(4)
v_smfmac_f32_16x16x64_bf16 v[16:19], v[12:15], v[248:255], v106
ds_read_b128 v[248:251], v99 offset:36864
v_smfmac_f32_16x16x64_bf16 v[20:23], v[12:15], v[168:175], v106
ds_read_b128 v[252:255], v99 offset:37888
v_smfmac_f32_16x16x64_bf16 v[24:27], v[0:3], v[176:183], v106
v_smfmac_f32_16x16x64_bf16 v[28:31], v[0:3], v[208:215], v106
v_cvt_pk_bf16_f32 v16, v16, v20
v_cvt_pk_bf16_f32 v17, v17, v21
v_bfi_b32 v16, 1, s76, v16
v_cvt_pk_bf16_f32 v18, v18, v22
v_cvt_pk_bf16_f32 v19, v19, v23
buffer_store_dwordx4 v[16:19], v96, s[4:7], s60 offen
v_smfmac_f32_16x16x64_bf16 v[24:27], v[4:7], v[184:191], v106
s_waitcnt lgkmcnt(4)
v_smfmac_f32_16x16x64_bf16 v[28:31], v[4:7], v[232:239], v106
v_smfmac_f32_16x16x64_bf16 v[24:27], v[8:11], v[192:199], v106
s_waitcnt lgkmcnt(2)
v_smfmac_f32_16x16x64_bf16 v[28:31], v[8:11], v[240:247], v106
v_smfmac_f32_16x16x64_bf16 v[24:27], v[12:15], v[200:207], v106
s_waitcnt lgkmcnt(0)
v_smfmac_f32_16x16x64_bf16 v[28:31], v[12:15], v[248:255], v106
v_mov_b64 v[76:77], s[86:87]
v_mov_b64 v[78:79], s[86:87]
v_mov_b64 v[80:81], 0
v_mov_b64 v[82:83], 0
s_nop 3
v_cvt_pk_bf16_f32 v24, v24, v28
v_cvt_pk_bf16_f32 v25, v25, v29
v_bfi_b32 v24, 1, s76, v24
v_cvt_pk_bf16_f32 v26, v26, v30
v_cvt_pk_bf16_f32 v27, v27, v31
buffer_store_dwordx4 v[24:27], v96, s[4:7], s61 offen
v_mov_b64 v[32:33], 0
v_mov_b64 v[34:35], 0
v_mov_b64 v[36:37], 0
v_mov_b64 v[38:39], 0
v_mov_b64 v[40:41], 0
v_mov_b64 v[42:43], 0
v_mov_b64 v[44:45], 0
v_mov_b64 v[46:47], 0
v_mov_b64 v[48:49], 0
v_mov_b64 v[50:51], 0
v_mov_b64 v[52:53], 0
v_mov_b64 v[54:55], 0
s_nop 15
s_nop 2
s_nop 2
buffer_load_dword v216, v104, s[4:7], s62 offen offset:0 sc1
buffer_load_dword v217, v104, s[4:7], s62 offen offset:256 sc1
buffer_load_dword v218, v104, s[4:7], s62 offen offset:512 sc1
buffer_load_dword v219, v104, s[4:7], s62 offen offset:768 sc1
buffer_load_dword v220, v104, s[4:7], s62 offen offset:1024 sc1
buffer_load_dword v221, v104, s[4:7], s62 offen offset:1280 sc1
buffer_load_dword v222, v104, s[4:7], s62 offen offset:1536 sc1
buffer_load_dword v223, v104, s[4:7], s62 offen offset:1792 sc1
ds_read_b128 v[224:227], v99 offset:0
ds_read_b128 v[228:231], v99 offset:1024
ds_read_b128 v[232:235], v99 offset:2048
ds_read_b128 v[236:239], v99 offset:3072
ds_read_b128 v[240:243], v99 offset:4096
ds_read_b128 v[244:247], v99 offset:5120
ds_read_b128 v[248:251], v99 offset:6144
ds_read_b128 v[252:255], v99 offset:7168
s_xor_b32 s60, s60, 0x40000
s_xor_b32 s61, s61, 0x40000
s_add_u32 s65, s65, 0x40000
s_add_u32 s68, s68, 1
s_mov_b32 s57, 0
s_waitcnt vmcnt(5)
v_bitop3_b32 v0, v216, v217, v218 bitop3:0x7e
s_waitcnt vmcnt(3)
v_bitop3_b32 v1, v218, v219, v220 bitop3:0x7e
s_waitcnt vmcnt(1)
v_bitop3_b32 v2, v220, v221, v222 bitop3:0x7e
v_or3_b32 v0, v0, v1, v2
s_waitcnt vmcnt(0)
v_smfmac_f32_16x16x64_bf16 v[80:83], v[76:79], v[216:223], v110
v_bitop3_b32 v3, v222, v223, s76 bitop3:0x7e
v_bitop3_b32 v0, v0, v111, v3 bitop3:0xc8
v_cmp_ne_u32 vcc, 0, v0
s_nop 3
s_cbranch_vccnz L_repoll0
v_cvt_pk_bf16_f32 v80, v80, v81
L_sum0:
buffer_store_dword v80, v97, s[4:7], s63 offen
v_mov_b32 v83, -1
s_xor_b32 s62, s62, 0x40000
s_bitcmp1_b32 s68, 1
s_cselect_b32 s76, -1, 0
buffer_store_dword v83, v97, s[4:7], s74 offen
s_nop 15
s_nop 15
s_nop 15
s_nop 0
buffer_load_dwordx4 v[216:219], v102, s[4:7], s63 offen sc1
buffer_load_dwordx4 v[220:223], v102, s[4:7], s63 offen offset:1024 sc1
v_mov_b32 v78, s68
v_lshlrev_b32 v79, 3, v98
s_nop 15
s_nop 3
buffer_load_dwordx4 v[16:19], v102, s[4:7], s63 offen sc1
buffer_load_dwordx4 v[20:23], v102, s[4:7], s63 offen offset:1024 sc1
s_nop 15
s_nop 7
buffer_load_dwordx4 v[16:19], v102, s[4:7], s63 offen sc1
buffer_load_dwordx4 v[20:23], v102, s[4:7], s63 offen offset:1024 sc1
s_waitcnt vmcnt(4)
ds_write_b128 v102, v[216:219]
v_max_u32 v76, v216, v220
ds_write_b128 v102, v[220:223] offset:1024
v_cmp_eq_u32 vcc, -1, v76
s_cbranch_vccnz L_rg_0
L_rg_ret0:
s_barrier
s_cmp_lt_u32 s68, 63
s_waitcnt lgkmcnt(0)
s_barrier
ds_read_b128 v[0:3], v98 offset:0
ds_read_b128 v[4:7], v98 offset:1024
ds_read_b128 v[8:11], v98 offset:2048
ds_read_b128 v[12:15], v98 offset:3072
buffer_load_dwordx4 v[64:67], v102, s[4:7], s75 offen offset:0 sc1
buffer_load_dwordx4 v[68:71], v102, s[4:7], s75 offen offset:1024 sc1
s_cbranch_scc1 L_top0
s_branch L_final01
L_rg_0:
s_mov_b32 s57, 0
L_rgl_0:
s_mov_b64 exec, vcc
buffer_load_dwordx4 v[16:19], v102, s[4:7], s63 offen sc1
buffer_load_dwordx4 v[20:23], v102, s[4:7], s63 offen offset:1024 sc1
s_add_u32 s57, s57, 0x2000
s_cbranch_scc1 L_end
s_waitcnt vmcnt(4)
v_max3_u32 v76, v16, v17, v18
v_max3_u32 v77, v19, v20, v21
v_max3_u32 v76, v76, v22, v23
v_max_u32 v76, v76, v77
v_cmp_eq_u32 vcc, -1, v76
s_cbranch_vccnz L_rgl_0
s_mov_b64 exec, -1
ds_write_b128 v102, v[16:19]
ds_write_b128 v102, v[20:23] offset:1024
s_branch L_rg_ret0
L_repoll0:
s_lshl_b64 s[88:89], vcc, 1
s_or_b64 vcc, vcc, s[88:89]
s_lshl_b64 s[88:89], vcc, 2
s_or_b64 exec, vcc, s[88:89]
buffer_load_dword v216, v104, s[4:7], s62 offen offset:0 sc1
buffer_load_dword v217, v104, s[4:7], s62 offen offset:256 sc1
buffer_load_dword v218, v104, s[4:7], s62 offen offset:512 sc1
buffer_load_dword v219, v104, s[4:7], s62 offen offset:768 sc1
buffer_load_dword v220, v104, s[4:7], s62 offen offset:1024 sc1
buffer_load_dword v221, v104, s[4:7], s62 offen offset:1280 sc1
buffer_load_dword v222, v104, s[4:7], s62 offen offset:1536 sc1
buffer_load_dword v223, v104, s[4:7], s62 offen offset:1792 sc1
s_mov_b64 exec, -1
v_mov_b64 v[80:81], 0
v_mov_b64 v[82:83], 0
s_add_u32 s57, s57, 0x2000
s_cbranch_scc1 L_end
s_waitcnt vmcnt(0)
v_smfmac_f32_16x16x64_bf16 v[80:83], v[76:79], v[216:223], v110
v_bitop3_b32 v0, v216, v217, v218 bitop3:0x7e
v_bitop3_b32 v1, v218, v219, v220 bitop3:0x7e
v_bitop3_b32 v2, v220, v221, v222 bitop3:0x7e
v_bitop3_b32 v3, v222, v223, s76 bitop3:0x7e
v_or3_b32 v0, v0, v1, v2
v_bitop3_b32 v0, v0, v111, v3 bitop3:0xc8
v_cmp_ne_u32 vcc, 0, v0
s_nop 0
v_cvt_pk_bf16_f32 v80, v80, v81
s_cbranch_vccz L_sum0
s_branch L_repoll0
L_max0:
v_max3_f32 v46, v32, v33, v34
v_max3_f32 v47, v35, v76, v77
v_max_f32 v46, v46, v47
s_nop 1
v_max_f32_dpp v46, v46, v46 row_ror:8 row_mask:0xf bank_mask:0xf
v_mov_b32 v47, v46
s_nop 1
v_permlane16_swap_b32 v46, v47
v_max_f32 v46, v46, v47
v_mov_b32 v47, v46
s_nop 1
v_permlane32_swap_b32 v46, v47
v_max_f32 v46, v46, v47
v_sub_f32 v32, v32, v46
v_exp_f32 v36, v32
v_sub_f32 v33, v33, v46
v_exp_f32 v37, v33
v_sub_f32 v34, v34, v46
v_exp_f32 v38, v34
v_sub_f32 v35, v35, v46
v_exp_f32 v39, v35
v_sub_f32 v76, v76, v46
v_exp_f32 v78, v76
v_sub_f32 v77, v77, v46
v_exp_f32 v79, v77
s_nop 0
v_cvt_pk_bf16_f32 v41, v78, v79
v_cvt_pk_bf16_f32 v42, v36, v37
v_cvt_pk_bf16_f32 v43, v38, v39
v_mov_b32_dpp v40, v41 row_ror:8 row_mask:0xf bank_mask:0xf
v_mov_b32_dpp v44, v42 row_ror:8 row_mask:0xf bank_mask:0xf
v_mov_b32_dpp v45, v43 row_ror:8 row_mask:0xf bank_mask:0xf
v_mfma_f32_16x16x16_bf16 v[216:219], v[92:93], v[40:41], 0
v_mfma_f32_16x16x16_bf16 v[220:223], v[94:95], v[40:41], 0
v_mfma_f32_16x16x32_bf16 v[80:83], v[88:91], v[40:43], 0
v_mfma_f32_16x16x32_bf16 v[216:219], v[64:67], v[42:45], v[216:219]
v_mfma_f32_16x16x32_bf16 v[220:223], v[68:71], v[42:45], v[220:223]
v_add_f32_dpp v80, v80, v80 row_ror:8 row_mask:0xf bank_mask:0xf
v_rcp_f32 v80, v80
s_nop 1
v_pk_mul_f32 v[216:217], v[216:217], v[80:81] op_sel_hi:[1,0]
v_pk_mul_f32 v[218:219], v[218:219], v[80:81] op_sel_hi:[1,0]
v_cvt_pk_bf16_f32 v216, v216, v217
v_cvt_pk_bf16_f32 v217, v218, v219
v_pk_mul_f32 v[220:221], v[220:221], v[80:81] op_sel_hi:[1,0]
v_pk_mul_f32 v[222:223], v[222:223], v[80:81] op_sel_hi:[1,0]
v_cvt_pk_bf16_f32 v218, v220, v221
v_cvt_pk_bf16_f32 v219, v222, v223
s_nop 0
v_mov_b32_dpp v218, v216 row_ror:8 row_mask:0xf bank_mask:0xc
v_mov_b32_dpp v219, v217 row_ror:8 row_mask:0xf bank_mask:0xc
ds_write_b64 v109, v[218:219] offset:1024
s_branch L_pv0
.p2alignl 12, 0xbf810000
.p2align 6
.fill 3, 4, 0xbf800000
L_top1:
s_waitcnt lgkmcnt(3)
v_smfmac_f32_16x16x64_bf16 v[32:35], v[0:3], v[224:231], v106
ds_read_b128 v[224:227], v99 offset:8192
v_smfmac_f32_16x16x64_bf16 v[36:39], v[0:3], a[0:7], v106
ds_read_b128 v[228:231], v99 offset:9216
v_smfmac_f32_16x16x64_bf16 v[40:43], v[0:3], a[8:15], v106
v_smfmac_f32_16x16x64_bf16 v[44:47], v[0:3], a[24:31], v106
s_waitcnt lgkmcnt(4)
v_smfmac_f32_16x16x64_bf16 v[32:35], v[4:7], v[232:239], v106
ds_read_b128 v[232:235], v99 offset:10240
v_smfmac_f32_16x16x64_bf16 v[36:39], v[4:7], a[40:47], v106
ds_read_b128 v[236:239], v99 offset:11264
v_smfmac_f32_16x16x64_bf16 v[40:43], v[4:7], a[48:55], v106
v_smfmac_f32_16x16x64_bf16 v[44:47], v[4:7], a[64:71], v106
s_mov_b64 exec, s[84:85]
buffer_store_dwordx4 v[72:75], v102, s[4:7], s65 offen sc1
s_mov_b64 exec, -1
s_waitcnt lgkmcnt(5)
v_smfmac_f32_16x16x64_bf16 v[32:35], v[8:11], v[240:247], v106
buffer_store_dwordx4 v[92:95], v102, s[4:7], s65 offen offset:1024 sc1
v_smfmac_f32_16x16x64_bf16 v[36:39], v[8:11], a[80:87], v106
v_smfmac_f32_16x16x64_bf16 v[40:43], v[8:11], a[88:95], v106
s_waitcnt vmcnt(4)
s_barrier
ds_read_b128 v[16:19], v98 offset:4096
v_smfmac_f32_16x16x64_bf16 v[44:47], v[8:11], a[104:111], v106
ds_read_b128 v[20:23], v98 offset:5120
s_waitcnt lgkmcnt(6)
v_smfmac_f32_16x16x64_bf16 v[32:35], v[12:15], v[248:255], v106
ds_read_b128 v[24:27], v98 offset:6144
v_smfmac_f32_16x16x64_bf16 v[36:39], v[12:15], a[120:127], v106
ds_read_b128 v[28:31], v98 offset:7168
v_smfmac_f32_16x16x64_bf16 v[40:43], v[12:15], a[128:135], v106
ds_read_b128 v[240:243], v99 offset:12288
v_smfmac_f32_16x16x64_bf16 v[44:47], v[12:15], a[144:151], v106
ds_read_b128 v[244:247], v99 offset:13312
s_waitcnt lgkmcnt(5)
v_smfmac_f32_16x16x64_bf16 v[32:35], v[16:19], v[224:231], v106
ds_read_b128 v[248:251], v99 offset:18432
s_mov_b64 exec, s[96:97]
buffer_load_dword v108, v105, s[4:7], 0 offen offset:1024 sc1
s_mov_b64 exec, -1
v_smfmac_f32_16x16x64_bf16 v[36:39], v[16:19], v[112:119], v106
ds_read_b128 v[252:255], v99 offset:19456
v_smfmac_f32_16x16x64_bf16 v[40:43], v[16:19], a[160:167], v106
ds_read_b128 v[224:227], v99 offset:14336
v_smfmac_f32_16x16x64_bf16 v[44:47], v[16:19], a[176:183], v106
ds_read_b128 v[228:231], v99 offset:15360
s_waitcnt lgkmcnt(8)
v_smfmac_f32_16x16x64_bf16 v[32:35], v[20:23], v[232:239], v106
ds_read_b128 v[232:235], v99 offset:16384
v_smfmac_f32_16x16x64_bf16 v[36:39], v[20:23], v[120:127], v106
ds_read_b128 v[236:239], v99 offset:17408
v_smfmac_f32_16x16x64_bf16 v[40:43], v[20:23], a[192:199], v106
v_smfmac_f32_16x16x64_bf16 v[44:47], v[20:23], a[208:215], v106
s_waitcnt lgkmcnt(9)
s_waitcnt lgkmcnt(6)
v_smfmac_f32_16x16x64_bf16 v[32:35], v[24:27], v[240:247], v106
ds_read_b128 v[240:243], v99 offset:20480
v_smfmac_f32_16x16x64_bf16 v[40:43], v[24:27], a[224:231], v106
ds_read_b128 v[244:247], v99 offset:21504
s_waitcnt lgkmcnt(6)
v_smfmac_f32_16x16x64_bf16 v[32:35], v[28:31], v[248:255], v106
ds_read_b128 v[248:251], v99 offset:22528
v_smfmac_f32_16x16x64_bf16 v[40:43], v[28:31], a[240:247], v106
ds_read_b128 v[252:255], v99 offset:23552
v_smfmac_f32_16x16x64_bf16 v[36:39], v[24:27], v[128:135], v106
v_cvt_pk_bf16_f32 v32, v32, v33
v_smfmac_f32_16x16x64_bf16 v[44:47], v[24:27], a[232:239], v106
v_cvt_pk_bf16_f32 v33, v34, v35
v_smfmac_f32_16x16x64_bf16 v[36:39], v[28:31], v[136:143], v106
v_cvt_pk_bf16_f32 v34, v40, v41
v_smfmac_f32_16x16x64_bf16 v[44:47], v[28:31], a[248:255], v106
s_barrier
v_cvt_pk_bf16_f32 v35, v42, v43
s_waitcnt lgkmcnt(6)
v_smfmac_f32_16x16x64_bf16 v[48:51], v[24:27], v[224:231], v106
ds_read_b128 v[224:227], v99 offset:24576
v_cvt_pk_bf16_f32 v36, v36, v37
v_mfma_f32_16x16x32_bf16 v[40:43], v[32:35], v[84:87], 0
ds_read_b128 v[228:231], v99 offset:25600
v_cvt_pk_bf16_f32 v37, v38, v39
v_cvt_pk_bf16_f32 v38, v44, v45
s_waitcnt lgkmcnt(6)
v_smfmac_f32_16x16x64_bf16 v[52:55], v[24:27], v[232:239], v106
ds_read_b128 v[232:235], v99 offset:26624
v_cvt_pk_bf16_f32 v39, v46, v47
s_nop 1
v_mfma_f32_16x16x32_bf16 v[44:47], v[36:39], v[84:87], 0
ds_read_b128 v[236:239], v99 offset:27648
v_cvt_pk_bf16_f32 v72, v40, v41
v_cvt_pk_bf16_f32 v73, v42, v43
s_waitcnt lgkmcnt(6)
v_smfmac_f32_16x16x64_bf16 v[48:51], v[28:31], v[240:247], v106
ds_read_b128 v[240:243], v99 offset:28672
s_waitcnt lgkmcnt(5)
v_smfmac_f32_16x16x64_bf16 v[52:55], v[28:31], v[248:255], v106
ds_read_b128 v[244:247], v99 offset:29696
v_cvt_pk_bf16_f32 v74, v44, v45
v_cvt_pk_bf16_f32 v75, v46, v47
s_nop 1
v_mfma_f32_16x16x32_bf16 v[40:43], v[72:75], v[72:75], 0
ds_read_b128 v[248:251], v99 offset:30720
v_mfma_f32_16x16x32_bf16 v[32:35], v[56:59], v[72:75], 0
ds_read_b128 v[252:255], v99 offset:31744
v_mfma_f32_16x16x32_bf16 v[36:39], v[60:63], v[72:75], 0
v_mov_b32_dpp v40, v42 row_ror:8 row_mask:0xf bank_mask:0xc
v_mov_b32_dpp v41, v43 row_ror:8 row_mask:0xf bank_mask:0xc
ds_write_b64 v107, v[40:41] offset:1152
v_smfmac_f32_16x16x64_bf16 v[48:51], v[0:3], a[16:23], v106
s_nop 3
v_mov_b32_dpp v32, v36 row_ror:8 row_mask:0xf bank_mask:0xc
v_mov_b32_dpp v33, v37 row_ror:8 row_mask:0xf bank_mask:0xc
v_mov_b32_dpp v34, v38 row_ror:8 row_mask:0xf bank_mask:0xc
v_mov_b32_dpp v35, v39 row_ror:8 row_mask:0xf bank_mask:0xc
ds_write_b128 v102, v[32:35]
v_smfmac_f32_16x16x64_bf16 v[48:51], v[4:7], a[56:63], v106
s_add_u32 s64, s64, 0x40000
s_add_u32 s75, s64, 16777216
v_smfmac_f32_16x16x64_bf16 v[48:51], v[8:11], a[96:103], v106
buffer_load_dwordx4 v[56:59], v102, s[4:7], s64 offen offset:0 sc1
v_smfmac_f32_16x16x64_bf16 v[48:51], v[12:15], a[136:143], v106
buffer_load_dwordx4 v[60:63], v102, s[4:7], s64 offen offset:1024 sc1
v_smfmac_f32_16x16x64_bf16 v[48:51], v[16:19], a[168:175], v106
s_waitcnt lgkmcnt(0)
s_barrier
ds_read_b64 v[76:77], v100 offset:0
v_smfmac_f32_16x16x64_bf16 v[48:51], v[20:23], a[200:207], v106
ds_read_b64 v[78:79], v100 offset:2048
v_smfmac_f32_16x16x64_bf16 v[52:55], v[0:3], a[32:39], v106
ds_read_b64 v[80:81], v100 offset:4096
v_smfmac_f32_16x16x64_bf16 v[52:55], v[4:7], a[72:79], v106
ds_read_b64 v[82:83], v100 offset:6144
v_smfmac_f32_16x16x64_bf16 v[52:55], v[8:11], a[112:119], v106
v_cvt_pk_bf16_f32 v92, v48, v49
ds_read_b128 v[32:35], v98 offset:0
v_smfmac_f32_16x16x64_bf16 v[52:55], v[12:15], a[152:159], v106
v_cvt_pk_bf16_f32 v93, v50, v51
ds_read_b128 v[36:39], v98 offset:2048
v_smfmac_f32_16x16x64_bf16 v[52:55], v[16:19], a[184:191], v106
ds_read_b128 v[216:219], v98 offset:4096
v_smfmac_f32_16x16x64_bf16 v[52:55], v[20:23], a[216:223], v106
ds_read_b128 v[220:223], v98 offset:6144
s_waitcnt lgkmcnt(6)
v_pk_mul_f32 v[76:77], s[72:73], v[76:77] op_sel_hi:[0,1]
v_pk_fma_f32 v[76:77], s[72:73], v[78:79], v[76:77] op_sel_hi:[0,1,1]
s_waitcnt lgkmcnt(4)
v_pk_fma_f32 v[76:77], s[72:73], v[80:81], v[76:77] op_sel_hi:[0,1,1]
v_pk_fma_f32 v[76:77], s[72:73], v[82:83], v[76:77] op_sel_hi:[0,1,1]
v_exp_f32 v78, v76
v_exp_f32 v79, v77
v_cvt_pk_bf16_f32 v94, v52, v53
v_cvt_pk_bf16_f32 v41, v78, v79
v_cvt_pk_bf16_f32 v95, v54, v55
s_waitcnt lgkmcnt(3)
v_pk_mul_f32 v[32:33], s[72:73], v[32:33] op_sel_hi:[0,1]
v_mov_b32_dpp v40, v41 row_ror:8 row_mask:0xf bank_mask:0xf
v_pk_mul_f32 v[34:35], s[72:73], v[34:35] op_sel_hi:[0,1]
s_waitcnt lgkmcnt(2)
v_pk_fma_f32 v[32:33], s[72:73], v[36:37], v[32:33] op_sel_hi:[0,1,1]
v_pk_fma_f32 v[34:35], s[72:73], v[38:39], v[34:35] op_sel_hi:[0,1,1]
s_waitcnt lgkmcnt(1)
v_pk_fma_f32 v[32:33], s[72:73], v[216:217], v[32:33] op_sel_hi:[0,1,1]
v_pk_fma_f32 v[34:35], s[72:73], v[218:219], v[34:35] op_sel_hi:[0,1,1]
s_waitcnt lgkmcnt(0)
v_pk_fma_f32 v[32:33], s[72:73], v[220:221], v[32:33] op_sel_hi:[0,1,1]
v_pk_fma_f32 v[34:35], s[72:73], v[222:223], v[34:35] op_sel_hi:[0,1,1]
v_mfma_f32_16x16x16_bf16 v[216:219], v[92:93], v[40:41], 0
v_exp_f32 v36, v32
v_exp_f32 v37, v33
v_mfma_f32_16x16x16_bf16 v[220:223], v[94:95], v[40:41], 0
v_exp_f32 v38, v34
v_exp_f32 v39, v35
v_cvt_pk_bf16_f32 v42, v36, v37
v_cvt_pk_bf16_f32 v43, v38, v39
v_max3_f32 v46, |v32|, |v33|, |v34|
v_mov_b32_dpp v44, v42 row_ror:8 row_mask:0xf bank_mask:0xf
v_mov_b32_dpp v45, v43 row_ror:8 row_mask:0xf bank_mask:0xf
v_mfma_f32_16x16x32_bf16 v[80:83], v[88:91], v[40:43], 0
v_max3_f32 v46, v46, |v35|, |v76|
v_max_f32 v46, v46, |v77|
s_waitcnt vmcnt(5)
v_mfma_f32_16x16x32_bf16 v[216:219], v[64:67], v[42:45], v[216:219]
v_cmp_lt_f32 vcc, s77, v46
v_mov_b64 v[16:17], 0
v_mfma_f32_16x16x32_bf16 v[220:223], v[68:71], v[42:45], v[220:223]
v_add_f32_dpp v80, v80, v80 row_ror:8 row_mask:0xf bank_mask:0xf
v_rcp_f32 v80, v80
v_mov_b64 v[18:19], 0
v_mov_b64 v[20:21], 0
v_pk_mul_f32 v[216:217], v[216:217], v[80:81] op_sel_hi:[1,0]
v_pk_mul_f32 v[218:219], v[218:219], v[80:81] op_sel_hi:[1,0]
v_cvt_pk_bf16_f32 v216, v216, v217
v_cvt_pk_bf16_f32 v217, v218, v219
v_pk_mul_f32 v[220:221], v[220:221], v[80:81] op_sel_hi:[1,0]
v_pk_mul_f32 v[222:223], v[222:223], v[80:81] op_sel_hi:[1,0]
v_cvt_pk_bf16_f32 v218, v220, v221
v_cvt_pk_bf16_f32 v219, v222, v223
v_mov_b64 v[22:23], 0
v_mov_b32_dpp v218, v216 row_ror:8 row_mask:0xf bank_mask:0xc
v_mov_b32_dpp v219, v217 row_ror:8 row_mask:0xf bank_mask:0xc
ds_write_b64 v109, v[218:219] offset:1024
s_cbranch_vccnz L_max1
L_pv1:
v_mov_b64 v[24:25], 0
v_mov_b64 v[26:27], 0
v_mov_b64 v[28:29], 0
v_mov_b64 v[30:31], 0
s_waitcnt lgkmcnt(0)
s_barrier
ds_read_b128 v[0:3], v101 offset:0
ds_read_b128 v[4:7], v101 offset:2048
ds_read_b128 v[8:11], v101 offset:4096
ds_read_b128 v[12:15], v101 offset:6144
s_mov_b32 s74, s63
s_xor_b32 s63, s63, 8192
s_waitcnt lgkmcnt(3)
v_smfmac_f32_16x16x64_bf16 v[16:19], v[0:3], v[224:231], v106
v_smfmac_f32_16x16x64_bf16 v[20:23], v[0:3], v[144:151], v106
s_waitcnt lgkmcnt(2)
v_smfmac_f32_16x16x64_bf16 v[16:19], v[4:7], v[232:239], v106
ds_read_b128 v[232:235], v99 offset:32768
v_smfmac_f32_16x16x64_bf16 v[20:23], v[4:7], v[152:159], v106
ds_read_b128 v[236:239], v99 offset:33792
s_waitcnt lgkmcnt(3)
v_smfmac_f32_16x16x64_bf16 v[16:19], v[8:11], v[240:247], v106
ds_read_b128 v[240:243], v99 offset:34816
v_smfmac_f32_16x16x64_bf16 v[20:23], v[8:11], v[160:167], v106
ds_read_b128 v[244:247], v99 offset:35840
s_waitcnt lgkmcnt(4)
v_smfmac_f32_16x16x64_bf16 v[16:19], v[12:15], v[248:255], v106
ds_read_b128 v[248:251], v99 offset:36864
v_smfmac_f32_16x16x64_bf16 v[20:23], v[12:15], v[168:175], v106
ds_read_b128 v[252:255], v99 offset:37888
v_smfmac_f32_16x16x64_bf16 v[24:27], v[0:3], v[176:183], v106
v_smfmac_f32_16x16x64_bf16 v[28:31], v[0:3], v[208:215], v106
v_cvt_pk_bf16_f32 v16, v16, v20
v_cvt_pk_bf16_f32 v17, v17, v21
v_bfi_b32 v16, 1, s76, v16
v_cvt_pk_bf16_f32 v18, v18, v22
v_cvt_pk_bf16_f32 v19, v19, v23
buffer_store_dwordx4 v[16:19], v96, s[4:7], s60 offen
v_smfmac_f32_16x16x64_bf16 v[24:27], v[4:7], v[184:191], v106
s_waitcnt lgkmcnt(4)
v_smfmac_f32_16x16x64_bf16 v[28:31], v[4:7], v[232:239], v106
v_smfmac_f32_16x16x64_bf16 v[24:27], v[8:11], v[192:199], v106
s_waitcnt lgkmcnt(2)
v_smfmac_f32_16x16x64_bf16 v[28:31], v[8:11], v[240:247], v106
v_smfmac_f32_16x16x64_bf16 v[24:27], v[12:15], v[200:207], v106
s_waitcnt lgkmcnt(0)
v_smfmac_f32_16x16x64_bf16 v[28:31], v[12:15], v[248:255], v106
v_mov_b64 v[76:77], s[86:87]
v_mov_b64 v[78:79], s[86:87]
v_mov_b64 v[80:81], 0
v_mov_b64 v[82:83], 0
s_nop 3
v_cvt_pk_bf16_f32 v24, v24, v28
v_cvt_pk_bf16_f32 v25, v25, v29
v_bfi_b32 v24, 1, s76, v24
v_cvt_pk_bf16_f32 v26, v26, v30
v_cvt_pk_bf16_f32 v27, v27, v31
buffer_store_dwordx4 v[24:27], v96, s[4:7], s61 offen
v_mov_b64 v[32:33], 0
v_mov_b64 v[34:35], 0
v_mov_b64 v[36:37], 0
v_mov_b64 v[38:39], 0
v_mov_b64 v[40:41], 0
v_mov_b64 v[42:43], 0
v_mov_b64 v[44:45], 0
v_mov_b64 v[46:47], 0
v_mov_b64 v[48:49], 0
v_mov_b64 v[50:51], 0
v_mov_b64 v[52:53], 0
v_mov_b64 v[54:55], 0
s_nop 15
s_nop 2
s_nop 2
buffer_load_dword v216, v104, s[4:7], s62 offen offset:0 sc1
buffer_load_dword v217, v104, s[4:7], s62 offen offset:256 sc1
buffer_load_dword v218, v104, s[4:7], s62 offen offset:512 sc1
buffer_load_dword v219, v104, s[4:7], s62 offen offset:768 sc1
buffer_load_dword v220, v104, s[4:7], s62 offen offset:1024 sc1
buffer_load_dword v221, v104, s[4:7], s62 offen offset:1280 sc1
buffer_load_dword v222, v104, s[4:7], s62 offen offset:1536 sc1
buffer_load_dword v223, v104, s[4:7], s62 offen offset:1792 sc1
ds_read_b128 v[224:227], v99 offset:0
ds_read_b128 v[228:231], v99 offset:1024
ds_read_b128 v[232:235], v99 offset:2048
ds_read_b128 v[236:239], v99 offset:3072
ds_read_b128 v[240:243], v99 offset:4096
ds_read_b128 v[244:247], v99 offset:5120
ds_read_b128 v[248:251], v99 offset:6144
ds_read_b128 v[252:255], v99 offset:7168
s_xor_b32 s60, s60, 0x40000
s_xor_b32 s61, s61, 0x40000
s_add_u32 s65, s65, 0x40000
s_add_u32 s68, s68, 1
s_mov_b32 s57, 0
s_waitcnt vmcnt(5)
v_bitop3_b32 v0, v216, v217, v218 bitop3:0x7e
s_waitcnt vmcnt(3)
v_bitop3_b32 v1, v218, v219, v220 bitop3:0x7e
s_waitcnt vmcnt(1)
v_bitop3_b32 v2, v220, v221, v222 bitop3:0x7e
v_or3_b32 v0, v0, v1, v2
s_waitcnt vmcnt(0)
v_smfmac_f32_16x16x64_bf16 v[80:83], v[76:79], v[216:223], v110
v_bitop3_b32 v3, v222, v223, s76 bitop3:0x7e
v_bitop3_b32 v0, v0, v111, v3 bitop3:0xc8
v_cmp_ne_u32 vcc, 0, v0
s_nop 3
s_cbranch_vccnz L_repoll1
v_cvt_pk_bf16_f32 v80, v80, v81
L_sum1:
buffer_store_dword v80, v97, s[4:7], s63 offen
v_mov_b32 v83, -1
s_xor_b32 s62, s62, 0x40000
s_bitcmp1_b32 s68, 1
s_cselect_b32 s76, -1, 0
buffer_store_dword v83, v97, s[4:7], s74 offen
s_cmp_lg_u32 s96, 0
s_cbranch_scc1 L_s1_1
s_nop 15
s_nop 15
s_nop 11
L_s1_ret_1:
buffer_load_dwordx4 v[216:219], v102, s[4:7], s63 offen sc1
buffer_load_dwordx4 v[220:223], v102, s[4:7], s63 offen offset:1024 sc1
s_nop 15
s_nop 5
buffer_load_dwordx4 v[16:19], v102, s[4:7], s63 offen sc1
buffer_load_dwordx4 v[20:23], v102, s[4:7], s63 offen offset:1024 sc1
s_nop 15
s_nop 9
buffer_load_dwordx4 v[16:19], v102, s[4:7], s63 offen sc1
buffer_load_dwordx4 v[20:23], v102, s[4:7], s63 offen offset:1024 sc1
s_waitcnt vmcnt(4)
ds_write_b128 v102, v[216:219]
v_max_u32 v76, v216, v220
ds_write_b128 v102, v[220:223] offset:1024
v_cmp_eq_u32 vcc, -1, v76
s_cbranch_vccnz L_rg_1
L_rg_ret1:
s_barrier
s_cmp_lt_u32 s68, 63
s_waitcnt lgkmcnt(0)
s_barrier
ds_read_b128 v[0:3], v98 offset:0
ds_read_b128 v[4:7], v98 offset:1024
ds_read_b128 v[8:11], v98 offset:2048
ds_read_b128 v[12:15], v98 offset:3072
buffer_load_dwordx4 v[64:67], v102, s[4:7], s75 offen offset:0 sc1
buffer_load_dwordx4 v[68:71], v102, s[4:7], s75 offen offset:1024 sc1
s_cbranch_scc1 L_top1
s_branch L_final01
L_rg_1:
s_mov_b32 s57, 0
L_rgl_1:
s_mov_b64 exec, vcc
buffer_load_dwordx4 v[16:19], v102, s[4:7], s63 offen sc1
buffer_load_dwordx4 v[20:23], v102, s[4:7], s63 offen offset:1024 sc1
s_add_u32 s57, s57, 0x2000
s_cbranch_scc1 L_end
s_waitcnt vmcnt(4)
v_max3_u32 v76, v16, v17, v18
v_max3_u32 v77, v19, v20, v21
v_max3_u32 v76, v76, v22, v23
v_max_u32 v76, v76, v77
v_cmp_eq_u32 vcc, -1, v76
s_cbranch_vccnz L_rgl_1
s_mov_b64 exec, -1
ds_write_b128 v102, v[16:19]
ds_write_b128 v102, v[20:23] offset:1024
s_branch L_rg_ret1
L_s1_1:
s_sub_u32 s67, s68, 0xffffffff
s_min_u32 s67, s67, 63
v_cmp_ge_u32 vcc, s67, v108
s_cbranch_vccz L_s1ok_28
s_mov_b32 s57, 0
L_wf_29:
buffer_load_dword v108, v105, s[4:7], 0 offen offset:1024 sc1
s_add_u32 s57, s57, 1
s_cmp_ge_u32 s57, 524288
s_cbranch_scc1 L_end
s_waitcnt vmcnt(0)
v_cmp_ge_u32 vcc, s67, v108
s_cbranch_vccnz L_wf_29
L_s1ok_28:
v_cmp_gt_u32 vcc, 64, v108
s_cmp_lg_u64 vcc, 0
s_cselect_b64 s[96:97], -1, 0
s_mov_b32 s57, 0
L_s1b_1:
s_nop 11
s_branch L_s1_ret_1
L_repoll1:
s_lshl_b64 s[88:89], vcc, 1
s_or_b64 vcc, vcc, s[88:89]
s_lshl_b64 s[88:89], vcc, 2
s_or_b64 exec, vcc, s[88:89]
buffer_load_dword v216, v104, s[4:7], s62 offen offset:0 sc1
buffer_load_dword v217, v104, s[4:7], s62 offen offset:256 sc1
buffer_load_dword v218, v104, s[4:7], s62 offen offset:512 sc1
buffer_load_dword v219, v104, s[4:7], s62 offen offset:768 sc1
buffer_load_dword v220, v104, s[4:7], s62 offen offset:1024 sc1
buffer_load_dword v221, v104, s[4:7], s62 offen offset:1280 sc1
buffer_load_dword v222, v104, s[4:7], s62 offen offset:1536 sc1
buffer_load_dword v223, v104, s[4:7], s62 offen offset:1792 sc1
s_mov_b64 exec, -1
v_mov_b64 v[80:81], 0
v_mov_b64 v[82:83], 0
s_add_u32 s57, s57, 0x2000
s_cbranch_scc1 L_end
s_waitcnt vmcnt(0)
v_smfmac_f32_16x16x64_bf16 v[80:83], v[76:79], v[216:223], v110
v_bitop3_b32 v0, v216, v217, v218 bitop3:0x7e
v_bitop3_b32 v1, v218, v219, v220 bitop3:0x7e
v_bitop3_b32 v2, v220, v221, v222 bitop3:0x7e
v_bitop3_b32 v3, v222, v223, s76 bitop3:0x7e
v_or3_b32 v0, v0, v1, v2
v_bitop3_b32 v0, v0, v111, v3 bitop3:0xc8
v_cmp_ne_u32 vcc, 0, v0
s_nop 0
v_cvt_pk_bf16_f32 v80, v80, v81
s_cbranch_vccz L_sum1
s_branch L_repoll1
L_max1:
v_max3_f32 v46, v32, v33, v34
v_max3_f32 v47, v35, v76, v77
v_max_f32 v46, v46, v47
s_nop 1
v_max_f32_dpp v46, v46, v46 row_ror:8 row_mask:0xf bank_mask:0xf
v_mov_b32 v47, v46
s_nop 1
v_permlane16_swap_b32 v46, v47
v_max_f32 v46, v46, v47
v_mov_b32 v47, v46
s_nop 1
v_permlane32_swap_b32 v46, v47
v_max_f32 v46, v46, v47
v_sub_f32 v32, v32, v46
v_exp_f32 v36, v32
v_sub_f32 v33, v33, v46
v_exp_f32 v37, v33
v_sub_f32 v34, v34, v46
v_exp_f32 v38, v34
v_sub_f32 v35, v35, v46
v_exp_f32 v39, v35
v_sub_f32 v76, v76, v46
v_exp_f32 v78, v76
v_sub_f32 v77, v77, v46
v_exp_f32 v79, v77
s_nop 0
v_cvt_pk_bf16_f32 v41, v78, v79
v_cvt_pk_bf16_f32 v42, v36, v37
v_cvt_pk_bf16_f32 v43, v38, v39
v_mov_b32_dpp v40, v41 row_ror:8 row_mask:0xf bank_mask:0xf
v_mov_b32_dpp v44, v42 row_ror:8 row_mask:0xf bank_mask:0xf
v_mov_b32_dpp v45, v43 row_ror:8 row_mask:0xf bank_mask:0xf
v_mfma_f32_16x16x16_bf16 v[216:219], v[92:93], v[40:41], 0
v_mfma_f32_16x16x16_bf16 v[220:223], v[94:95], v[40:41], 0
v_mfma_f32_16x16x32_bf16 v[80:83], v[88:91], v[40:43], 0
v_mfma_f32_16x16x32_bf16 v[216:219], v[64:67], v[42:45], v[216:219]
v_mfma_f32_16x16x32_bf16 v[220:223], v[68:71], v[42:45], v[220:223]
v_add_f32_dpp v80, v80, v80 row_ror:8 row_mask:0xf bank_mask:0xf
v_rcp_f32 v80, v80
s_nop 1
v_pk_mul_f32 v[216:217], v[216:217], v[80:81] op_sel_hi:[1,0]
v_pk_mul_f32 v[218:219], v[218:219], v[80:81] op_sel_hi:[1,0]
v_cvt_pk_bf16_f32 v216, v216, v217
v_cvt_pk_bf16_f32 v217, v218, v219
v_pk_mul_f32 v[220:221], v[220:221], v[80:81] op_sel_hi:[1,0]
v_pk_mul_f32 v[222:223], v[222:223], v[80:81] op_sel_hi:[1,0]
v_cvt_pk_bf16_f32 v218, v220, v221
v_cvt_pk_bf16_f32 v219, v222, v223
s_nop 0
v_mov_b32_dpp v218, v216 row_ror:8 row_mask:0xf bank_mask:0xc
v_mov_b32_dpp v219, v217 row_ror:8 row_mask:0xf bank_mask:0xc
ds_write_b64 v109, v[218:219] offset:1024
s_branch L_pv1
.p2alignl 12, 0xbf810000
.p2align 6
.fill 5, 4, 0xbf800000
L_top2:
s_waitcnt lgkmcnt(3)
v_smfmac_f32_16x16x64_bf16 v[32:35], v[0:3], v[224:231], v106
ds_read_b128 v[224:227], v99 offset:8192
v_smfmac_f32_16x16x64_bf16 v[36:39], v[0:3], a[0:7], v106
ds_read_b128 v[228:231], v99 offset:9216
v_smfmac_f32_16x16x64_bf16 v[40:43], v[0:3], a[8:15], v106
v_smfmac_f32_16x16x64_bf16 v[44:47], v[0:3], a[24:31], v106
s_waitcnt lgkmcnt(4)
v_smfmac_f32_16x16x64_bf16 v[32:35], v[4:7], v[232:239], v106
ds_read_b128 v[232:235], v99 offset:10240
v_smfmac_f32_16x16x64_bf16 v[36:39], v[4:7], a[40:47], v106
ds_read_b128 v[236:239], v99 offset:11264
v_smfmac_f32_16x16x64_bf16 v[40:43], v[4:7], a[48:55], v106
s_waitcnt vmcnt(2)
ds_write_b128 v102, v[216:219]
v_smfmac_f32_16x16x64_bf16 v[44:47], v[4:7], a[64:71], v106
ds_write_b128 v102, v[220:223] offset:1024
v_max_u32 v76, v216, v220
s_waitcnt lgkmcnt(7)
v_smfmac_f32_16x16x64_bf16 v[32:35], v[8:11], v[240:247], v106
v_cmp_eq_u32 vcc, -1, v76
v_smfmac_f32_16x16x64_bf16 v[36:39], v[8:11], a[80:87], v106
s_cbranch_vccnz L_rg_qk2
L_rg_qret2:
v_smfmac_f32_16x16x64_bf16 v[40:43], v[8:11], a[88:95], v106
s_waitcnt lgkmcnt(0)
s_barrier
ds_read_b128 v[16:19], v98 offset:4096
v_smfmac_f32_16x16x64_bf16 v[44:47], v[8:11], a[104:111], v106
ds_read_b128 v[20:23], v98 offset:5120
buffer_store_dwordx4 v[92:95], v102, s[4:7], s65 offen offset:1024 sc1
v_smfmac_f32_16x16x64_bf16 v[32:35], v[12:15], v[248:255], v106
ds_read_b128 v[24:27], v98 offset:6144
v_smfmac_f32_16x16x64_bf16 v[36:39], v[12:15], a[120:127], v106
ds_read_b128 v[28:31], v98 offset:7168
v_smfmac_f32_16x16x64_bf16 v[40:43], v[12:15], a[128:135], v106
ds_read_b128 v[240:243], v99 offset:12288
v_smfmac_f32_16x16x64_bf16 v[44:47], v[12:15], a[144:151], v106
ds_read_b128 v[244:247], v99 offset:13312
s_waitcnt lgkmcnt(5)
v_smfmac_f32_16x16x64_bf16 v[32:35], v[16:19], v[224:231], v106
ds_read_b128 v[248:251], v99 offset:18432
v_smfmac_f32_16x16x64_bf16 v[36:39], v[16:19], v[112:119], v106
ds_read_b128 v[252:255], v99 offset:19456
v_smfmac_f32_16x16x64_bf16 v[40:43], v[16:19], a[160:167], v106
ds_read_b128 v[224:227], v99 offset:14336
v_smfmac_f32_16x16x64_bf16 v[44:47], v[16:19], a[176:183], v106
ds_read_b128 v[228:231], v99 offset:15360
s_waitcnt lgkmcnt(8)
v_smfmac_f32_16x16x64_bf16 v[32:35], v[20:23], v[232:239], v106
ds_read_b128 v[232:235], v99 offset:16384
v_smfmac_f32_16x16x64_bf16 v[36:39], v[20:23], v[120:127], v106
ds_read_b128 v[236:239], v99 offset:17408
v_smfmac_f32_16x16x64_bf16 v[40:43], v[20:23], a[192:199], v106
v_smfmac_f32_16x16x64_bf16 v[44:47], v[20:23], a[208:215], v106
s_mov_b64 exec, s[84:85]
buffer_store_dwordx4 v[72:75], v102, s[4:7], s65 offen sc1
s_mov_b64 exec, -1
s_waitcnt lgkmcnt(9)
s_waitcnt lgkmcnt(6)
v_smfmac_f32_16x16x64_bf16 v[32:35], v[24:27], v[240:247], v106
ds_read_b128 v[240:243], v99 offset:20480
v_smfmac_f32_16x16x64_bf16 v[40:43], v[24:27], a[224:231], v106
ds_read_b128 v[244:247], v99 offset:21504
s_waitcnt lgkmcnt(6)
v_smfmac_f32_16x16x64_bf16 v[32:35], v[28:31], v[248:255], v106
ds_read_b128 v[248:251], v99 offset:22528
v_smfmac_f32_16x16x64_bf16 v[40:43], v[28:31], a[240:247], v106
ds_read_b128 v[252:255], v99 offset:23552
v_smfmac_f32_16x16x64_bf16 v[36:39], v[24:27], v[128:135], v106
v_cvt_pk_bf16_f32 v32, v32, v33
v_smfmac_f32_16x16x64_bf16 v[44:47], v[24:27], a[232:239], v106
v_cvt_pk_bf16_f32 v33, v34, v35
v_smfmac_f32_16x16x64_bf16 v[36:39], v[28:31], v[136:143], v106
v_cvt_pk_bf16_f32 v34, v40, v41
v_smfmac_f32_16x16x64_bf16 v[44:47], v[28:31], a[248:255], v106
s_barrier
v_cvt_pk_bf16_f32 v35, v42, v43
s_waitcnt lgkmcnt(6)
v_smfmac_f32_16x16x64_bf16 v[48:51], v[24:27], v[224:231], v106
ds_read_b128 v[224:227], v99 offset:24576
v_cvt_pk_bf16_f32 v36, v36, v37
v_mfma_f32_16x16x32_bf16 v[40:43], v[32:35], v[84:87], 0
ds_read_b128 v[228:231], v99 offset:25600
v_cvt_pk_bf16_f32 v37, v38, v39
v_cvt_pk_bf16_f32 v38, v44, v45
s_waitcnt lgkmcnt(6)
v_smfmac_f32_16x16x64_bf16 v[52:55], v[24:27], v[232:239], v106
ds_read_b128 v[232:235], v99 offset:26624
v_cvt_pk_bf16_f32 v39, v46, v47
s_nop 1
v_mfma_f32_16x16x32_bf16 v[44:47], v[36:39], v[84:87], 0
ds_read_b128 v[236:239], v99 offset:27648
v_cvt_pk_bf16_f32 v72, v40, v41
v_cvt_pk_bf16_f32 v73, v42, v43
s_waitcnt lgkmcnt(6)
v_smfmac_f32_16x16x64_bf16 v[48:51], v[28:31], v[240:247], v106
ds_read_b128 v[240:243], v99 offset:28672
s_waitcnt lgkmcnt(5)
v_smfmac_f32_16x16x64_bf16 v[52:55], v[28:31], v[248:255], v106
ds_read_b128 v[244:247], v99 offset:29696
v_cvt_pk_bf16_f32 v74, v44, v45
v_cvt_pk_bf16_f32 v75, v46, v47
s_nop 1
v_mfma_f32_16x16x32_bf16 v[40:43], v[72:75], v[72:75], 0
ds_read_b128 v[248:251], v99 offset:30720
v_mfma_f32_16x16x32_bf16 v[32:35], v[56:59], v[72:75], 0
ds_read_b128 v[252:255], v99 offset:31744
v_mfma_f32_16x16x32_bf16 v[36:39], v[60:63], v[72:75], 0
v_mov_b32_dpp v40, v42 row_ror:8 row_mask:0xf bank_mask:0xc
v_mov_b32_dpp v41, v43 row_ror:8 row_mask:0xf bank_mask:0xc
ds_write_b64 v107, v[40:41] offset:1152
v_smfmac_f32_16x16x64_bf16 v[48:51], v[0:3], a[16:23], v106
s_nop 1
s_nop 1
v_mov_b32_dpp v32, v36 row_ror:8 row_mask:0xf bank_mask:0xc
v_mov_b32_dpp v33, v37 row_ror:8 row_mask:0xf bank_mask:0xc
v_mov_b32_dpp v34, v38 row_ror:8 row_mask:0xf bank_mask:0xc
v_mov_b32_dpp v35, v39 row_ror:8 row_mask:0xf bank_mask:0xc
ds_write_b128 v102, v[32:35]
v_smfmac_f32_16x16x64_bf16 v[48:51], v[4:7], a[56:63], v106
s_add_u32 s64, s64, 0x40000
s_add_u32 s75, s64, 16777216
v_smfmac_f32_16x16x64_bf16 v[48:51], v[8:11], a[96:103], v106
buffer_load_dwordx4 v[56:59], v102, s[4:7], s64 offen offset:0 sc1
v_smfmac_f32_16x16x64_bf16 v[48:51], v[12:15], a[136:143], v106
buffer_load_dwordx4 v[60:63], v102, s[4:7], s64 offen offset:1024 sc1
v_smfmac_f32_16x16x64_bf16 v[48:51], v[16:19], a[168:175], v106
s_waitcnt lgkmcnt(0)
s_barrier
ds_read_b64 v[76:77], v100 offset:0
v_smfmac_f32_16x16x64_bf16 v[48:51], v[20:23], a[200:207], v106
ds_read_b64 v[78:79], v100 offset:2048
v_smfmac_f32_16x16x64_bf16 v[52:55], v[0:3], a[32:39], v106
ds_read_b64 v[80:81], v100 offset:4096
v_smfmac_f32_16x16x64_bf16 v[52:55], v[4:7], a[72:79], v106
ds_read_b64 v[82:83], v100 offset:6144
v_smfmac_f32_16x16x64_bf16 v[52:55], v[8:11], a[112:119], v106
v_cvt_pk_bf16_f32 v92, v48, v49
ds_read_b128 v[32:35], v98 offset:0
v_smfmac_f32_16x16x64_bf16 v[52:55], v[12:15], a[152:159], v106
v_cvt_pk_bf16_f32 v93, v50, v51
ds_read_b128 v[36:39], v98 offset:2048
v_smfmac_f32_16x16x64_bf16 v[52:55], v[16:19], a[184:191], v106
ds_read_b128 v[216:219], v98 offset:4096
v_smfmac_f32_16x16x64_bf16 v[52:55], v[20:23], a[216:223], v106
ds_read_b128 v[220:223], v98 offset:6144
s_waitcnt lgkmcnt(6)
v_pk_mul_f32 v[76:77], s[72:73], v[76:77] op_sel_hi:[0,1]
v_pk_fma_f32 v[76:77], s[72:73], v[78:79], v[76:77] op_sel_hi:[0,1,1]
s_waitcnt lgkmcnt(4)
v_pk_fma_f32 v[76:77], s[72:73], v[80:81], v[76:77] op_sel_hi:[0,1,1]
v_pk_fma_f32 v[76:77], s[72:73], v[82:83], v[76:77] op_sel_hi:[0,1,1]
v_exp_f32 v78, v76
v_exp_f32 v79, v77
v_cvt_pk_bf16_f32 v94, v52, v53
v_cvt_pk_bf16_f32 v41, v78, v79
v_cvt_pk_bf16_f32 v95, v54, v55
s_waitcnt lgkmcnt(3)
v_pk_mul_f32 v[32:33], s[72:73], v[32:33] op_sel_hi:[0,1]
v_mov_b32_dpp v40, v41 row_ror:8 row_mask:0xf bank_mask:0xf
v_pk_mul_f32 v[34:35], s[72:73], v[34:35] op_sel_hi:[0,1]
s_waitcnt lgkmcnt(2)
v_pk_fma_f32 v[32:33], s[72:73], v[36:37], v[32:33] op_sel_hi:[0,1,1]
v_pk_fma_f32 v[34:35], s[72:73], v[38:39], v[34:35] op_sel_hi:[0,1,1]
s_waitcnt lgkmcnt(1)
v_pk_fma_f32 v[32:33], s[72:73], v[216:217], v[32:33] op_sel_hi:[0,1,1]
v_pk_fma_f32 v[34:35], s[72:73], v[218:219], v[34:35] op_sel_hi:[0,1,1]
s_waitcnt lgkmcnt(0)
v_pk_fma_f32 v[32:33], s[72:73], v[220:221], v[32:33] op_sel_hi:[0,1,1]
v_pk_fma_f32 v[34:35], s[72:73], v[222:223], v[34:35] op_sel_hi:[0,1,1]
v_mfma_f32_16x16x16_bf16 v[216:219], v[92:93], v[40:41], 0
v_exp_f32 v36, v32
v_exp_f32 v37, v33
v_mfma_f32_16x16x16_bf16 v[220:223], v[94:95], v[40:41], 0
v_exp_f32 v38, v34
v_exp_f32 v39, v35
v_cvt_pk_bf16_f32 v42, v36, v37
v_cvt_pk_bf16_f32 v43, v38, v39
v_max3_f32 v46, |v32|, |v33|, |v34|
v_mov_b32_dpp v44, v42 row_ror:8 row_mask:0xf bank_mask:0xf
v_mov_b32_dpp v45, v43 row_ror:8 row_mask:0xf bank_mask:0xf
v_mfma_f32_16x16x32_bf16 v[80:83], v[88:91], v[40:43], 0
v_max3_f32 v46, v46, |v35|, |v76|
v_max_f32 v46, v46, |v77|
s_waitcnt vmcnt(4)
v_mfma_f32_16x16x32_bf16 v[216:219], v[64:67], v[42:45], v[216:219]
v_cmp_lt_f32 vcc, s77, v46
v_mov_b64 v[16:17], 0
v_mfma_f32_16x16x32_bf16 v[220:223], v[68:71], v[42:45], v[220:223]
v_add_f32_dpp v80, v80, v80 row_ror:8 row_mask:0xf bank_mask:0xf
v_rcp_f32 v80, v80
v_mov_b64 v[18:19], 0
v_mov_b64 v[20:21], 0
v_pk_mul_f32 v[216:217], v[216:217], v[80:81] op_sel_hi:[1,0]
v_pk_mul_f32 v[218:219], v[218:219], v[80:81] op_sel_hi:[1,0]
v_cvt_pk_bf16_f32 v216, v216, v217
v_cvt_pk_bf16_f32 v217, v218, v219
v_pk_mul_f32 v[220:221], v[220:221], v[80:81] op_sel_hi:[1,0]
v_pk_mul_f32 v[222:223], v[222:223], v[80:81] op_sel_hi:[1,0]
v_cvt_pk_bf16_f32 v218, v220, v221
v_cvt_pk_bf16_f32 v219, v222, v223
v_mov_b64 v[22:23], 0
v_mov_b32_dpp v218, v216 row_ror:8 row_mask:0xf bank_mask:0xc
v_mov_b32_dpp v219, v217 row_ror:8 row_mask:0xf bank_mask:0xc
ds_write_b64 v109, v[218:219] offset:1024
s_cbranch_vccnz L_max2
L_pv2:
v_mov_b64 v[24:25], 0
v_mov_b64 v[26:27], 0
v_mov_b64 v[28:29], 0
v_mov_b64_e64 v[30:31], 0
s_waitcnt lgkmcnt(0)
s_barrier
ds_read_b128 v[0:3], v101 offset:0
ds_read_b128 v[4:7], v101 offset:2048
ds_read_b128 v[8:11], v101 offset:4096
ds_read_b128 v[12:15], v101 offset:6144
s_mov_b32 s74, s63
s_xor_b32 s63, s63, 8192
s_waitcnt lgkmcnt(3)
v_smfmac_f32_16x16x64_bf16 v[16:19], v[0:3], v[224:231], v106
v_smfmac_f32_16x16x64_bf16 v[20:23], v[0:3], v[144:151], v106
s_waitcnt lgkmcnt(2)
v_smfmac_f32_16x16x64_bf16 v[16:19], v[4:7], v[232:239], v106
ds_read_b128 v[232:235], v99 offset:32768
v_smfmac_f32_16x16x64_bf16 v[20:23], v[4:7], v[152:159], v106
ds_read_b128 v[236:239], v99 offset:33792
s_waitcnt lgkmcnt(3)
v_smfmac_f32_16x16x64_bf16 v[16:19], v[8:11], v[240:247], v106
ds_read_b128 v[240:243], v99 offset:34816
v_smfmac_f32_16x16x64_bf16 v[20:23], v[8:11], v[160:167], v106
ds_read_b128 v[244:247], v99 offset:35840
s_waitcnt lgkmcnt(4)
v_smfmac_f32_16x16x64_bf16 v[16:19], v[12:15], v[248:255], v106
ds_read_b128 v[248:251], v99 offset:36864
v_smfmac_f32_16x16x64_bf16 v[20:23], v[12:15], v[168:175], v106
ds_read_b128 v[252:255], v99 offset:37888
v_smfmac_f32_16x16x64_bf16 v[24:27], v[0:3], v[176:183], v106
v_smfmac_f32_16x16x64_bf16 v[28:31], v[0:3], v[208:215], v106
v_cvt_pk_bf16_f32 v16, v16, v20
v_cvt_pk_bf16_f32 v17, v17, v21
v_bfi_b32 v16, 1, s76, v16
v_cvt_pk_bf16_f32 v18, v18, v22
v_cvt_pk_bf16_f32 v19, v19, v23
buffer_store_dwordx4 v[16:19], v96, s[4:7], s60 offen
v_smfmac_f32_16x16x64_bf16 v[24:27], v[4:7], v[184:191], v106
s_waitcnt lgkmcnt(4)
v_smfmac_f32_16x16x64_bf16 v[28:31], v[4:7], v[232:239], v106
v_smfmac_f32_16x16x64_bf16 v[24:27], v[8:11], v[192:199], v106
s_waitcnt lgkmcnt(2)
v_smfmac_f32_16x16x64_bf16 v[28:31], v[8:11], v[240:247], v106
v_smfmac_f32_16x16x64_bf16 v[24:27], v[12:15], v[200:207], v106
s_waitcnt lgkmcnt(0)
v_smfmac_f32_16x16x64_bf16 v[28:31], v[12:15], v[248:255], v106
v_mov_b64 v[76:77], s[86:87]
v_mov_b64 v[78:79], s[86:87]
v_mov_b64 v[80:81], 0
v_mov_b64 v[82:83], 0
s_nop 3
v_cvt_pk_bf16_f32 v24, v24, v28
v_cvt_pk_bf16_f32 v25, v25, v29
v_bfi_b32 v24, 1, s76, v24
v_cvt_pk_bf16_f32 v26, v26, v30
v_cvt_pk_bf16_f32 v27, v27, v31
buffer_store_dwordx4 v[24:27], v96, s[4:7], s61 offen
v_mov_b64 v[32:33], 0
v_mov_b64 v[34:35], 0
v_mov_b64 v[36:37], 0
v_mov_b64 v[38:39], 0
v_mov_b64 v[40:41], 0
v_mov_b64 v[42:43], 0
v_mov_b64 v[44:45], 0
v_mov_b64 v[46:47], 0
v_mov_b64 v[48:49], 0
v_mov_b64 v[50:51], 0
v_mov_b64 v[52:53], 0
v_mov_b64 v[54:55], 0
s_nop 15
s_nop 15
s_nop 3
s_nop 4
buffer_load_dword v216, v104, s[4:7], s62 offen offset:0 sc1
buffer_load_dword v217, v104, s[4:7], s62 offen offset:256 sc1
buffer_load_dword v218, v104, s[4:7], s62 offen offset:512 sc1
buffer_load_dword v219, v104, s[4:7], s62 offen offset:768 sc1
buffer_load_dword v220, v104, s[4:7], s62 offen offset:1024 sc1
buffer_load_dword v221, v104, s[4:7], s62 offen offset:1280 sc1
buffer_load_dword v222, v104, s[4:7], s62 offen offset:1536 sc1
buffer_load_dword v223, v104, s[4:7], s62 offen offset:1792 sc1
ds_read_b128 v[224:227], v99 offset:0
ds_read_b128 v[228:231], v99 offset:1024
ds_read_b128 v[232:235], v99 offset:2048
ds_read_b128 v[236:239], v99 offset:3072
ds_read_b128 v[240:243], v99 offset:4096
ds_read_b128 v[244:247], v99 offset:5120
ds_read_b128 v[248:251], v99 offset:6144
ds_read_b128 v[252:255], v99 offset:7168
s_xor_b32 s60, s60, 0x40000
s_xor_b32 s61, s61, 0x40000
s_add_u32 s65, s65, 0x40000
s_add_u32 s68, s68, 1
s_mov_b32 s57, 0
s_waitcnt vmcnt(5)
v_bitop3_b32 v0, v216, v217, v218 bitop3:0x7e
s_waitcnt vmcnt(3)
v_bitop3_b32 v1, v218, v219, v220 bitop3:0x7e
s_waitcnt vmcnt(1)
v_bitop3_b32 v2, v220, v221, v222 bitop3:0x7e
v_or3_b32 v0, v0, v1, v2
s_waitcnt vmcnt(0)
v_smfmac_f32_16x16x64_bf16 v[80:83], v[76:79], v[216:223], v110
v_bitop3_b32 v3, v222, v223, s76 bitop3:0x7e
v_bitop3_b32 v0, v0, v111, v3 bitop3:0xc8
v_cmp_ne_u32 vcc, 0, v0
s_nop 3
s_cbranch_vccnz L_repoll2
v_cvt_pk_bf16_f32 v80, v80, v81
L_sum2:
buffer_store_dword v80, v97, s[4:7], s63 offen
v_mov_b32 v83, -1
s_xor_b32 s62, s62, 0x40000
s_bitcmp1_b32 s68, 1
s_cselect_b32 s76, -1, 0
buffer_store_dword v83, v97, s[4:7], s74 offen
s_cmp_lt_u32 s68, 63
s_waitcnt lgkmcnt(0)
s_barrier
buffer_load_dwordx4 v[216:219], v102, s[4:7], s63 offen sc1
buffer_load_dwordx4 v[220:223], v102, s[4:7], s63 offen offset:1024 sc1
s_barrier
ds_read_b128 v[0:3], v98 offset:0
ds_read_b128 v[4:7], v98 offset:1024
ds_read_b128 v[8:11], v98 offset:2048
ds_read_b128 v[12:15], v98 offset:3072
buffer_load_dwordx4 v[64:67], v102, s[4:7], s75 offen offset:0 sc1
buffer_load_dwordx4 v[68:71], v102, s[4:7], s75 offen offset:1024 sc1
s_cbranch_scc1 L_top2
s_branch L_final23
L_rg_qk2:
s_mov_b32 s57, 0
s_mov_b64 exec, vcc
buffer_load_dwordx4 v[216:219], v102, s[4:7], s63 offen sc1
buffer_load_dwordx4 v[220:223], v102, s[4:7], s63 offen offset:1024 sc1
s_branch L_rgw_qk2
L_rgl_qk2:
s_mov_b64 exec, vcc
buffer_load_dwordx4 v[216:219], v102, s[4:7], s63 offen sc1
buffer_load_dwordx4 v[220:223], v102, s[4:7], s63 offen offset:1024 sc1
s_add_u32 s57, s57, 0x2000
s_cbranch_scc1 L_end
L_rgw_qk2:
s_waitcnt vmcnt(0)
v_max3_u32 v76, v216, v217, v218
v_max3_u32 v77, v219, v220, v221
v_max3_u32 v76, v76, v222, v223
v_max_u32 v76, v76, v77
v_cmp_eq_u32 vcc, -1, v76
s_cbranch_vccnz L_rgl_qk2
s_mov_b64 exec, -1
ds_write_b128 v102, v[216:219]
ds_write_b128 v102, v[220:223] offset:1024
s_branch L_rg_qret2
L_repoll2:
s_lshl_b64 s[88:89], vcc, 1
s_or_b64 vcc, vcc, s[88:89]
s_lshl_b64 s[88:89], vcc, 2
s_or_b64 exec, vcc, s[88:89]
buffer_load_dword v216, v104, s[4:7], s62 offen offset:0 sc1
buffer_load_dword v217, v104, s[4:7], s62 offen offset:256 sc1
buffer_load_dword v218, v104, s[4:7], s62 offen offset:512 sc1
buffer_load_dword v219, v104, s[4:7], s62 offen offset:768 sc1
buffer_load_dword v220, v104, s[4:7], s62 offen offset:1024 sc1
buffer_load_dword v221, v104, s[4:7], s62 offen offset:1280 sc1
buffer_load_dword v222, v104, s[4:7], s62 offen offset:1536 sc1
buffer_load_dword v223, v104, s[4:7], s62 offen offset:1792 sc1
s_mov_b64 exec, -1
v_mov_b64 v[80:81], 0
v_mov_b64 v[82:83], 0
s_add_u32 s57, s57, 0x2000
s_cbranch_scc1 L_end
s_waitcnt vmcnt(0)
v_smfmac_f32_16x16x64_bf16 v[80:83], v[76:79], v[216:223], v110
v_bitop3_b32 v0, v216, v217, v218 bitop3:0x7e
v_bitop3_b32 v1, v218, v219, v220 bitop3:0x7e
v_bitop3_b32 v2, v220, v221, v222 bitop3:0x7e
v_bitop3_b32 v3, v222, v223, s76 bitop3:0x7e
v_or3_b32 v0, v0, v1, v2
v_bitop3_b32 v0, v0, v111, v3 bitop3:0xc8
v_cmp_ne_u32 vcc, 0, v0
s_nop 0
v_cvt_pk_bf16_f32 v80, v80, v81
s_cbranch_vccz L_sum2
s_branch L_repoll2
L_max2:
v_max3_f32 v46, v32, v33, v34
v_max3_f32 v47, v35, v76, v77
v_max_f32 v46, v46, v47
s_nop 1
v_max_f32_dpp v46, v46, v46 row_ror:8 row_mask:0xf bank_mask:0xf
v_mov_b32 v47, v46
s_nop 1
v_permlane16_swap_b32 v46, v47
v_max_f32 v46, v46, v47
v_mov_b32 v47, v46
s_nop 1
v_permlane32_swap_b32 v46, v47
v_max_f32 v46, v46, v47
v_sub_f32 v32, v32, v46
v_exp_f32 v36, v32
v_sub_f32 v33, v33, v46
v_exp_f32 v37, v33
v_sub_f32 v34, v34, v46
v_exp_f32 v38, v34
v_sub_f32 v35, v35, v46
v_exp_f32 v39, v35
v_sub_f32 v76, v76, v46
v_exp_f32 v78, v76
v_sub_f32 v77, v77, v46
v_exp_f32 v79, v77
s_nop 0
v_cvt_pk_bf16_f32 v41, v78, v79
v_cvt_pk_bf16_f32 v42, v36, v37
v_cvt_pk_bf16_f32 v43, v38, v39
v_mov_b32_dpp v40, v41 row_ror:8 row_mask:0xf bank_mask:0xf
v_mov_b32_dpp v44, v42 row_ror:8 row_mask:0xf bank_mask:0xf
v_mov_b32_dpp v45, v43 row_ror:8 row_mask:0xf bank_mask:0xf
v_mfma_f32_16x16x16_bf16 v[216:219], v[92:93], v[40:41], 0
v_mfma_f32_16x16x16_bf16 v[220:223], v[94:95], v[40:41], 0
v_mfma_f32_16x16x32_bf16 v[80:83], v[88:91], v[40:43], 0
v_mfma_f32_16x16x32_bf16 v[216:219], v[64:67], v[42:45], v[216:219]
v_mfma_f32_16x16x32_bf16 v[220:223], v[68:71], v[42:45], v[220:223]
v_add_f32_dpp v80, v80, v80 row_ror:8 row_mask:0xf bank_mask:0xf
v_rcp_f32 v80, v80
s_nop 1
v_pk_mul_f32 v[216:217], v[216:217], v[80:81] op_sel_hi:[1,0]
v_pk_mul_f32 v[218:219], v[218:219], v[80:81] op_sel_hi:[1,0]
v_cvt_pk_bf16_f32 v216, v216, v217
v_cvt_pk_bf16_f32 v217, v218, v219
v_pk_mul_f32 v[220:221], v[220:221], v[80:81] op_sel_hi:[1,0]
v_pk_mul_f32 v[222:223], v[222:223], v[80:81] op_sel_hi:[1,0]
v_cvt_pk_bf16_f32 v218, v220, v221
v_cvt_pk_bf16_f32 v219, v222, v223
s_nop 0
v_mov_b32_dpp v218, v216 row_ror:8 row_mask:0xf bank_mask:0xc
v_mov_b32_dpp v219, v217 row_ror:8 row_mask:0xf bank_mask:0xc
ds_write_b64 v109, v[218:219] offset:1024
s_branch L_pv2
.p2alignl 12, 0xbf810000
.p2align 6
.fill 5, 4, 0xbf800000
L_top3:
s_waitcnt lgkmcnt(3)
v_smfmac_f32_16x16x64_bf16 v[32:35], v[0:3], v[224:231], v106
ds_read_b128 v[224:227], v99 offset:8192
v_smfmac_f32_16x16x64_bf16 v[36:39], v[0:3], a[0:7], v106
ds_read_b128 v[228:231], v99 offset:9216
v_smfmac_f32_16x16x64_bf16 v[40:43], v[0:3], a[8:15], v106
v_smfmac_f32_16x16x64_bf16 v[44:47], v[0:3], a[24:31], v106
s_waitcnt lgkmcnt(4)
v_smfmac_f32_16x16x64_bf16 v[32:35], v[4:7], v[232:239], v106
ds_read_b128 v[232:235], v99 offset:10240
v_smfmac_f32_16x16x64_bf16 v[36:39], v[4:7], a[40:47], v106
ds_read_b128 v[236:239], v99 offset:11264
v_smfmac_f32_16x16x64_bf16 v[40:43], v[4:7], a[48:55], v106
s_waitcnt vmcnt(2)
ds_write_b128 v102, v[216:219]
v_smfmac_f32_16x16x64_bf16 v[44:47], v[4:7], a[64:71], v106
ds_write_b128 v102, v[220:223] offset:1024
v_max_u32 v76, v216, v220
s_waitcnt lgkmcnt(7)
v_smfmac_f32_16x16x64_bf16 v[32:35], v[8:11], v[240:247], v106
v_cmp_eq_u32 vcc, -1, v76
v_smfmac_f32_16x16x64_bf16 v[36:39], v[8:11], a[80:87], v106
s_cbranch_vccnz L_rg_qk3
L_rg_qret3:
v_smfmac_f32_16x16x64_bf16 v[40:43], v[8:11], a[88:95], v106
s_waitcnt lgkmcnt(0)
s_barrier
ds_read_b128 v[16:19], v98 offset:4096
v_smfmac_f32_16x16x64_bf16 v[44:47], v[8:11], a[104:111], v106
ds_read_b128 v[20:23], v98 offset:5120
buffer_store_dwordx4 v[92:95], v102, s[4:7], s65 offen offset:1024 sc1
v_smfmac_f32_16x16x64_bf16 v[32:35], v[12:15], v[248:255], v106
ds_read_b128 v[24:27], v98 offset:6144
v_smfmac_f32_16x16x64_bf16 v[36:39], v[12:15], a[120:127], v106
ds_read_b128 v[28:31], v98 offset:7168
v_smfmac_f32_16x16x64_bf16 v[40:43], v[12:15], a[128:135], v106
ds_read_b128 v[240:243], v99 offset:12288
v_smfmac_f32_16x16x64_bf16 v[44:47], v[12:15], a[144:151], v106
ds_read_b128 v[244:247], v99 offset:13312
s_waitcnt lgkmcnt(5)
v_smfmac_f32_16x16x64_bf16 v[32:35], v[16:19], v[224:231], v106
ds_read_b128 v[248:251], v99 offset:18432
v_smfmac_f32_16x16x64_bf16 v[36:39], v[16:19], v[112:119], v106
ds_read_b128 v[252:255], v99 offset:19456
v_smfmac_f32_16x16x64_bf16 v[40:43], v[16:19], a[160:167], v106
ds_read_b128 v[224:227], v99 offset:14336
v_smfmac_f32_16x16x64_bf16 v[44:47], v[16:19], a[176:183], v106
ds_read_b128 v[228:231], v99 offset:15360
s_waitcnt lgkmcnt(8)
v_smfmac_f32_16x16x64_bf16 v[32:35], v[20:23], v[232:239], v106
ds_read_b128 v[232:235], v99 offset:16384
v_smfmac_f32_16x16x64_bf16 v[36:39], v[20:23], v[120:127], v106
ds_read_b128 v[236:239], v99 offset:17408
v_smfmac_f32_16x16x64_bf16 v[40:43], v[20:23], a[192:199], v106
v_smfmac_f32_16x16x64_bf16 v[44:47], v[20:23], a[208:215], v106
s_mov_b64 exec, s[84:85]
buffer_store_dwordx4 v[72:75], v102, s[4:7], s65 offen sc1
s_mov_b64 exec, -1
s_waitcnt lgkmcnt(9)
s_waitcnt lgkmcnt(6)
v_smfmac_f32_16x16x64_bf16 v[32:35], v[24:27], v[240:247], v106
ds_read_b128 v[240:243], v99 offset:20480
v_smfmac_f32_16x16x64_bf16 v[40:43], v[24:27], a[224:231], v106
ds_read_b128 v[244:247], v99 offset:21504
s_waitcnt lgkmcnt(6)
v_smfmac_f32_16x16x64_bf16 v[32:35], v[28:31], v[248:255], v106
ds_read_b128 v[248:251], v99 offset:22528
v_smfmac_f32_16x16x64_bf16 v[40:43], v[28:31], a[240:247], v106
ds_read_b128 v[252:255], v99 offset:23552
v_smfmac_f32_16x16x64_bf16 v[36:39], v[24:27], v[128:135], v106
v_cvt_pk_bf16_f32 v32, v32, v33
v_smfmac_f32_16x16x64_bf16 v[44:47], v[24:27], a[232:239], v106
v_cvt_pk_bf16_f32 v33, v34, v35
v_smfmac_f32_16x16x64_bf16 v[36:39], v[28:31], v[136:143], v106
v_cvt_pk_bf16_f32 v34, v40, v41
v_smfmac_f32_16x16x64_bf16 v[44:47], v[28:31], a[248:255], v106
s_barrier
v_cvt_pk_bf16_f32 v35, v42, v43
s_waitcnt lgkmcnt(6)
v_smfmac_f32_16x16x64_bf16 v[48:51], v[24:27], v[224:231], v106
ds_read_b128 v[224:227], v99 offset:24576
v_cvt_pk_bf16_f32 v36, v36, v37
v_mfma_f32_16x16x32_bf16 v[40:43], v[32:35], v[84:87], 0
ds_read_b128 v[228:231], v99 offset:25600
v_cvt_pk_bf16_f32 v37, v38, v39
v_cvt_pk_bf16_f32 v38, v44, v45
s_waitcnt lgkmcnt(6)
v_smfmac_f32_16x16x64_bf16 v[52:55], v[24:27], v[232:239], v106
ds_read_b128 v[232:235], v99 offset:26624
v_cvt_pk_bf16_f32 v39, v46, v47
s_nop 1
v_mfma_f32_16x16x32_bf16 v[44:47], v[36:39], v[84:87], 0
ds_read_b128 v[236:239], v99 offset:27648
v_cvt_pk_bf16_f32 v72, v40, v41
v_cvt_pk_bf16_f32 v73, v42, v43
s_waitcnt lgkmcnt(6)
v_smfmac_f32_16x16x64_bf16 v[48:51], v[28:31], v[240:247], v106
ds_read_b128 v[240:243], v99 offset:28672
s_waitcnt lgkmcnt(5)
v_smfmac_f32_16x16x64_bf16 v[52:55], v[28:31], v[248:255], v106
ds_read_b128 v[244:247], v99 offset:29696
v_cvt_pk_bf16_f32 v74, v44, v45
v_cvt_pk_bf16_f32 v75, v46, v47
s_nop 1
v_mfma_f32_16x16x32_bf16 v[40:43], v[72:75], v[72:75], 0
ds_read_b128 v[248:251], v99 offset:30720
v_mfma_f32_16x16x32_bf16 v[32:35], v[56:59], v[72:75], 0
ds_read_b128 v[252:255], v99 offset:31744
v_mfma_f32_16x16x32_bf16 v[36:39], v[60:63], v[72:75], 0
v_mov_b32_dpp v40, v42 row_ror:8 row_mask:0xf bank_mask:0xc
v_mov_b32_dpp v41, v43 row_ror:8 row_mask:0xf bank_mask:0xc
ds_write_b64 v107, v[40:41] offset:1152
v_smfmac_f32_16x16x64_bf16 v[48:51], v[0:3], a[16:23], v106
s_nop 1
s_nop 1
v_mov_b32_dpp v32, v36 row_ror:8 row_mask:0xf bank_mask:0xc
v_mov_b32_dpp v33, v37 row_ror:8 row_mask:0xf bank_mask:0xc
v_mov_b32_dpp v34, v38 row_ror:8 row_mask:0xf bank_mask:0xc
v_mov_b32_dpp v35, v39 row_ror:8 row_mask:0xf bank_mask:0xc
ds_write_b128 v102, v[32:35]
v_smfmac_f32_16x16x64_bf16 v[48:51], v[4:7], a[56:63], v106
s_add_u32 s64, s64, 0x40000
s_add_u32 s75, s64, 16777216
v_smfmac_f32_16x16x64_bf16 v[48:51], v[8:11], a[96:103], v106
buffer_load_dwordx4 v[56:59], v102, s[4:7], s64 offen offset:0 sc1
v_smfmac_f32_16x16x64_bf16 v[48:51], v[12:15], a[136:143], v106
buffer_load_dwordx4 v[60:63], v102, s[4:7], s64 offen offset:1024 sc1
v_smfmac_f32_16x16x64_bf16 v[48:51], v[16:19], a[168:175], v106
s_waitcnt lgkmcnt(0)
s_barrier
ds_read_b64 v[76:77], v100 offset:0
v_smfmac_f32_16x16x64_bf16 v[48:51], v[20:23], a[200:207], v106
ds_read_b64 v[78:79], v100 offset:2048
v_smfmac_f32_16x16x64_bf16 v[52:55], v[0:3], a[32:39], v106
ds_read_b64 v[80:81], v100 offset:4096
v_smfmac_f32_16x16x64_bf16 v[52:55], v[4:7], a[72:79], v106
ds_read_b64 v[82:83], v100 offset:6144
v_smfmac_f32_16x16x64_bf16 v[52:55], v[8:11], a[112:119], v106
v_cvt_pk_bf16_f32 v92, v48, v49
ds_read_b128 v[32:35], v98 offset:0
v_smfmac_f32_16x16x64_bf16 v[52:55], v[12:15], a[152:159], v106
v_cvt_pk_bf16_f32 v93, v50, v51
ds_read_b128 v[36:39], v98 offset:2048
v_smfmac_f32_16x16x64_bf16 v[52:55], v[16:19], a[184:191], v106
ds_read_b128 v[216:219], v98 offset:4096
v_smfmac_f32_16x16x64_bf16 v[52:55], v[20:23], a[216:223], v106
ds_read_b128 v[220:223], v98 offset:6144
s_waitcnt lgkmcnt(6)
v_pk_mul_f32 v[76:77], s[72:73], v[76:77] op_sel_hi:[0,1]
v_pk_fma_f32 v[76:77], s[72:73], v[78:79], v[76:77] op_sel_hi:[0,1,1]
s_waitcnt lgkmcnt(4)
v_pk_fma_f32 v[76:77], s[72:73], v[80:81], v[76:77] op_sel_hi:[0,1,1]
v_pk_fma_f32 v[76:77], s[72:73], v[82:83], v[76:77] op_sel_hi:[0,1,1]
v_exp_f32 v78, v76
v_exp_f32 v79, v77
v_cvt_pk_bf16_f32 v94, v52, v53
v_cvt_pk_bf16_f32 v41, v78, v79
v_cvt_pk_bf16_f32 v95, v54, v55
s_waitcnt lgkmcnt(3)
v_pk_mul_f32 v[32:33], s[72:73], v[32:33] op_sel_hi:[0,1]
v_mov_b32_dpp v40, v41 row_ror:8 row_mask:0xf bank_mask:0xf
v_pk_mul_f32 v[34:35], s[72:73], v[34:35] op_sel_hi:[0,1]
s_waitcnt lgkmcnt(2)
v_pk_fma_f32 v[32:33], s[72:73], v[36:37], v[32:33] op_sel_hi:[0,1,1]
v_pk_fma_f32 v[34:35], s[72:73], v[38:39], v[34:35] op_sel_hi:[0,1,1]
s_waitcnt lgkmcnt(1)
v_pk_fma_f32 v[32:33], s[72:73], v[216:217], v[32:33] op_sel_hi:[0,1,1]
v_pk_fma_f32 v[34:35], s[72:73], v[218:219], v[34:35] op_sel_hi:[0,1,1]
s_waitcnt lgkmcnt(0)
v_pk_fma_f32 v[32:33], s[72:73], v[220:221], v[32:33] op_sel_hi:[0,1,1]
v_pk_fma_f32 v[34:35], s[72:73], v[222:223], v[34:35] op_sel_hi:[0,1,1]
v_mfma_f32_16x16x16_bf16 v[216:219], v[92:93], v[40:41], 0
v_exp_f32 v36, v32
v_exp_f32 v37, v33
v_mfma_f32_16x16x16_bf16 v[220:223], v[94:95], v[40:41], 0
v_exp_f32 v38, v34
v_exp_f32 v39, v35
v_cvt_pk_bf16_f32 v42, v36, v37
v_cvt_pk_bf16_f32 v43, v38, v39
v_max3_f32 v46, |v32|, |v33|, |v34|
v_mov_b32_dpp v44, v42 row_ror:8 row_mask:0xf bank_mask:0xf
v_mov_b32_dpp v45, v43 row_ror:8 row_mask:0xf bank_mask:0xf
v_mfma_f32_16x16x32_bf16 v[80:83], v[88:91], v[40:43], 0
v_max3_f32 v46, v46, |v35|, |v76|
v_max_f32 v46, v46, |v77|
s_waitcnt vmcnt(4)
v_mfma_f32_16x16x32_bf16 v[216:219], v[64:67], v[42:45], v[216:219]
v_cmp_lt_f32 vcc, s77, v46
v_mov_b64 v[16:17], 0
v_mfma_f32_16x16x32_bf16 v[220:223], v[68:71], v[42:45], v[220:223]
v_add_f32_dpp v80, v80, v80 row_ror:8 row_mask:0xf bank_mask:0xf
v_rcp_f32 v80, v80
v_mov_b64 v[18:19], 0
v_mov_b64 v[20:21], 0
v_pk_mul_f32 v[216:217], v[216:217], v[80:81] op_sel_hi:[1,0]
v_pk_mul_f32 v[218:219], v[218:219], v[80:81] op_sel_hi:[1,0]
v_cvt_pk_bf16_f32 v216, v216, v217
v_cvt_pk_bf16_f32 v217, v218, v219
v_pk_mul_f32 v[220:221], v[220:221], v[80:81] op_sel_hi:[1,0]
v_pk_mul_f32 v[222:223], v[222:223], v[80:81] op_sel_hi:[1,0]
v_cvt_pk_bf16_f32 v218, v220, v221
v_cvt_pk_bf16_f32 v219, v222, v223
v_mov_b64 v[22:23], 0
v_mov_b32_dpp v218, v216 row_ror:8 row_mask:0xf bank_mask:0xc
v_mov_b32_dpp v219, v217 row_ror:8 row_mask:0xf bank_mask:0xc
ds_write_b64 v109, v[218:219] offset:1024
s_cbranch_vccnz L_max3
L_pv3:
v_mov_b64 v[24:25], 0
v_mov_b64 v[26:27], 0
v_mov_b64 v[28:29], 0
v_mov_b64_e64 v[30:31], 0
s_waitcnt lgkmcnt(0)
s_barrier
ds_read_b128 v[0:3], v101 offset:0
ds_read_b128 v[4:7], v101 offset:2048
ds_read_b128 v[8:11], v101 offset:4096
ds_read_b128 v[12:15], v101 offset:6144
s_mov_b32 s74, s63
s_xor_b32 s63, s63, 8192
s_waitcnt lgkmcnt(3)
v_smfmac_f32_16x16x64_bf16 v[16:19], v[0:3], v[224:231], v106
v_smfmac_f32_16x16x64_bf16 v[20:23], v[0:3], v[144:151], v106
s_waitcnt lgkmcnt(2)
v_smfmac_f32_16x16x64_bf16 v[16:19], v[4:7], v[232:239], v106
ds_read_b128 v[232:235], v99 offset:32768
v_smfmac_f32_16x16x64_bf16 v[20:23], v[4:7], v[152:159], v106
ds_read_b128 v[236:239], v99 offset:33792
s_waitcnt lgkmcnt(3)
v_smfmac_f32_16x16x64_bf16 v[16:19], v[8:11], v[240:247], v106
ds_read_b128 v[240:243], v99 offset:34816
v_smfmac_f32_16x16x64_bf16 v[20:23], v[8:11], v[160:167], v106
ds_read_b128 v[244:247], v99 offset:35840
s_waitcnt lgkmcnt(4)
v_smfmac_f32_16x16x64_bf16 v[16:19], v[12:15], v[248:255], v106
ds_read_b128 v[248:251], v99 offset:36864
v_smfmac_f32_16x16x64_bf16 v[20:23], v[12:15], v[168:175], v106
ds_read_b128 v[252:255], v99 offset:37888
v_smfmac_f32_16x16x64_bf16 v[24:27], v[0:3], v[176:183], v106
v_smfmac_f32_16x16x64_bf16 v[28:31], v[0:3], v[208:215], v106
v_cvt_pk_bf16_f32 v16, v16, v20
v_cvt_pk_bf16_f32 v17, v17, v21
v_bfi_b32 v16, 1, s76, v16
v_cvt_pk_bf16_f32 v18, v18, v22
v_cvt_pk_bf16_f32 v19, v19, v23
buffer_store_dwordx4 v[16:19], v96, s[4:7], s60 offen
v_smfmac_f32_16x16x64_bf16 v[24:27], v[4:7], v[184:191], v106
s_waitcnt lgkmcnt(4)
v_smfmac_f32_16x16x64_bf16 v[28:31], v[4:7], v[232:239], v106
v_smfmac_f32_16x16x64_bf16 v[24:27], v[8:11], v[192:199], v106
s_waitcnt lgkmcnt(2)
v_smfmac_f32_16x16x64_bf16 v[28:31], v[8:11], v[240:247], v106
v_smfmac_f32_16x16x64_bf16 v[24:27], v[12:15], v[200:207], v106
s_waitcnt lgkmcnt(0)
v_smfmac_f32_16x16x64_bf16 v[28:31], v[12:15], v[248:255], v106
v_mov_b64 v[76:77], s[86:87]
v_mov_b64 v[78:79], s[86:87]
v_mov_b64 v[80:81], 0
v_mov_b64 v[82:83], 0
s_nop 3
v_cvt_pk_bf16_f32 v24, v24, v28
v_cvt_pk_bf16_f32 v25, v25, v29
v_bfi_b32 v24, 1, s76, v24
v_cvt_pk_bf16_f32 v26, v26, v30
v_cvt_pk_bf16_f32 v27, v27, v31
buffer_store_dwordx4 v[24:27], v96, s[4:7], s61 offen
v_mov_b64 v[32:33], 0
v_mov_b64 v[34:35], 0
v_mov_b64 v[36:37], 0
v_mov_b64 v[38:39], 0
v_mov_b64 v[40:41], 0
v_mov_b64 v[42:43], 0
v_mov_b64 v[44:45], 0
v_mov_b64 v[46:47], 0
v_mov_b64 v[48:49], 0
v_mov_b64 v[50:51], 0
v_mov_b64 v[52:53], 0
v_mov_b64 v[54:55], 0
s_nop 15
s_nop 15
s_nop 3
s_nop 4
buffer_load_dword v216, v104, s[4:7], s62 offen offset:0 sc1
buffer_load_dword v217, v104, s[4:7], s62 offen offset:256 sc1
buffer_load_dword v218, v104, s[4:7], s62 offen offset:512 sc1
buffer_load_dword v219, v104, s[4:7], s62 offen offset:768 sc1
buffer_load_dword v220, v104, s[4:7], s62 offen offset:1024 sc1
buffer_load_dword v221, v104, s[4:7], s62 offen offset:1280 sc1
buffer_load_dword v222, v104, s[4:7], s62 offen offset:1536 sc1
buffer_load_dword v223, v104, s[4:7], s62 offen offset:1792 sc1
ds_read_b128 v[224:227], v99 offset:0
ds_read_b128 v[228:231], v99 offset:1024
ds_read_b128 v[232:235], v99 offset:2048
ds_read_b128 v[236:239], v99 offset:3072
ds_read_b128 v[240:243], v99 offset:4096
ds_read_b128 v[244:247], v99 offset:5120
ds_read_b128 v[248:251], v99 offset:6144
ds_read_b128 v[252:255], v99 offset:7168
s_xor_b32 s60, s60, 0x40000
s_xor_b32 s61, s61, 0x40000
s_add_u32 s65, s65, 0x40000
s_add_u32 s68, s68, 1
s_mov_b32 s57, 0
s_waitcnt vmcnt(5)
v_bitop3_b32 v0, v216, v217, v218 bitop3:0x7e
s_waitcnt vmcnt(3)
v_bitop3_b32 v1, v218, v219, v220 bitop3:0x7e
s_waitcnt vmcnt(1)
v_bitop3_b32 v2, v220, v221, v222 bitop3:0x7e
v_or3_b32 v0, v0, v1, v2
s_waitcnt vmcnt(0)
v_smfmac_f32_16x16x64_bf16 v[80:83], v[76:79], v[216:223], v110
v_bitop3_b32 v3, v222, v223, s76 bitop3:0x7e
v_bitop3_b32 v0, v0, v111, v3 bitop3:0xc8
v_cmp_ne_u32 vcc, 0, v0
s_nop 3
s_cbranch_vccnz L_repoll3
v_cvt_pk_bf16_f32 v80, v80, v81
L_sum3:
buffer_store_dword v80, v97, s[4:7], s63 offen
v_mov_b32 v83, -1
s_xor_b32 s62, s62, 0x40000
s_bitcmp1_b32 s68, 1
s_cselect_b32 s76, -1, 0
buffer_store_dword v83, v97, s[4:7], s74 offen
s_cmp_lt_u32 s68, 63
s_waitcnt lgkmcnt(0)
s_barrier
buffer_load_dwordx4 v[216:219], v102, s[4:7], s63 offen sc1
buffer_load_dwordx4 v[220:223], v102, s[4:7], s63 offen offset:1024 sc1
s_barrier
ds_read_b128 v[0:3], v98 offset:0
ds_read_b128 v[4:7], v98 offset:1024
ds_read_b128 v[8:11], v98 offset:2048
ds_read_b128 v[12:15], v98 offset:3072
buffer_load_dwordx4 v[64:67], v102, s[4:7], s75 offen offset:0 sc1
buffer_load_dwordx4 v[68:71], v102, s[4:7], s75 offen offset:1024 sc1
s_cbranch_scc1 L_top3
s_branch L_final23
L_rg_qk3:
s_mov_b32 s57, 0
s_mov_b64 exec, vcc
buffer_load_dwordx4 v[216:219], v102, s[4:7], s63 offen sc1
buffer_load_dwordx4 v[220:223], v102, s[4:7], s63 offen offset:1024 sc1
s_branch L_rgw_qk3
L_rgl_qk3:
s_mov_b64 exec, vcc
buffer_load_dwordx4 v[216:219], v102, s[4:7], s63 offen sc1
buffer_load_dwordx4 v[220:223], v102, s[4:7], s63 offen offset:1024 sc1
s_add_u32 s57, s57, 0x2000
s_cbranch_scc1 L_end
L_rgw_qk3:
s_waitcnt vmcnt(0)
v_max3_u32 v76, v216, v217, v218
v_max3_u32 v77, v219, v220, v221
v_max3_u32 v76, v76, v222, v223
v_max_u32 v76, v76, v77
v_cmp_eq_u32 vcc, -1, v76
s_cbranch_vccnz L_rgl_qk3
s_mov_b64 exec, -1
ds_write_b128 v102, v[216:219]
ds_write_b128 v102, v[220:223] offset:1024
s_branch L_rg_qret3
L_repoll3:
s_lshl_b64 s[88:89], vcc, 1
s_or_b64 vcc, vcc, s[88:89]
s_lshl_b64 s[88:89], vcc, 2
s_or_b64 exec, vcc, s[88:89]
buffer_load_dword v216, v104, s[4:7], s62 offen offset:0 sc1
buffer_load_dword v217, v104, s[4:7], s62 offen offset:256 sc1
buffer_load_dword v218, v104, s[4:7], s62 offen offset:512 sc1
buffer_load_dword v219, v104, s[4:7], s62 offen offset:768 sc1
buffer_load_dword v220, v104, s[4:7], s62 offen offset:1024 sc1
buffer_load_dword v221, v104, s[4:7], s62 offen offset:1280 sc1
buffer_load_dword v222, v104, s[4:7], s62 offen offset:1536 sc1
buffer_load_dword v223, v104, s[4:7], s62 offen offset:1792 sc1
s_mov_b64 exec, -1
v_mov_b64 v[80:81], 0
v_mov_b64 v[82:83], 0
s_add_u32 s57, s57, 0x2000
s_cbranch_scc1 L_end
s_waitcnt vmcnt(0)
v_smfmac_f32_16x16x64_bf16 v[80:83], v[76:79], v[216:223], v110
v_bitop3_b32 v0, v216, v217, v218 bitop3:0x7e
v_bitop3_b32 v1, v218, v219, v220 bitop3:0x7e
v_bitop3_b32 v2, v220, v221, v222 bitop3:0x7e
v_bitop3_b32 v3, v222, v223, s76 bitop3:0x7e
v_or3_b32 v0, v0, v1, v2
v_bitop3_b32 v0, v0, v111, v3 bitop3:0xc8
v_cmp_ne_u32 vcc, 0, v0
s_nop 0
v_cvt_pk_bf16_f32 v80, v80, v81
s_cbranch_vccz L_sum3
s_branch L_repoll3
L_max3:
v_max3_f32 v46, v32, v33, v34
v_max3_f32 v47, v35, v76, v77
v_max_f32 v46, v46, v47
s_nop 1
v_max_f32_dpp v46, v46, v46 row_ror:8 row_mask:0xf bank_mask:0xf
v_mov_b32 v47, v46
s_nop 1
v_permlane16_swap_b32 v46, v47
v_max_f32 v46, v46, v47
v_mov_b32 v47, v46
s_nop 1
v_permlane32_swap_b32 v46, v47
v_max_f32 v46, v46, v47
v_sub_f32 v32, v32, v46
v_exp_f32 v36, v32
v_sub_f32 v33, v33, v46
v_exp_f32 v37, v33
v_sub_f32 v34, v34, v46
v_exp_f32 v38, v34
v_sub_f32 v35, v35, v46
v_exp_f32 v39, v35
v_sub_f32 v76, v76, v46
v_exp_f32 v78, v76
v_sub_f32 v77, v77, v46
v_exp_f32 v79, v77
s_nop 0
v_cvt_pk_bf16_f32 v41, v78, v79
v_cvt_pk_bf16_f32 v42, v36, v37
v_cvt_pk_bf16_f32 v43, v38, v39
v_mov_b32_dpp v40, v41 row_ror:8 row_mask:0xf bank_mask:0xf
v_mov_b32_dpp v44, v42 row_ror:8 row_mask:0xf bank_mask:0xf
v_mov_b32_dpp v45, v43 row_ror:8 row_mask:0xf bank_mask:0xf
v_mfma_f32_16x16x16_bf16 v[216:219], v[92:93], v[40:41], 0
v_mfma_f32_16x16x16_bf16 v[220:223], v[94:95], v[40:41], 0
v_mfma_f32_16x16x32_bf16 v[80:83], v[88:91], v[40:43], 0
v_mfma_f32_16x16x32_bf16 v[216:219], v[64:67], v[42:45], v[216:219]
v_mfma_f32_16x16x32_bf16 v[220:223], v[68:71], v[42:45], v[220:223]
v_add_f32_dpp v80, v80, v80 row_ror:8 row_mask:0xf bank_mask:0xf
v_rcp_f32 v80, v80
s_nop 1
v_pk_mul_f32 v[216:217], v[216:217], v[80:81] op_sel_hi:[1,0]
v_pk_mul_f32 v[218:219], v[218:219], v[80:81] op_sel_hi:[1,0]
v_cvt_pk_bf16_f32 v216, v216, v217
v_cvt_pk_bf16_f32 v217, v218, v219
v_pk_mul_f32 v[220:221], v[220:221], v[80:81] op_sel_hi:[1,0]
v_pk_mul_f32 v[222:223], v[222:223], v[80:81] op_sel_hi:[1,0]
v_cvt_pk_bf16_f32 v218, v220, v221
v_cvt_pk_bf16_f32 v219, v222, v223
s_nop 0
v_mov_b32_dpp v218, v216 row_ror:8 row_mask:0xf bank_mask:0xc
v_mov_b32_dpp v219, v217 row_ror:8 row_mask:0xf bank_mask:0xc
ds_write_b64 v109, v[218:219] offset:1024
s_branch L_pv3
L_rg_fin:
s_mov_b32 s57, 0
s_mov_b64 exec, vcc
buffer_load_dwordx4 v[216:219], v102, s[4:7], s63 offen sc1
buffer_load_dwordx4 v[220:223], v102, s[4:7], s63 offen offset:1024 sc1
s_sleep 2
buffer_load_dwordx4 v[216:219], v102, s[4:7], s63 offen sc1
buffer_load_dwordx4 v[220:223], v102, s[4:7], s63 offen offset:1024 sc1
s_branch L_rgw_fin
L_rgl_fin:
s_mov_b64 exec, vcc
buffer_load_dwordx4 v[216:219], v102, s[4:7], s63 offen sc1
buffer_load_dwordx4 v[220:223], v102, s[4:7], s63 offen offset:1024 sc1
s_add_u32 s57, s57, 0x2000
s_cbranch_scc1 L_end
L_rgw_fin:
s_waitcnt vmcnt(2)
v_max3_u32 v76, v216, v217, v218
v_max3_u32 v77, v219, v220, v221
v_max3_u32 v76, v76, v222, v223
v_max_u32 v76, v76, v77
v_cmp_eq_u32 vcc, -1, v76
s_cbranch_vccnz L_rgl_fin
s_mov_b64 exec, -1
ds_write_b128 v102, v[216:219]
ds_write_b128 v102, v[220:223] offset:1024
s_branch L_final2
L_final23:
s_mov_b64 exec, s[84:85]
buffer_store_dwordx4 v[72:75], v102, s[4:7], s65 offen sc1
s_mov_b64 exec, -1
buffer_store_dwordx4 v[92:95], v102, s[4:7], s65 offen offset:1024 sc1
ds_read_b128 v[224:227], v99 offset:14336
ds_read_b128 v[228:231], v99 offset:15360
ds_read_b128 v[232:235], v99 offset:16384
ds_read_b128 v[236:239], v99 offset:17408
ds_read_b128 v[240:243], v99 offset:20480
ds_read_b128 v[244:247], v99 offset:21504
ds_read_b128 v[248:251], v99 offset:22528
ds_read_b128 v[252:255], v99 offset:23552
s_waitcnt vmcnt(4)
ds_write_b128 v102, v[216:219]
ds_write_b128 v102, v[220:223] offset:1024
v_max_u32 v76, v216, v220
v_cmp_eq_u32 vcc, -1, v76
s_cbranch_vccnz L_rg_fin
s_branch L_final2
L_final01:
s_mov_b64 exec, s[84:85]
buffer_store_dwordx4 v[72:75], v102, s[4:7], s65 offen sc1
s_mov_b64 exec, -1
buffer_store_dwordx4 v[92:95], v102, s[4:7], s65 offen offset:1024 sc1
ds_read_b128 v[224:227], v99 offset:14336
ds_read_b128 v[228:231], v99 offset:15360
ds_read_b128 v[232:235], v99 offset:16384
ds_read_b128 v[236:239], v99 offset:17408
ds_read_b128 v[240:243], v99 offset:20480
ds_read_b128 v[244:247], v99 offset:21504
ds_read_b128 v[248:251], v99 offset:22528
ds_read_b128 v[252:255], v99 offset:23552
s_waitcnt vmcnt(4)
L_final2:
s_waitcnt lgkmcnt(0)
s_barrier
ds_read_b128 v[16:19], v98 offset:4096
ds_read_b128 v[20:23], v98 offset:5120
ds_read_b128 v[24:27], v98 offset:6144
ds_read_b128 v[28:31], v98 offset:7168
s_cmp_eq_u32 s79, 0
s_cbranch_scc1 L_fin_nw
v_lshlrev_b32 v79, 3, v98
v_mov_b32 v78, 0x40
s_mov_b64 exec, s[94:95]
buffer_store_dword v78, v79, s[4:7], 0 offen offset:2048 sc1
s_mov_b64 exec, -1
L_fin_nw:
v_smfmac_f32_16x16x64_bf16 v[40:43], v[0:3], a[8:15], v106
v_smfmac_f32_16x16x64_bf16 v[44:47], v[0:3], a[24:31], v106
v_smfmac_f32_16x16x64_bf16 v[40:43], v[4:7], a[48:55], v106
v_smfmac_f32_16x16x64_bf16 v[44:47], v[4:7], a[64:71], v106
v_smfmac_f32_16x16x64_bf16 v[40:43], v[8:11], a[88:95], v106
v_smfmac_f32_16x16x64_bf16 v[44:47], v[8:11], a[104:111], v106
v_smfmac_f32_16x16x64_bf16 v[40:43], v[12:15], a[128:135], v106
v_smfmac_f32_16x16x64_bf16 v[44:47], v[12:15], a[144:151], v106
s_waitcnt lgkmcnt(3)
v_smfmac_f32_16x16x64_bf16 v[40:43], v[16:19], a[160:167], v106
v_smfmac_f32_16x16x64_bf16 v[44:47], v[16:19], a[176:183], v106
s_waitcnt lgkmcnt(2)
v_smfmac_f32_16x16x64_bf16 v[40:43], v[20:23], a[192:199], v106
v_smfmac_f32_16x16x64_bf16 v[44:47], v[20:23], a[208:215], v106
s_waitcnt lgkmcnt(1)
v_smfmac_f32_16x16x64_bf16 v[40:43], v[24:27], a[224:231], v106
s_waitcnt lgkmcnt(0)
v_smfmac_f32_16x16x64_bf16 v[40:43], v[28:31], a[240:247], v106
v_smfmac_f32_16x16x64_bf16 v[44:47], v[24:27], a[232:239], v106
v_smfmac_f32_16x16x64_bf16 v[44:47], v[28:31], a[248:255], v106
v_smfmac_f32_16x16x64_bf16 v[48:51], v[24:27], v[224:231], v106
v_smfmac_f32_16x16x64_bf16 v[52:55], v[24:27], v[232:239], v106
v_cvt_pk_bf16_f32 v32, v32, v33
v_cvt_pk_bf16_f32 v33, v34, v35
v_cvt_pk_bf16_f32 v34, v40, v41
v_cvt_pk_bf16_f32 v35, v42, v43
v_cvt_pk_bf16_f32 v36, v36, v37
v_cvt_pk_bf16_f32 v37, v38, v39
v_cvt_pk_bf16_f32 v38, v44, v45
v_cvt_pk_bf16_f32 v39, v46, v47
v_mfma_f32_16x16x32_bf16 v[40:43], v[32:35], v[84:87], 0
s_nop 0
v_mfma_f32_16x16x32_bf16 v[44:47], v[36:39], v[84:87], 0
v_smfmac_f32_16x16x64_bf16 v[48:51], v[28:31], v[240:247], v106
v_smfmac_f32_16x16x64_bf16 v[52:55], v[28:31], v[248:255], v106
v_cvt_pk_bf16_f32 v72, v40, v41
v_cvt_pk_bf16_f32 v73, v42, v43
v_cvt_pk_bf16_f32 v74, v44, v45
v_cvt_pk_bf16_f32 v75, v46, v47
s_add_u32 s65, s65, 0x40000
s_mov_b64 exec, s[84:85]
buffer_store_dwordx4 v[72:75], v102, s[4:7], s65 offen sc1
s_mov_b64 exec, -1
v_smfmac_f32_16x16x64_bf16 v[48:51], v[0:3], a[16:23], v106
v_smfmac_f32_16x16x64_bf16 v[48:51], v[4:7], a[56:63], v106
v_smfmac_f32_16x16x64_bf16 v[48:51], v[8:11], a[96:103], v106
v_smfmac_f32_16x16x64_bf16 v[48:51], v[12:15], a[136:143], v106
v_smfmac_f32_16x16x64_bf16 v[48:51], v[16:19], a[168:175], v106
v_smfmac_f32_16x16x64_bf16 v[48:51], v[20:23], a[200:207], v106
v_smfmac_f32_16x16x64_bf16 v[52:55], v[0:3], a[32:39], v106
v_smfmac_f32_16x16x64_bf16 v[52:55], v[4:7], a[72:79], v106
v_smfmac_f32_16x16x64_bf16 v[52:55], v[8:11], a[112:119], v106
v_smfmac_f32_16x16x64_bf16 v[52:55], v[12:15], a[152:159], v106
v_smfmac_f32_16x16x64_bf16 v[52:55], v[16:19], a[184:191], v106
v_smfmac_f32_16x16x64_bf16 v[52:55], v[20:23], a[216:223], v106
v_cvt_pk_bf16_f32 v92, v48, v49
v_cvt_pk_bf16_f32 v93, v50, v51
s_nop 5
v_cvt_pk_bf16_f32 v94, v52, v53
v_cvt_pk_bf16_f32 v95, v54, v55
buffer_store_dwordx4 v[92:95], v102, s[4:7], s65 offen offset:1024 sc1
s_branch L_end
.p2alignl 12, 0xbf810000
.p2align 6
.fill 7, 4, 0xbf800000
L_top4:
s_waitcnt lgkmcnt(3)
v_smfmac_f32_16x16x64_bf16 v[32:35], v[0:3], v[224:231], v106
ds_read_b128 v[224:227], v99 offset:8192
v_smfmac_f32_16x16x64_bf16 v[36:39], v[0:3], a[0:7], v106
ds_read_b128 v[228:231], v99 offset:9216
v_smfmac_f32_16x16x64_bf16 v[40:43], v[0:3], a[8:15], v106
ds_read_b128 v[16:19], v98 offset:4096
buffer_store_dwordx4 v[92:95], v102, s[4:7], s65 offen offset:1024 sc1
v_smfmac_f32_16x16x64_bf16 v[44:47], v[0:3], a[24:31], v106
ds_read_b128 v[20:23], v98 offset:5120
s_mov_b64 exec, s[84:85]
buffer_store_dwordx4 v[72:75], v102, s[4:7], s65 offen sc1
s_mov_b64 exec, -1
s_waitcnt lgkmcnt(6)
v_smfmac_f32_16x16x64_bf16 v[32:35], v[4:7], v[232:239], v106
ds_read_b128 v[232:235], v99 offset:10240
v_smfmac_f32_16x16x64_bf16 v[36:39], v[4:7], a[40:47], v106
ds_read_b128 v[236:239], v99 offset:11264
v_smfmac_f32_16x16x64_bf16 v[40:43], v[4:7], a[48:55], v106
ds_read_b128 v[24:27], v98 offset:6144
s_mov_b64 exec, s[94:95]
buffer_store_dword v78, v79, s[4:7], 0 offen offset:2048 sc1
s_mov_b64 exec, -1
v_smfmac_f32_16x16x64_bf16 v[44:47], v[4:7], a[64:71], v106
ds_read_b128 v[28:31], v98 offset:7168
s_mov_b64 exec, s[96:97]
buffer_load_dword v108, v105, s[4:7], 0 offen offset:1024 sc1
s_mov_b64 exec, -1
s_waitcnt lgkmcnt(9)
v_smfmac_f32_16x16x64_bf16 v[32:35], v[8:11], v[240:247], v106
ds_read_b128 v[240:243], v99 offset:12288
v_smfmac_f32_16x16x64_bf16 v[36:39], v[8:11], a[80:87], v106
ds_read_b128 v[244:247], v99 offset:13312
v_smfmac_f32_16x16x64_bf16 v[40:43], v[8:11], a[88:95], v106
v_smfmac_f32_16x16x64_bf16 v[44:47], v[8:11], a[104:111], v106
s_waitcnt lgkmcnt(10)
v_smfmac_f32_16x16x64_bf16 v[32:35], v[12:15], v[248:255], v106
ds_read_b128 v[248:251], v99 offset:18432
v_smfmac_f32_16x16x64_bf16 v[36:39], v[12:15], a[120:127], v106
ds_read_b128 v[252:255], v99 offset:19456
v_smfmac_f32_16x16x64_bf16 v[40:43], v[12:15], a[128:135], v106
v_smfmac_f32_16x16x64_bf16 v[44:47], v[12:15], a[144:151], v106
s_waitcnt lgkmcnt(9)
v_smfmac_f32_16x16x64_bf16 v[32:35], v[16:19], v[224:231], v106
ds_read_b128 v[224:227], v99 offset:14336
v_smfmac_f32_16x16x64_bf16 v[36:39], v[16:19], v[112:119], v106
ds_read_b128 v[228:231], v99 offset:15360
v_smfmac_f32_16x16x64_bf16 v[40:43], v[16:19], a[160:167], v106
v_smfmac_f32_16x16x64_bf16 v[44:47], v[16:19], a[176:183], v106
s_waitcnt lgkmcnt(10)
s_waitcnt lgkmcnt(8)
v_smfmac_f32_16x16x64_bf16 v[32:35], v[20:23], v[232:239], v106
ds_read_b128 v[232:235], v99 offset:16384
v_smfmac_f32_16x16x64_bf16 v[36:39], v[20:23], v[120:127], v106
ds_read_b128 v[236:239], v99 offset:17408
v_smfmac_f32_16x16x64_bf16 v[40:43], v[20:23], a[192:199], v106
v_smfmac_f32_16x16x64_bf16 v[44:47], v[20:23], a[208:215], v106
s_waitcnt lgkmcnt(9)
s_waitcnt lgkmcnt(6)
v_smfmac_f32_16x16x64_bf16 v[32:35], v[24:27], v[240:247], v106
ds_read_b128 v[240:243], v99 offset:20480
v_smfmac_f32_16x16x64_bf16 v[40:43], v[24:27], a[224:231], v106
ds_read_b128 v[244:247], v99 offset:21504
s_waitcnt lgkmcnt(6)
v_smfmac_f32_16x16x64_bf16 v[32:35], v[28:31], v[248:255], v106
s_waitcnt vmcnt(6)
ds_read_b128 v[248:251], v99 offset:22528
v_smfmac_f32_16x16x64_bf16 v[40:43], v[28:31], a[240:247], v106
ds_read_b128 v[252:255], v99 offset:23552
v_smfmac_f32_16x16x64_bf16 v[36:39], v[24:27], v[128:135], v106
v_cvt_pk_bf16_f32 v32, v32, v33
v_smfmac_f32_16x16x64_bf16 v[44:47], v[24:27], a[232:239], v106
v_cvt_pk_bf16_f32 v33, v34, v35
v_smfmac_f32_16x16x64_bf16 v[36:39], v[28:31], v[136:143], v106
v_cvt_pk_bf16_f32 v34, v40, v41
v_smfmac_f32_16x16x64_bf16 v[44:47], v[28:31], a[248:255], v106
s_barrier
v_cvt_pk_bf16_f32 v35, v42, v43
s_waitcnt lgkmcnt(6)
v_smfmac_f32_16x16x64_bf16 v[48:51], v[24:27], v[224:231], v106
ds_read_b128 v[224:227], v99 offset:24576
v_cvt_pk_bf16_f32 v36, v36, v37
v_mfma_f32_16x16x32_bf16 v[40:43], v[32:35], v[84:87], 0
ds_read_b128 v[228:231], v99 offset:25600
v_cvt_pk_bf16_f32 v37, v38, v39
v_cvt_pk_bf16_f32 v38, v44, v45
s_waitcnt lgkmcnt(6)
v_smfmac_f32_16x16x64_bf16 v[52:55], v[24:27], v[232:239], v106
ds_read_b128 v[232:235], v99 offset:26624
v_cvt_pk_bf16_f32 v39, v46, v47
s_nop 1
v_mfma_f32_16x16x32_bf16 v[44:47], v[36:39], v[84:87], 0
ds_read_b128 v[236:239], v99 offset:27648
v_cvt_pk_bf16_f32 v72, v40, v41
v_cvt_pk_bf16_f32 v73, v42, v43
s_waitcnt lgkmcnt(6)
v_smfmac_f32_16x16x64_bf16 v[48:51], v[28:31], v[240:247], v106
ds_read_b128 v[240:243], v99 offset:28672
s_waitcnt lgkmcnt(5)
v_smfmac_f32_16x16x64_bf16 v[52:55], v[28:31], v[248:255], v106
ds_read_b128 v[244:247], v99 offset:29696
v_cvt_pk_bf16_f32 v74, v44, v45
v_cvt_pk_bf16_f32 v75, v46, v47
s_nop 1
v_mfma_f32_16x16x32_bf16 v[40:43], v[72:75], v[72:75], 0
ds_read_b128 v[248:251], v99 offset:30720
v_mfma_f32_16x16x32_bf16 v[32:35], v[56:59], v[72:75], 0
ds_read_b128 v[252:255], v99 offset:31744
v_mfma_f32_16x16x32_bf16 v[36:39], v[60:63], v[72:75], 0
v_mov_b32_dpp v40, v42 row_ror:8 row_mask:0xf bank_mask:0xc
v_mov_b32_dpp v41, v43 row_ror:8 row_mask:0xf bank_mask:0xc
ds_write_b64 v107, v[40:41] offset:1152
v_smfmac_f32_16x16x64_bf16 v[48:51], v[0:3], a[16:23], v106
s_nop 3
v_mov_b32_dpp v32, v36 row_ror:8 row_mask:0xf bank_mask:0xc
v_mov_b32_dpp v33, v37 row_ror:8 row_mask:0xf bank_mask:0xc
v_mov_b32_dpp v34, v38 row_ror:8 row_mask:0xf bank_mask:0xc
v_mov_b32_dpp v35, v39 row_ror:8 row_mask:0xf bank_mask:0xc
ds_write_b128 v102, v[32:35]
v_smfmac_f32_16x16x64_bf16 v[48:51], v[4:7], a[56:63], v106
s_add_u32 s64, s64, 0x40000
s_add_u32 s75, s64, 16777216
v_smfmac_f32_16x16x64_bf16 v[48:51], v[8:11], a[96:103], v106
buffer_load_dwordx4 v[56:59], v102, s[4:7], s64 offen offset:0 sc1
v_smfmac_f32_16x16x64_bf16 v[48:51], v[12:15], a[136:143], v106
buffer_load_dwordx4 v[60:63], v102, s[4:7], s64 offen offset:1024 sc1
v_smfmac_f32_16x16x64_bf16 v[48:51], v[16:19], a[168:175], v106
s_waitcnt lgkmcnt(0)
s_barrier
ds_read_b64 v[76:77], v100 offset:0
v_smfmac_f32_16x16x64_bf16 v[48:51], v[20:23], a[200:207], v106
ds_read_b64 v[78:79], v100 offset:2048
v_smfmac_f32_16x16x64_bf16 v[52:55], v[0:3], a[32:39], v106
ds_read_b64 v[80:81], v100 offset:4096
v_smfmac_f32_16x16x64_bf16 v[52:55], v[4:7], a[72:79], v106
ds_read_b64 v[82:83], v100 offset:6144
v_smfmac_f32_16x16x64_bf16 v[52:55], v[8:11], a[112:119], v106
v_cvt_pk_bf16_f32 v92, v48, v49
ds_read_b128 v[32:35], v98 offset:0
v_smfmac_f32_16x16x64_bf16 v[52:55], v[12:15], a[152:159], v106
v_cvt_pk_bf16_f32 v93, v50, v51
ds_read_b128 v[36:39], v98 offset:2048
v_smfmac_f32_16x16x64_bf16 v[52:55], v[16:19], a[184:191], v106
ds_read_b128 v[216:219], v98 offset:4096
v_smfmac_f32_16x16x64_bf16 v[52:55], v[20:23], a[216:223], v106
ds_read_b128 v[220:223], v98 offset:6144
s_waitcnt lgkmcnt(6)
v_pk_mul_f32 v[76:77], s[72:73], v[76:77] op_sel_hi:[0,1]
v_pk_fma_f32 v[76:77], s[72:73], v[78:79], v[76:77] op_sel_hi:[0,1,1]
s_waitcnt lgkmcnt(4)
v_pk_fma_f32 v[76:77], s[72:73], v[80:81], v[76:77] op_sel_hi:[0,1,1]
v_pk_fma_f32 v[76:77], s[72:73], v[82:83], v[76:77] op_sel_hi:[0,1,1]
v_exp_f32 v78, v76
v_exp_f32 v79, v77
v_cvt_pk_bf16_f32 v94, v52, v53
v_cvt_pk_bf16_f32 v41, v78, v79
v_cvt_pk_bf16_f32 v95, v54, v55
s_waitcnt lgkmcnt(3)
v_pk_mul_f32 v[32:33], s[72:73], v[32:33] op_sel_hi:[0,1]
v_mov_b32_dpp v40, v41 row_ror:8 row_mask:0xf bank_mask:0xf
v_pk_mul_f32 v[34:35], s[72:73], v[34:35] op_sel_hi:[0,1]
s_waitcnt lgkmcnt(2)
v_pk_fma_f32 v[32:33], s[72:73], v[36:37], v[32:33] op_sel_hi:[0,1,1]
v_pk_fma_f32 v[34:35], s[72:73], v[38:39], v[34:35] op_sel_hi:[0,1,1]
s_waitcnt lgkmcnt(1)
v_pk_fma_f32 v[32:33], s[72:73], v[216:217], v[32:33] op_sel_hi:[0,1,1]
v_pk_fma_f32 v[34:35], s[72:73], v[218:219], v[34:35] op_sel_hi:[0,1,1]
s_waitcnt lgkmcnt(0)
v_pk_fma_f32 v[32:33], s[72:73], v[220:221], v[32:33] op_sel_hi:[0,1,1]
v_pk_fma_f32 v[34:35], s[72:73], v[222:223], v[34:35] op_sel_hi:[0,1,1]
v_mfma_f32_16x16x16_bf16 v[216:219], v[92:93], v[40:41], 0
v_exp_f32 v36, v32
v_exp_f32 v37, v33
v_mfma_f32_16x16x16_bf16 v[220:223], v[94:95], v[40:41], 0
v_exp_f32 v38, v34
v_exp_f32 v39, v35
v_cvt_pk_bf16_f32 v42, v36, v37
v_cvt_pk_bf16_f32 v43, v38, v39
v_max3_f32 v46, |v32|, |v33|, |v34|
v_mov_b32_dpp v44, v42 row_ror:8 row_mask:0xf bank_mask:0xf
v_mov_b32_dpp v45, v43 row_ror:8 row_mask:0xf bank_mask:0xf
v_mfma_f32_16x16x32_bf16 v[80:83], v[88:91], v[40:43], 0
v_max3_f32 v46, v46, |v35|, |v76|
v_max_f32 v46, v46, |v77|
s_waitcnt vmcnt(6)
v_mfma_f32_16x16x32_bf16 v[216:219], v[64:67], v[42:45], v[216:219]
v_cmp_lt_f32 vcc, s77, v46
v_mov_b64 v[16:17], 0
v_mfma_f32_16x16x32_bf16 v[220:223], v[68:71], v[42:45], v[220:223]
v_add_f32_dpp v80, v80, v80 row_ror:8 row_mask:0xf bank_mask:0xf
v_rcp_f32 v80, v80
v_mov_b64 v[18:19], 0
v_mov_b64 v[20:21], 0
v_pk_mul_f32 v[216:217], v[216:217], v[80:81] op_sel_hi:[1,0]
v_pk_mul_f32 v[218:219], v[218:219], v[80:81] op_sel_hi:[1,0]
v_cvt_pk_bf16_f32 v216, v216, v217
v_cvt_pk_bf16_f32 v217, v218, v219
v_pk_mul_f32 v[220:221], v[220:221], v[80:81] op_sel_hi:[1,0]
v_pk_mul_f32 v[222:223], v[222:223], v[80:81] op_sel_hi:[1,0]
v_cvt_pk_bf16_f32 v218, v220, v221
v_cvt_pk_bf16_f32 v219, v222, v223
v_mov_b64 v[22:23], 0
v_mov_b32_dpp v218, v216 row_ror:8 row_mask:0xf bank_mask:0xc
v_mov_b32_dpp v219, v217 row_ror:8 row_mask:0xf bank_mask:0xc
ds_write_b64 v109, v[218:219] offset:1024
s_cbranch_vccnz L_max4
L_pv4:
v_mov_b64 v[24:25], 0
v_mov_b64 v[26:27], 0
v_mov_b64 v[28:29], 0
v_mov_b64 v[30:31], 0
s_waitcnt lgkmcnt(0)
s_barrier
ds_read_b128 v[0:3], v101 offset:0
ds_read_b128 v[4:7], v101 offset:2048
ds_read_b128 v[8:11], v101 offset:4096
ds_read_b128 v[12:15], v101 offset:6144
s_mov_b32 s74, s63
s_xor_b32 s63, s63, 8192
s_waitcnt lgkmcnt(3)
v_smfmac_f32_16x16x64_bf16 v[16:19], v[0:3], v[224:231], v106
v_smfmac_f32_16x16x64_bf16 v[20:23], v[0:3], v[144:151], v106
s_waitcnt lgkmcnt(2)
v_smfmac_f32_16x16x64_bf16 v[16:19], v[4:7], v[232:239], v106
ds_read_b128 v[232:235], v99 offset:32768
v_smfmac_f32_16x16x64_bf16 v[20:23], v[4:7], v[152:159], v106
ds_read_b128 v[236:239], v99 offset:33792
s_waitcnt lgkmcnt(3)
v_smfmac_f32_16x16x64_bf16 v[16:19], v[8:11], v[240:247], v106
ds_read_b128 v[240:243], v99 offset:34816
v_smfmac_f32_16x16x64_bf16 v[20:23], v[8:11], v[160:167], v106
ds_read_b128 v[244:247], v99 offset:35840
s_waitcnt lgkmcnt(4)
v_smfmac_f32_16x16x64_bf16 v[16:19], v[12:15], v[248:255], v106
ds_read_b128 v[248:251], v99 offset:36864
v_smfmac_f32_16x16x64_bf16 v[20:23], v[12:15], v[168:175], v106
ds_read_b128 v[252:255], v99 offset:37888
v_smfmac_f32_16x16x64_bf16 v[24:27], v[0:3], v[176:183], v106
v_smfmac_f32_16x16x64_bf16 v[28:31], v[0:3], v[208:215], v106
v_cvt_pk_bf16_f32 v16, v16, v20
v_cvt_pk_bf16_f32 v17, v17, v21
v_bfi_b32 v16, 1, s76, v16
v_cvt_pk_bf16_f32 v18, v18, v22
v_cvt_pk_bf16_f32 v19, v19, v23
buffer_store_dwordx4 v[16:19], v96, s[4:7], s60 offen sc1
v_smfmac_f32_16x16x64_bf16 v[24:27], v[4:7], v[184:191], v106
s_waitcnt lgkmcnt(4)
v_smfmac_f32_16x16x64_bf16 v[28:31], v[4:7], v[232:239], v106
v_smfmac_f32_16x16x64_bf16 v[24:27], v[8:11], v[192:199], v106
s_waitcnt lgkmcnt(2)
v_smfmac_f32_16x16x64_bf16 v[28:31], v[8:11], v[240:247], v106
v_smfmac_f32_16x16x64_bf16 v[24:27], v[12:15], v[200:207], v106
s_waitcnt lgkmcnt(0)
v_smfmac_f32_16x16x64_bf16 v[28:31], v[12:15], v[248:255], v106
v_mov_b64 v[76:77], s[86:87]
v_mov_b64 v[78:79], s[86:87]
v_mov_b64 v[80:81], 0
v_mov_b64 v[82:83], 0
s_nop 3
v_cvt_pk_bf16_f32 v24, v24, v28
v_cvt_pk_bf16_f32 v25, v25, v29
v_bfi_b32 v24, 1, s76, v24
v_cvt_pk_bf16_f32 v26, v26, v30
v_cvt_pk_bf16_f32 v27, v27, v31
buffer_store_dwordx4 v[24:27], v96, s[4:7], s61 offen sc1
v_mov_b64 v[32:33], 0
v_mov_b64 v[34:35], 0
v_mov_b64 v[36:37], 0
v_mov_b64 v[38:39], 0
v_mov_b64 v[40:41], 0
v_mov_b64 v[42:43], 0
v_mov_b64 v[44:45], 0
v_mov_b64 v[46:47], 0
v_mov_b64 v[48:49], 0
v_mov_b64 v[50:51], 0
v_mov_b64 v[52:53], 0
v_mov_b64 v[54:55], 0
s_nop 0
buffer_load_dword v216, v104, s[4:7], s62 offen offset:0 sc1
buffer_load_dword v217, v104, s[4:7], s62 offen offset:256 sc1
buffer_load_dword v218, v104, s[4:7], s62 offen offset:512 sc1
buffer_load_dword v219, v104, s[4:7], s62 offen offset:768 sc1
buffer_load_dword v220, v104, s[4:7], s62 offen offset:1024 sc1
buffer_load_dword v221, v104, s[4:7], s62 offen offset:1280 sc1
buffer_load_dword v222, v104, s[4:7], s62 offen offset:1536 sc1
buffer_load_dword v223, v104, s[4:7], s62 offen offset:1792 sc1
ds_read_b128 v[224:227], v99 offset:0
ds_read_b128 v[228:231], v99 offset:1024
ds_read_b128 v[232:235], v99 offset:2048
ds_read_b128 v[236:239], v99 offset:3072
ds_read_b128 v[240:243], v99 offset:4096
ds_read_b128 v[244:247], v99 offset:5120
ds_read_b128 v[248:251], v99 offset:6144
ds_read_b128 v[252:255], v99 offset:7168
s_xor_b32 s60, s60, 0x40000
s_xor_b32 s61, s61, 0x40000
s_add_u32 s65, s65, 0x40000
s_add_u32 s68, s68, 1
s_mov_b32 s57, 0
s_waitcnt vmcnt(5)
v_bitop3_b32 v0, v216, v217, v218 bitop3:0x7e
s_waitcnt vmcnt(3)
v_bitop3_b32 v1, v218, v219, v220 bitop3:0x7e
s_waitcnt vmcnt(1)
v_bitop3_b32 v2, v220, v221, v222 bitop3:0x7e
v_or3_b32 v0, v0, v1, v2
s_waitcnt vmcnt(0)
v_smfmac_f32_16x16x64_bf16 v[80:83], v[76:79], v[216:223], v110
v_bitop3_b32 v3, v222, v223, s76 bitop3:0x7e
v_bitop3_b32 v0, v0, v111, v3 bitop3:0xc8
v_cmp_ne_u32_e64 vcc, 0, v0
s_nop 1
s_nop 1
s_cbranch_vccnz L_repoll4
v_cvt_pk_bf16_f32 v80, v80, v81
L_sum4:
buffer_store_dword v80, v97, s[4:7], s63 offen sc1
v_mov_b32 v83, -1
s_xor_b32 s62, s62, 0x40000
s_bitcmp1_b32 s68, 1
s_cselect_b32 s76, -1, 0
buffer_load_dwordx4 v[216:219], v102, s[4:7], s63 offen sc1
buffer_load_dwordx4 v[220:223], v102, s[4:7], s63 offen offset:1024 sc1
buffer_store_dword v83, v97, s[4:7], s74 offen sc1
s_cmp_lg_u32 s96, 0
s_cbranch_scc1 L_s1_4
L_s1_ret_4:
v_mov_b32 v78, s68
v_lshlrev_b32 v79, 3, v98
s_waitcnt vmcnt(1)
ds_write_b128 v102, v[216:219]
v_max_u32 v76, v216, v220
ds_write_b128 v102, v[220:223] offset:1024
v_cmp_eq_u32 vcc, -1, v76
s_cbranch_vccnz L_rg_4
L_rg_ret4:
s_cmp_lt_u32 s68, 63
s_waitcnt lgkmcnt(0)
s_barrier
ds_read_b128 v[0:3], v98 offset:0
ds_read_b128 v[4:7], v98 offset:1024
ds_read_b128 v[8:11], v98 offset:2048
ds_read_b128 v[12:15], v98 offset:3072
buffer_load_dwordx4 v[64:67], v102, s[4:7], s75 offen offset:0 sc1
buffer_load_dwordx4 v[68:71], v102, s[4:7], s75 offen offset:1024 sc1
s_cbranch_scc1 L_top4
s_branch L_final01
L_rg_4:
s_mov_b32 s57, 0
s_mov_b64 exec, vcc
buffer_load_dwordx4 v[216:219], v102, s[4:7], s63 offen sc1
buffer_load_dwordx4 v[220:223], v102, s[4:7], s63 offen offset:1024 sc1
s_sleep 2
buffer_load_dwordx4 v[216:219], v102, s[4:7], s63 offen sc1
buffer_load_dwordx4 v[220:223], v102, s[4:7], s63 offen offset:1024 sc1
s_branch L_rgw_4
L_rgl_4:
s_mov_b64 exec, vcc
buffer_load_dwordx4 v[216:219], v102, s[4:7], s63 offen sc1
buffer_load_dwordx4 v[220:223], v102, s[4:7], s63 offen offset:1024 sc1
s_add_u32 s57, s57, 0x2000
s_cbranch_scc1 L_end
L_rgw_4:
s_waitcnt vmcnt(2)
v_max3_u32 v76, v216, v217, v218
v_max3_u32 v77, v219, v220, v221
v_max3_u32 v76, v76, v222, v223
v_max_u32 v76, v76, v77
v_cmp_eq_u32 vcc, -1, v76
s_cbranch_vccnz L_rgl_4
s_mov_b64 exec, -1
ds_write_b128 v102, v[216:219]
ds_write_b128 v102, v[220:223] offset:1024
s_branch L_rg_ret4
L_s1_4:
s_sub_u32 s67, s68, 0xffffffff
s_min_u32 s67, s67, 63
v_cmp_ge_u32 vcc, s67, v108
s_cbranch_vccz L_s1ok_30
s_mov_b32 s57, 0
L_wf_31:
buffer_load_dword v108, v105, s[4:7], 0 offen offset:1024 sc1
s_add_u32 s57, s57, 1
s_cmp_ge_u32 s57, 524288
s_cbranch_scc1 L_end
s_waitcnt vmcnt(0)
v_cmp_ge_u32 vcc, s67, v108
s_cbranch_vccnz L_wf_31
L_s1ok_30:
v_cmp_gt_u32 vcc, 64, v108
s_cmp_lg_u64 vcc, 0
s_cselect_b64 s[96:97], -1, 0
s_mov_b32 s57, 0
L_s1b_4:
s_branch L_s1_ret_4
L_repoll4:
s_lshl_b64 s[88:89], vcc, 1
s_or_b64 vcc, vcc, s[88:89]
s_lshl_b64 s[88:89], vcc, 2
s_or_b64 exec, vcc, s[88:89]
buffer_load_dword v216, v104, s[4:7], s62 offen offset:0 sc1
buffer_load_dword v217, v104, s[4:7], s62 offen offset:256 sc1
buffer_load_dword v218, v104, s[4:7], s62 offen offset:512 sc1
buffer_load_dword v219, v104, s[4:7], s62 offen offset:768 sc1
buffer_load_dword v220, v104, s[4:7], s62 offen offset:1024 sc1
buffer_load_dword v221, v104, s[4:7], s62 offen offset:1280 sc1
buffer_load_dword v222, v104, s[4:7], s62 offen offset:1536 sc1
buffer_load_dword v223, v104, s[4:7], s62 offen offset:1792 sc1
s_mov_b64 exec, -1
v_mov_b64 v[80:81], 0
v_mov_b64 v[82:83], 0
s_add_u32 s57, s57, 0x2000
s_cbranch_scc1 L_end
s_waitcnt vmcnt(0)
v_smfmac_f32_16x16x64_bf16 v[80:83], v[76:79], v[216:223], v110
v_bitop3_b32 v0, v216, v217, v218 bitop3:0x7e
v_bitop3_b32 v1, v218, v219, v220 bitop3:0x7e
v_bitop3_b32 v2, v220, v221, v222 bitop3:0x7e
v_bitop3_b32 v3, v222, v223, s76 bitop3:0x7e
v_or3_b32 v0, v0, v1, v2
v_bitop3_b32 v0, v0, v111, v3 bitop3:0xc8
v_cmp_ne_u32 vcc, 0, v0
s_nop 0
v_cvt_pk_bf16_f32 v80, v80, v81
s_cbranch_vccz L_sum4
s_branch L_repoll4
L_max4:
v_max3_f32 v46, v32, v33, v34
v_max3_f32 v47, v35, v76, v77
v_max_f32 v46, v46, v47
s_nop 1
v_max_f32_dpp v46, v46, v46 row_ror:8 row_mask:0xf bank_mask:0xf
v_mov_b32 v47, v46
s_nop 1
v_permlane16_swap_b32 v46, v47
v_max_f32 v46, v46, v47
v_mov_b32 v47, v46
s_nop 1
v_permlane32_swap_b32 v46, v47
v_max_f32 v46, v46, v47
v_sub_f32 v32, v32, v46
v_exp_f32 v36, v32
v_sub_f32 v33, v33, v46
v_exp_f32 v37, v33
v_sub_f32 v34, v34, v46
v_exp_f32 v38, v34
v_sub_f32 v35, v35, v46
v_exp_f32 v39, v35
v_sub_f32 v76, v76, v46
v_exp_f32 v78, v76
v_sub_f32 v77, v77, v46
v_exp_f32 v79, v77
s_nop 0
v_cvt_pk_bf16_f32 v41, v78, v79
v_cvt_pk_bf16_f32 v42, v36, v37
v_cvt_pk_bf16_f32 v43, v38, v39
v_mov_b32_dpp v40, v41 row_ror:8 row_mask:0xf bank_mask:0xf
v_mov_b32_dpp v44, v42 row_ror:8 row_mask:0xf bank_mask:0xf
v_mov_b32_dpp v45, v43 row_ror:8 row_mask:0xf bank_mask:0xf
v_mfma_f32_16x16x16_bf16 v[216:219], v[92:93], v[40:41], 0
v_mfma_f32_16x16x16_bf16 v[220:223], v[94:95], v[40:41], 0
v_mfma_f32_16x16x32_bf16 v[80:83], v[88:91], v[40:43], 0
v_mfma_f32_16x16x32_bf16 v[216:219], v[64:67], v[42:45], v[216:219]
v_mfma_f32_16x16x32_bf16 v[220:223], v[68:71], v[42:45], v[220:223]
v_add_f32_dpp v80, v80, v80 row_ror:8 row_mask:0xf bank_mask:0xf
v_rcp_f32 v80, v80
s_nop 1
v_pk_mul_f32 v[216:217], v[216:217], v[80:81] op_sel_hi:[1,0]
v_pk_mul_f32 v[218:219], v[218:219], v[80:81] op_sel_hi:[1,0]
v_cvt_pk_bf16_f32 v216, v216, v217
v_cvt_pk_bf16_f32 v217, v218, v219
v_pk_mul_f32 v[220:221], v[220:221], v[80:81] op_sel_hi:[1,0]
v_pk_mul_f32 v[222:223], v[222:223], v[80:81] op_sel_hi:[1,0]
v_cvt_pk_bf16_f32 v218, v220, v221
v_cvt_pk_bf16_f32 v219, v222, v223
s_nop 0
v_mov_b32_dpp v218, v216 row_ror:8 row_mask:0xf bank_mask:0xc
v_mov_b32_dpp v219, v217 row_ror:8 row_mask:0xf bank_mask:0xc
ds_write_b64 v109, v[218:219] offset:1024
s_branch L_pv4
L_worker:
s_sub_u32 s42, s39, 32
v_and_b32 v1, 15, v0
v_lshrrev_b32 v2, 4, v0
v_lshlrev_b32 v3, 4, v0
s_mov_b32 s70, 0x5040100
s_mov_b32 s71, 0x7060302
s_cmp_lt_u32 s42, 32
s_cbranch_scc1 L_ln
s_and_b32 s56, s42, 31
s_cmp_lt_u32 s56, 30
s_cbranch_scc1 L_pre_done
s_lshr_b32 s58, s42, 5
s_lshl_b32 s58, s58, 1
s_add_u32 s56, s56, s58
s_sub_u32 s56, s56, 32
s_lshl_b32 s56, s56, 12
s_lshl_b32 s58, s38, 10
s_add_u32 s56, s56, s58
v_mov_b32 v8, 0
s_cmp_lg_u32 s56, 1024
s_cbranch_scc1 L_clr0
v_cmp_lt_u32 vcc, 47, v0
s_nop 1
v_cndmask_b32 v8, 0, 40, vcc
L_clr0:
v_mov_b32 v9, v8
v_mov_b32 v10, v8
v_mov_b32 v11, v8
buffer_store_dwordx4 v[8:11], v3, s[4:7], s56 offen sc1
s_waitcnt vmcnt(0)
s_barrier
s_cmp_lg_u32 s38, 0
s_cbranch_scc1 L_pre_done
s_mov_b64 exec, 1
v_mov_b32 v8, 64
v_mov_b32 v9, 1
global_atomic_add v8, v9, s[36:37] sc1
s_mov_b64 exec, -1
s_branch L_pre_done
L_ln:
s_lshl_b32 s56, s42, 14
s_lshl_b32 s58, s38, 12
s_add_u32 s56, s56, s58
buffer_load_dwordx4 v[8:11], v3, s[8:11], s56 offen offset:0
buffer_load_dwordx4 v[12:15], v3, s[8:11], s56 offen offset:1024
buffer_load_dwordx4 v[16:19], v3, s[8:11], s56 offen offset:2048
buffer_load_dwordx4 v[20:23], v3, s[8:11], s56 offen offset:3072
s_add_u32 s56, s56, 0x80000
buffer_load_dwordx4 v[128:131], v3, s[8:11], s56 offen offset:0
buffer_load_dwordx4 v[132:135], v3, s[8:11], s56 offen offset:1024
buffer_load_dwordx4 v[136:139], v3, s[8:11], s56 offen offset:2048
buffer_load_dwordx4 v[140:143], v3, s[8:11], s56 offen offset:3072
s_add_u32 s56, s56, 0x80000
buffer_load_dwordx4 v[144:147], v3, s[8:11], s56 offen offset:0
buffer_load_dwordx4 v[148:151], v3, s[8:11], s56 offen offset:1024
buffer_load_dwordx4 v[152:155], v3, s[8:11], s56 offen offset:2048
buffer_load_dwordx4 v[156:159], v3, s[8:11], s56 offen offset:3072
s_add_u32 s56, s56, 0x80000
buffer_load_dwordx4 v[160:163], v3, s[8:11], s56 offen offset:0
buffer_load_dwordx4 v[164:167], v3, s[8:11], s56 offen offset:1024
buffer_load_dwordx4 v[168:171], v3, s[8:11], s56 offen offset:2048
buffer_load_dwordx4 v[172:175], v3, s[8:11], s56 offen offset:3072
s_lshl_b32 s56, s42, 2
s_add_u32 s56, s56, s38
s_lshl_b32 s56, s56, 10
v_add_u32 v124, s56, v3
s_mov_b32 s20, s44
s_mov_b32 s21, s45
s_mov_b32 s22, 0x400000
s_mov_b32 s23, 0x20000
v_add_u32 v125, 0x0, v124
v_and_b32 v126, 0x7fff, v125
v_lshrrev_b32 v125, 15, v125
v_lshl_add_u32 v125, v125, 16, v126
s_mov_b32 s56, 32768
buffer_load_dwordx4 v[176:179], v125, s[20:23], s56 offen
v_add_u32 v125, 0xe0000, v124
v_and_b32 v126, 0x7fff, v125
v_lshrrev_b32 v125, 15, v125
v_lshl_add_u32 v125, v125, 16, v126
s_mov_b32 s56, 32768
buffer_load_dwordx4 v[176:179], v125, s[20:23], s56 offen
v_add_u32 v125, 0x1c0000, v124
v_and_b32 v126, 0x7fff, v125
v_lshrrev_b32 v125, 15, v125
v_lshl_add_u32 v125, v125, 16, v126
s_mov_b32 s56, 32768
buffer_load_dwordx4 v[176:179], v125, s[20:23], s56 offen
s_mov_b32 s24, s46
s_mov_b32 s25, s47
s_mov_b32 s26, 0x400000
s_mov_b32 s27, 0x20000
s_mov_b32 s56, 0x0
buffer_load_dwordx4 v[176:179], v124, s[24:27], s56 offen
s_mov_b32 s56, 0xe0000
buffer_load_dwordx4 v[176:179], v124, s[24:27], s56 offen
s_mov_b32 s56, 0x1c0000
buffer_load_dwordx4 v[176:179], v124, s[24:27], s56 offen
s_mov_b32 s56, 0x2a0000
buffer_load_dwordx4 v[176:179], v124, s[24:27], s56 offen
s_mov_b32 s56, 0x380000
buffer_load_dwordx4 v[176:179], v124, s[24:27], s56 offen
s_mov_b32 s28, s48
s_mov_b32 s29, s49
s_mov_b32 s30, 0x400000
s_mov_b32 s31, 0x20000
s_mov_b32 s56, 0x0
buffer_load_dwordx4 v[176:179], v124, s[28:31], s56 offen
s_mov_b32 s56, 0xe0000
buffer_load_dwordx4 v[176:179], v124, s[28:31], s56 offen
s_mov_b32 s56, 0x1c0000
buffer_load_dwordx4 v[176:179], v124, s[28:31], s56 offen
s_mov_b32 s56, 0x2a0000
buffer_load_dwordx4 v[176:179], v124, s[28:31], s56 offen
s_mov_b32 s56, 0x380000
buffer_load_dwordx4 v[176:179], v124, s[28:31], s56 offen
s_mov_b32 s20, s50
s_mov_b32 s21, s51
s_mov_b32 s22, 0x400000
s_mov_b32 s23, 0x20000
s_mov_b32 s56, 0x0
buffer_load_dwordx4 v[176:179], v124, s[20:23], s56 offen
s_mov_b32 s56, 0xe0000
buffer_load_dwordx4 v[176:179], v124, s[20:23], s56 offen
s_mov_b32 s56, 0x1c0000
buffer_load_dwordx4 v[176:179], v124, s[20:23], s56 offen
s_mov_b32 s56, 0x2a0000
buffer_load_dwordx4 v[176:179], v124, s[20:23], s56 offen
s_mov_b32 s56, 0x380000
buffer_load_dwordx4 v[176:179], v124, s[20:23], s56 offen
v_mov_b32 v121, 64
global_load_dword v122, v121, s[36:37] sc1
s_mov_b32 s60, s42
s_mov_b32 s61, 0
v_mov_b32 v25, 1
s_waitcnt vmcnt(19)
L_lnp:
v_lshlrev_b32 v32, 16, v8
v_and_b32 v33, 0xffff0000, v8
v_lshlrev_b32 v34, 16, v9
v_and_b32 v35, 0xffff0000, v9
v_lshlrev_b32 v36, 16, v10
v_and_b32 v37, 0xffff0000, v10
v_lshlrev_b32 v38, 16, v11
v_and_b32 v39, 0xffff0000, v11
v_add_f32 v64, v32, v33
v_add_f32 v64, v64, v34
v_add_f32 v64, v64, v35
v_add_f32 v64, v64, v36
v_add_f32 v64, v64, v37
v_add_f32 v64, v64, v38
v_add_f32 v64, v64, v39
v_lshlrev_b32 v40, 16, v12
v_and_b32 v41, 0xffff0000, v12
v_lshlrev_b32 v42, 16, v13
v_and_b32 v43, 0xffff0000, v13
v_lshlrev_b32 v44, 16, v14
v_and_b32 v45, 0xffff0000, v14
v_lshlrev_b32 v46, 16, v15
v_and_b32 v47, 0xffff0000, v15
v_add_f32 v65, v40, v41
v_add_f32 v65, v65, v42
v_add_f32 v65, v65, v43
v_add_f32 v65, v65, v44
v_add_f32 v65, v65, v45
v_add_f32 v65, v65, v46
v_add_f32 v65, v65, v47
v_lshlrev_b32 v48, 16, v16
v_and_b32 v49, 0xffff0000, v16
v_lshlrev_b32 v50, 16, v17
v_and_b32 v51, 0xffff0000, v17
v_lshlrev_b32 v52, 16, v18
v_and_b32 v53, 0xffff0000, v18
v_lshlrev_b32 v54, 16, v19
v_and_b32 v55, 0xffff0000, v19
v_add_f32 v66, v48, v49
v_add_f32 v66, v66, v50
v_add_f32 v66, v66, v51
v_add_f32 v66, v66, v52
v_add_f32 v66, v66, v53
v_add_f32 v66, v66, v54
v_add_f32 v66, v66, v55
v_lshlrev_b32 v56, 16, v20
v_and_b32 v57, 0xffff0000, v20
v_lshlrev_b32 v58, 16, v21
v_and_b32 v59, 0xffff0000, v21
v_lshlrev_b32 v60, 16, v22
v_and_b32 v61, 0xffff0000, v22
v_lshlrev_b32 v62, 16, v23
v_and_b32 v63, 0xffff0000, v23
v_add_f32 v67, v56, v57
v_add_f32 v67, v67, v58
v_add_f32 v67, v67, v59
v_add_f32 v67, v67, v60
v_add_f32 v67, v67, v61
v_add_f32 v67, v67, v62
v_add_f32 v67, v67, v63
v_add_f32_dpp v64, v64, v64 row_ror:8 row_mask:0xf bank_mask:0xf
v_add_f32_dpp v65, v65, v65 row_ror:8 row_mask:0xf bank_mask:0xf
v_add_f32_dpp v66, v66, v66 row_ror:8 row_mask:0xf bank_mask:0xf
v_add_f32_dpp v67, v67, v67 row_ror:8 row_mask:0xf bank_mask:0xf
v_add_f32_dpp v64, v64, v64 row_ror:4 row_mask:0xf bank_mask:0xf
v_add_f32_dpp v65, v65, v65 row_ror:4 row_mask:0xf bank_mask:0xf
v_add_f32_dpp v66, v66, v66 row_ror:4 row_mask:0xf bank_mask:0xf
v_add_f32_dpp v67, v67, v67 row_ror:4 row_mask:0xf bank_mask:0xf
v_add_f32_dpp v64, v64, v64 row_ror:2 row_mask:0xf bank_mask:0xf
v_add_f32_dpp v65, v65, v65 row_ror:2 row_mask:0xf bank_mask:0xf
v_add_f32_dpp v66, v66, v66 row_ror:2 row_mask:0xf bank_mask:0xf
v_add_f32_dpp v67, v67, v67 row_ror:2 row_mask:0xf bank_mask:0xf
v_add_f32_dpp v64, v64, v64 row_ror:1 row_mask:0xf bank_mask:0xf
v_add_f32_dpp v65, v65, v65 row_ror:1 row_mask:0xf bank_mask:0xf
v_add_f32_dpp v66, v66, v66 row_ror:1 row_mask:0xf bank_mask:0xf
v_add_f32_dpp v67, v67, v67 row_ror:1 row_mask:0xf bank_mask:0xf
v_mov_b32 v72, v64
v_mov_b32 v73, v65
v_mov_b32 v74, v66
v_mov_b32 v75, v67
v_permlane16_swap_b32 v64, v72
v_permlane16_swap_b32 v65, v73
v_permlane16_swap_b32 v66, v74
v_permlane16_swap_b32 v67, v75
v_add_f32 v64, v64, v72
v_add_f32 v65, v65, v73
v_add_f32 v66, v66, v74
v_add_f32 v67, v67, v75
v_mov_b32 v72, v64
v_mov_b32 v73, v65
v_mov_b32 v74, v66
v_mov_b32 v75, v67
v_permlane32_swap_b32 v64, v72
v_permlane32_swap_b32 v65, v73
v_permlane32_swap_b32 v66, v74
v_permlane32_swap_b32 v67, v75
v_add_f32 v64, v64, v72
v_add_f32 v65, v65, v73
v_add_f32 v66, v66, v74
v_add_f32 v67, v67, v75
v_mul_f32 v64, 0x3b000000, v64
v_sub_f32 v72, v32, v64
v_mul_f32 v68, v72, v72
v_sub_f32 v72, v33, v64
v_fmac_f32 v68, v72, v72
v_sub_f32 v72, v34, v64
v_fmac_f32 v68, v72, v72
v_sub_f32 v72, v35, v64
v_fmac_f32 v68, v72, v72
v_sub_f32 v72, v36, v64
v_fmac_f32 v68, v72, v72
v_sub_f32 v72, v37, v64
v_fmac_f32 v68, v72, v72
v_sub_f32 v72, v38, v64
v_fmac_f32 v68, v72, v72
v_sub_f32 v72, v39, v64
v_fmac_f32 v68, v72, v72
v_mul_f32 v65, 0x3b000000, v65
v_sub_f32 v72, v40, v65
v_mul_f32 v69, v72, v72
v_sub_f32 v72, v41, v65
v_fmac_f32 v69, v72, v72
v_sub_f32 v72, v42, v65
v_fmac_f32 v69, v72, v72
v_sub_f32 v72, v43, v65
v_fmac_f32 v69, v72, v72
v_sub_f32 v72, v44, v65
v_fmac_f32 v69, v72, v72
v_sub_f32 v72, v45, v65
v_fmac_f32 v69, v72, v72
v_sub_f32 v72, v46, v65
v_fmac_f32 v69, v72, v72
v_sub_f32 v72, v47, v65
v_fmac_f32 v69, v72, v72
v_mul_f32 v66, 0x3b000000, v66
v_sub_f32 v72, v48, v66
v_mul_f32 v70, v72, v72
v_sub_f32 v72, v49, v66
v_fmac_f32 v70, v72, v72
v_sub_f32 v72, v50, v66
v_fmac_f32 v70, v72, v72
v_sub_f32 v72, v51, v66
v_fmac_f32 v70, v72, v72
v_sub_f32 v72, v52, v66
v_fmac_f32 v70, v72, v72
v_sub_f32 v72, v53, v66
v_fmac_f32 v70, v72, v72
v_sub_f32 v72, v54, v66
v_fmac_f32 v70, v72, v72
v_sub_f32 v72, v55, v66
v_fmac_f32 v70, v72, v72
v_mul_f32 v67, 0x3b000000, v67
v_sub_f32 v72, v56, v67
v_mul_f32 v71, v72, v72
v_sub_f32 v72, v57, v67
v_fmac_f32 v71, v72, v72
v_sub_f32 v72, v58, v67
v_fmac_f32 v71, v72, v72
v_sub_f32 v72, v59, v67
v_fmac_f32 v71, v72, v72
v_sub_f32 v72, v60, v67
v_fmac_f32 v71, v72, v72
v_sub_f32 v72, v61, v67
v_fmac_f32 v71, v72, v72
v_sub_f32 v72, v62, v67
v_fmac_f32 v71, v72, v72
v_sub_f32 v72, v63, v67
v_fmac_f32 v71, v72, v72
v_add_f32_dpp v68, v68, v68 row_ror:8 row_mask:0xf bank_mask:0xf
v_add_f32_dpp v69, v69, v69 row_ror:8 row_mask:0xf bank_mask:0xf
v_add_f32_dpp v70, v70, v70 row_ror:8 row_mask:0xf bank_mask:0xf
v_add_f32_dpp v71, v71, v71 row_ror:8 row_mask:0xf bank_mask:0xf
v_add_f32_dpp v68, v68, v68 row_ror:4 row_mask:0xf bank_mask:0xf
v_add_f32_dpp v69, v69, v69 row_ror:4 row_mask:0xf bank_mask:0xf
v_add_f32_dpp v70, v70, v70 row_ror:4 row_mask:0xf bank_mask:0xf
v_add_f32_dpp v71, v71, v71 row_ror:4 row_mask:0xf bank_mask:0xf
v_add_f32_dpp v68, v68, v68 row_ror:2 row_mask:0xf bank_mask:0xf
v_add_f32_dpp v69, v69, v69 row_ror:2 row_mask:0xf bank_mask:0xf
v_add_f32_dpp v70, v70, v70 row_ror:2 row_mask:0xf bank_mask:0xf
v_add_f32_dpp v71, v71, v71 row_ror:2 row_mask:0xf bank_mask:0xf
v_add_f32_dpp v68, v68, v68 row_ror:1 row_mask:0xf bank_mask:0xf
v_add_f32_dpp v69, v69, v69 row_ror:1 row_mask:0xf bank_mask:0xf
v_add_f32_dpp v70, v70, v70 row_ror:1 row_mask:0xf bank_mask:0xf
v_add_f32_dpp v71, v71, v71 row_ror:1 row_mask:0xf bank_mask:0xf
v_mov_b32 v72, v68
v_mov_b32 v73, v69
v_mov_b32 v74, v70
v_mov_b32 v75, v71
v_permlane16_swap_b32 v68, v72
v_permlane16_swap_b32 v69, v73
v_permlane16_swap_b32 v70, v74
v_permlane16_swap_b32 v71, v75
v_add_f32 v68, v68, v72
v_add_f32 v69, v69, v73
v_add_f32 v70, v70, v74
v_add_f32 v71, v71, v75
v_mov_b32 v72, v68
v_mov_b32 v73, v69
v_mov_b32 v74, v70
v_mov_b32 v75, v71
v_permlane32_swap_b32 v68, v72
v_permlane32_swap_b32 v69, v73
v_permlane32_swap_b32 v70, v74
v_permlane32_swap_b32 v71, v75
v_add_f32 v68, v68, v72
v_add_f32 v69, v69, v73
v_add_f32 v70, v70, v74
v_add_f32 v71, v71, v75
v_mul_f32 v68, 0x3b000000, v68
v_cvt_pk_bf16_f32 v68, v68, v68
v_lshlrev_b32 v68, 16, v68
v_cvt_pk_bf16_f32 v64, v64, v64
v_lshlrev_b32 v64, 16, v64
v_add_f32 v68, 0x3727c5ac, v68
v_cvt_pk_bf16_f32 v68, v68, v68
v_lshlrev_b32 v68, 16, v68
v_sqrt_f32 v68, v68
s_nop 0
v_cvt_pk_bf16_f32 v68, v68, v68
v_lshlrev_b32 v68, 16, v68
v_rcp_f32 v76, v68
v_sub_f32 v32, v32, v64
v_sub_f32 v33, v33, v64
v_cvt_pk_bf16_f32 v72, v32, v33
v_lshlrev_b32 v32, 16, v72
v_and_b32 v33, 0xffff0000, v72
v_mul_f32 v72, v32, v76
v_mul_f32 v73, v33, v76
v_fma_f32 v32, -v72, v68, v32
v_fma_f32 v33, -v73, v68, v33
v_fmac_f32 v72, v32, v76
v_fmac_f32 v73, v33, v76
v_cvt_pk_bf16_f32 v8, v72, v73
v_sub_f32 v34, v34, v64
v_sub_f32 v35, v35, v64
v_cvt_pk_bf16_f32 v72, v34, v35
v_lshlrev_b32 v34, 16, v72
v_and_b32 v35, 0xffff0000, v72
v_mul_f32 v72, v34, v76
v_mul_f32 v73, v35, v76
v_fma_f32 v34, -v72, v68, v34
v_fma_f32 v35, -v73, v68, v35
v_fmac_f32 v72, v34, v76
v_fmac_f32 v73, v35, v76
v_cvt_pk_bf16_f32 v9, v72, v73
v_sub_f32 v36, v36, v64
v_sub_f32 v37, v37, v64
v_cvt_pk_bf16_f32 v72, v36, v37
v_lshlrev_b32 v36, 16, v72
v_and_b32 v37, 0xffff0000, v72
v_mul_f32 v72, v36, v76
v_mul_f32 v73, v37, v76
v_fma_f32 v36, -v72, v68, v36
v_fma_f32 v37, -v73, v68, v37
v_fmac_f32 v72, v36, v76
v_fmac_f32 v73, v37, v76
v_cvt_pk_bf16_f32 v10, v72, v73
v_sub_f32 v38, v38, v64
v_sub_f32 v39, v39, v64
v_cvt_pk_bf16_f32 v72, v38, v39
v_lshlrev_b32 v38, 16, v72
v_and_b32 v39, 0xffff0000, v72
v_mul_f32 v72, v38, v76
v_mul_f32 v73, v39, v76
v_fma_f32 v38, -v72, v68, v38
v_fma_f32 v39, -v73, v68, v39
v_fmac_f32 v72, v38, v76
v_fmac_f32 v73, v39, v76
v_cvt_pk_bf16_f32 v11, v72, v73
v_mul_f32 v69, 0x3b000000, v69
v_cvt_pk_bf16_f32 v69, v69, v69
v_lshlrev_b32 v69, 16, v69
v_cvt_pk_bf16_f32 v65, v65, v65
v_lshlrev_b32 v65, 16, v65
v_add_f32 v69, 0x3727c5ac, v69
v_cvt_pk_bf16_f32 v69, v69, v69
v_lshlrev_b32 v69, 16, v69
v_sqrt_f32 v69, v69
s_nop 0
v_cvt_pk_bf16_f32 v69, v69, v69
v_lshlrev_b32 v69, 16, v69
v_rcp_f32 v76, v69
v_sub_f32 v40, v40, v65
v_sub_f32 v41, v41, v65
v_cvt_pk_bf16_f32 v72, v40, v41
v_lshlrev_b32 v40, 16, v72
v_and_b32 v41, 0xffff0000, v72
v_mul_f32 v72, v40, v76
v_mul_f32 v73, v41, v76
v_fma_f32 v40, -v72, v69, v40
v_fma_f32 v41, -v73, v69, v41
v_fmac_f32 v72, v40, v76
v_fmac_f32 v73, v41, v76
v_cvt_pk_bf16_f32 v12, v72, v73
v_sub_f32 v42, v42, v65
v_sub_f32 v43, v43, v65
v_cvt_pk_bf16_f32 v72, v42, v43
v_lshlrev_b32 v42, 16, v72
v_and_b32 v43, 0xffff0000, v72
v_mul_f32 v72, v42, v76
v_mul_f32 v73, v43, v76
v_fma_f32 v42, -v72, v69, v42
v_fma_f32 v43, -v73, v69, v43
v_fmac_f32 v72, v42, v76
v_fmac_f32 v73, v43, v76
v_cvt_pk_bf16_f32 v13, v72, v73
v_sub_f32 v44, v44, v65
v_sub_f32 v45, v45, v65
v_cvt_pk_bf16_f32 v72, v44, v45
v_lshlrev_b32 v44, 16, v72
v_and_b32 v45, 0xffff0000, v72
v_mul_f32 v72, v44, v76
v_mul_f32 v73, v45, v76
v_fma_f32 v44, -v72, v69, v44
v_fma_f32 v45, -v73, v69, v45
v_fmac_f32 v72, v44, v76
v_fmac_f32 v73, v45, v76
v_cvt_pk_bf16_f32 v14, v72, v73
v_sub_f32 v46, v46, v65
v_sub_f32 v47, v47, v65
v_cvt_pk_bf16_f32 v72, v46, v47
v_lshlrev_b32 v46, 16, v72
v_and_b32 v47, 0xffff0000, v72
v_mul_f32 v72, v46, v76
v_mul_f32 v73, v47, v76
v_fma_f32 v46, -v72, v69, v46
v_fma_f32 v47, -v73, v69, v47
v_fmac_f32 v72, v46, v76
v_fmac_f32 v73, v47, v76
v_cvt_pk_bf16_f32 v15, v72, v73
v_mul_f32 v70, 0x3b000000, v70
v_cvt_pk_bf16_f32 v70, v70, v70
v_lshlrev_b32 v70, 16, v70
v_cvt_pk_bf16_f32 v66, v66, v66
v_lshlrev_b32 v66, 16, v66
v_add_f32 v70, 0x3727c5ac, v70
v_cvt_pk_bf16_f32 v70, v70, v70
v_lshlrev_b32 v70, 16, v70
v_sqrt_f32 v70, v70
s_nop 0
v_cvt_pk_bf16_f32 v70, v70, v70
v_lshlrev_b32 v70, 16, v70
v_rcp_f32 v76, v70
v_sub_f32 v48, v48, v66
v_sub_f32 v49, v49, v66
v_cvt_pk_bf16_f32 v72, v48, v49
v_lshlrev_b32 v48, 16, v72
v_and_b32 v49, 0xffff0000, v72
v_mul_f32 v72, v48, v76
v_mul_f32 v73, v49, v76
v_fma_f32 v48, -v72, v70, v48
v_fma_f32 v49, -v73, v70, v49
v_fmac_f32 v72, v48, v76
v_fmac_f32 v73, v49, v76
v_cvt_pk_bf16_f32 v16, v72, v73
v_sub_f32 v50, v50, v66
v_sub_f32 v51, v51, v66
v_cvt_pk_bf16_f32 v72, v50, v51
v_lshlrev_b32 v50, 16, v72
v_and_b32 v51, 0xffff0000, v72
v_mul_f32 v72, v50, v76
v_mul_f32 v73, v51, v76
v_fma_f32 v50, -v72, v70, v50
v_fma_f32 v51, -v73, v70, v51
v_fmac_f32 v72, v50, v76
v_fmac_f32 v73, v51, v76
v_cvt_pk_bf16_f32 v17, v72, v73
v_sub_f32 v52, v52, v66
v_sub_f32 v53, v53, v66
v_cvt_pk_bf16_f32 v72, v52, v53
v_lshlrev_b32 v52, 16, v72
v_and_b32 v53, 0xffff0000, v72
v_mul_f32 v72, v52, v76
v_mul_f32 v73, v53, v76
v_fma_f32 v52, -v72, v70, v52
v_fma_f32 v53, -v73, v70, v53
v_fmac_f32 v72, v52, v76
v_fmac_f32 v73, v53, v76
v_cvt_pk_bf16_f32 v18, v72, v73
v_sub_f32 v54, v54, v66
v_sub_f32 v55, v55, v66
v_cvt_pk_bf16_f32 v72, v54, v55
v_lshlrev_b32 v54, 16, v72
v_and_b32 v55, 0xffff0000, v72
v_mul_f32 v72, v54, v76
v_mul_f32 v73, v55, v76
v_fma_f32 v54, -v72, v70, v54
v_fma_f32 v55, -v73, v70, v55
v_fmac_f32 v72, v54, v76
v_fmac_f32 v73, v55, v76
v_cvt_pk_bf16_f32 v19, v72, v73
v_mul_f32 v71, 0x3b000000, v71
v_cvt_pk_bf16_f32 v71, v71, v71
v_lshlrev_b32 v71, 16, v71
v_cvt_pk_bf16_f32 v67, v67, v67
v_lshlrev_b32 v67, 16, v67
v_add_f32 v71, 0x3727c5ac, v71
v_cvt_pk_bf16_f32 v71, v71, v71
v_lshlrev_b32 v71, 16, v71
v_sqrt_f32 v71, v71
s_nop 0
v_cvt_pk_bf16_f32 v71, v71, v71
v_lshlrev_b32 v71, 16, v71
v_rcp_f32 v76, v71
v_sub_f32 v56, v56, v67
v_sub_f32 v57, v57, v67
v_cvt_pk_bf16_f32 v72, v56, v57
v_lshlrev_b32 v56, 16, v72
v_and_b32 v57, 0xffff0000, v72
v_mul_f32 v72, v56, v76
v_mul_f32 v73, v57, v76
v_fma_f32 v56, -v72, v71, v56
v_fma_f32 v57, -v73, v71, v57
v_fmac_f32 v72, v56, v76
v_fmac_f32 v73, v57, v76
v_cvt_pk_bf16_f32 v20, v72, v73
v_sub_f32 v58, v58, v67
v_sub_f32 v59, v59, v67
v_cvt_pk_bf16_f32 v72, v58, v59
v_lshlrev_b32 v58, 16, v72
v_and_b32 v59, 0xffff0000, v72
v_mul_f32 v72, v58, v76
v_mul_f32 v73, v59, v76
v_fma_f32 v58, -v72, v71, v58
v_fma_f32 v59, -v73, v71, v59
v_fmac_f32 v72, v58, v76
v_fmac_f32 v73, v59, v76
v_cvt_pk_bf16_f32 v21, v72, v73
v_sub_f32 v60, v60, v67
v_sub_f32 v61, v61, v67
v_cvt_pk_bf16_f32 v72, v60, v61
v_lshlrev_b32 v60, 16, v72
v_and_b32 v61, 0xffff0000, v72
v_mul_f32 v72, v60, v76
v_mul_f32 v73, v61, v76
v_fma_f32 v60, -v72, v71, v60
v_fma_f32 v61, -v73, v71, v61
v_fmac_f32 v72, v60, v76
v_fmac_f32 v73, v61, v76
v_cvt_pk_bf16_f32 v22, v72, v73
v_sub_f32 v62, v62, v67
v_sub_f32 v63, v63, v67
v_cvt_pk_bf16_f32 v72, v62, v63
v_lshlrev_b32 v62, 16, v72
v_and_b32 v63, 0xffff0000, v72
v_mul_f32 v72, v62, v76
v_mul_f32 v73, v63, v76
v_fma_f32 v62, -v72, v71, v62
v_fma_f32 v63, -v73, v71, v63
v_fmac_f32 v72, v62, v76
v_fmac_f32 v73, v63, v76
v_cvt_pk_bf16_f32 v23, v72, v73
v_lshlrev_b32 v4, 8, v0
s_lshl_b32 s56, s38, 6
s_add_u32 s56, s56, s61
v_add_u32 v4, s56, v4
ds_write_b128 v4, v[8:11] offset:0
ds_write_b128 v4, v[12:15] offset:16
ds_write_b128 v4, v[16:19] offset:32
ds_write_b128 v4, v[20:23] offset:48
s_lshl_b32 s56, s38, 12
v_add_u32 v4, s56, v3
v_add_u32 v24, s61, v4
s_cmp_eq_u32 s61, 0
s_cbranch_scc1 L_lnp_w
s_waitcnt vmcnt(0)
L_lnp_w:
s_waitcnt lgkmcnt(0)
s_barrier
s_cmp_lg_u32 s38, 0
s_cbranch_scc1 L_lnp_a
s_cmp_eq_u32 s61, 0
s_cbranch_scc1 L_lnp_a
v_cmp_gt_u32 vcc, 12, v122
s_cbranch_vccz L_lnp_a_clr
s_mov_b32 s57, 0
v_mov_b32 v121, 64
L_wd_32:
global_load_dword v122, v121, s[36:37] sc1
s_add_u32 s57, s57, 1
s_cmp_ge_u32 s57, 524288
s_cbranch_scc1 L_end
s_waitcnt vmcnt(0)
v_cmp_gt_u32 vcc, 12, v122
s_cbranch_vccnz L_wd_32
L_lnp_a_clr:
s_lshl_b32 s58, s60, 2
s_sub_u32 s58, s58, 128
s_mov_b64 exec, 1
buffer_store_dword v25, off, s[4:7], s58 offset:0 sc1
s_mov_b64 exec, -1
L_lnp_a:
ds_read_b128 v[8:11], v24 offset:0
ds_read_b128 v[12:15], v24 offset:1024
ds_read_b128 v[16:19], v24 offset:2048
ds_read_b128 v[20:23], v24 offset:3072
s_lshl_b32 s58, s60, 14
s_add_u32 s56, s58, 2097152
s_waitcnt lgkmcnt(0)
buffer_store_dwordx4 v[8:11], v4, s[4:7], s56 offen offset:0 sc1
buffer_store_dwordx4 v[12:15], v4, s[4:7], s56 offen offset:1024 sc1
buffer_store_dwordx4 v[16:19], v4, s[4:7], s56 offen offset:2048 sc1
buffer_store_dwordx4 v[20:23], v4, s[4:7], s56 offen offset:3072 sc1
v_mov_b32 v8, v128
v_mov_b32 v9, v129
v_mov_b32 v10, v130
v_mov_b32 v11, v131
v_mov_b32 v12, v132
v_mov_b32 v13, v133
v_mov_b32 v14, v134
v_mov_b32 v15, v135
v_mov_b32 v16, v136
v_mov_b32 v17, v137
v_mov_b32 v18, v138
v_mov_b32 v19, v139
v_mov_b32 v20, v140
v_mov_b32 v21, v141
v_mov_b32 v22, v142
v_mov_b32 v23, v143
v_mov_b32 v128, v144
v_mov_b32 v129, v145
v_mov_b32 v130, v146
v_mov_b32 v131, v147
v_mov_b32 v132, v148
v_mov_b32 v133, v149
v_mov_b32 v134, v150
v_mov_b32 v135, v151
v_mov_b32 v136, v152
v_mov_b32 v137, v153
v_mov_b32 v138, v154
v_mov_b32 v139, v155
v_mov_b32 v140, v156
v_mov_b32 v141, v157
v_mov_b32 v142, v158
v_mov_b32 v143, v159
v_mov_b32 v144, v160
v_mov_b32 v145, v161
v_mov_b32 v146, v162
v_mov_b32 v147, v163
v_mov_b32 v148, v164
v_mov_b32 v149, v165
v_mov_b32 v150, v166
v_mov_b32 v151, v167
v_mov_b32 v152, v168
v_mov_b32 v153, v169
v_mov_b32 v154, v170
v_mov_b32 v155, v171
v_mov_b32 v156, v172
v_mov_b32 v157, v173
v_mov_b32 v158, v174
v_mov_b32 v159, v175
s_add_u32 s60, s60, 32
s_add_u32 s61, s61, 0x4000
s_cmp_lt_u32 s60, 128
s_cbranch_scc1 L_lnp
s_waitcnt vmcnt(0)
s_barrier
s_cmp_lg_u32 s38, 0
s_cbranch_scc1 L_lnp_b
s_cmp_eq_u32 s61, 0
s_cbranch_scc1 L_lnp_b
v_cmp_gt_u32 vcc, 12, v122
s_cbranch_vccz L_lnp_b_clr
s_mov_b32 s57, 0
v_mov_b32 v121, 64
L_wd_33:
global_load_dword v122, v121, s[36:37] sc1
s_add_u32 s57, s57, 1
s_cmp_ge_u32 s57, 524288
s_cbranch_scc1 L_end
s_waitcnt vmcnt(0)
v_cmp_gt_u32 vcc, 12, v122
s_cbranch_vccnz L_wd_33
L_lnp_b_clr:
s_lshl_b32 s58, s60, 2
s_sub_u32 s58, s58, 128
s_mov_b64 exec, 1
buffer_store_dword v25, off, s[4:7], s58 offset:0 sc1
s_mov_b64 exec, -1
L_lnp_b:
s_branch L_nos2
L_pre_done:
s_lshl_b32 s56, s42, 2
s_add_u32 s56, s56, s38
s_lshl_b32 s56, s56, 10
v_add_u32 v124, s56, v3
s_mov_b32 s20, s44
s_mov_b32 s21, s45
s_mov_b32 s22, 0x400000
s_mov_b32 s23, 0x20000
v_add_u32 v125, 0x0, v124
v_and_b32 v126, 0x7fff, v125
v_lshrrev_b32 v125, 15, v125
v_lshl_add_u32 v125, v125, 16, v126
s_mov_b32 s56, 32768
buffer_load_dwordx4 v[176:179], v125, s[20:23], s56 offen
v_add_u32 v125, 0xe0000, v124
v_and_b32 v126, 0x7fff, v125
v_lshrrev_b32 v125, 15, v125
v_lshl_add_u32 v125, v125, 16, v126
s_mov_b32 s56, 32768
buffer_load_dwordx4 v[176:179], v125, s[20:23], s56 offen
v_add_u32 v125, 0x1c0000, v124
v_and_b32 v126, 0x7fff, v125
v_lshrrev_b32 v125, 15, v125
v_lshl_add_u32 v125, v125, 16, v126
s_mov_b32 s56, 32768
buffer_load_dwordx4 v[176:179], v125, s[20:23], s56 offen
s_waitcnt vmcnt(0)
s_mov_b32 s24, s46
s_mov_b32 s25, s47
s_mov_b32 s26, 0x400000
s_mov_b32 s27, 0x20000
s_mov_b32 s56, 0x0
buffer_load_dwordx4 v[176:179], v124, s[24:27], s56 offen
s_mov_b32 s56, 0xe0000
buffer_load_dwordx4 v[176:179], v124, s[24:27], s56 offen
s_mov_b32 s56, 0x1c0000
buffer_load_dwordx4 v[176:179], v124, s[24:27], s56 offen
s_mov_b32 s56, 0x2a0000
buffer_load_dwordx4 v[176:179], v124, s[24:27], s56 offen
s_mov_b32 s56, 0x380000
buffer_load_dwordx4 v[176:179], v124, s[24:27], s56 offen
s_waitcnt vmcnt(0)
s_mov_b32 s28, s48
s_mov_b32 s29, s49
s_mov_b32 s30, 0x400000
s_mov_b32 s31, 0x20000
s_mov_b32 s56, 0x0
buffer_load_dwordx4 v[176:179], v124, s[28:31], s56 offen
s_mov_b32 s56, 0xe0000
buffer_load_dwordx4 v[176:179], v124, s[28:31], s56 offen
s_mov_b32 s56, 0x1c0000
buffer_load_dwordx4 v[176:179], v124, s[28:31], s56 offen
s_mov_b32 s56, 0x2a0000
buffer_load_dwordx4 v[176:179], v124, s[28:31], s56 offen
s_mov_b32 s56, 0x380000
buffer_load_dwordx4 v[176:179], v124, s[28:31], s56 offen
s_waitcnt vmcnt(0)
s_mov_b32 s20, s50
s_mov_b32 s21, s51
s_mov_b32 s22, 0x400000
s_mov_b32 s23, 0x20000
s_mov_b32 s56, 0x0
buffer_load_dwordx4 v[176:179], v124, s[20:23], s56 offen
s_mov_b32 s56, 0xe0000
buffer_load_dwordx4 v[176:179], v124, s[20:23], s56 offen
s_mov_b32 s56, 0x1c0000
buffer_load_dwordx4 v[176:179], v124, s[20:23], s56 offen
s_mov_b32 s56, 0x2a0000
buffer_load_dwordx4 v[176:179], v124, s[20:23], s56 offen
s_mov_b32 s56, 0x380000
buffer_load_dwordx4 v[176:179], v124, s[20:23], s56 offen
L_warm_done:
s_lshr_b32 s56, s42, 5
s_sub_u32 s56, s56, 1
s_and_b32 s58, s42, 31
s_cmp_eq_u32 s56, 5
s_cselect_b32 s59, 30, 27
s_cmp_ge_u32 s58, s59
s_cbranch_scc1 L_s1_none
s_mul_i32 s56, s56, 27
s_add_u32 s56, s56, s58
s_mul_i32 s43, s56, 0x5556
s_lshr_b32 s43, s43, 16
s_mul_i32 s58, s43, 3
s_sub_u32 s79, s56, s58
s_sub_u32 s56, s43, 16
s_cmp_lt_u32 s56, 32
s_cselect_b32 s59, 0, 0
s_add_u32 s59, s59, s79
s_mov_b32 s78, 3
s_sub_u32 s73, 66, s59
s_mul_i32 s73, s73, 0x5556
s_lshr_b32 s73, s73, 16
s_mov_b32 s16, s44
s_mov_b32 s17, s45
s_cmp_ge_u32 s43, 16
s_cselect_b32 s16, s46, s16
s_cselect_b32 s17, s47, s17
s_cmp_ge_u32 s43, 32
s_cselect_b32 s16, s48, s16
s_cselect_b32 s17, s49, s17
s_mov_b32 s18, 0x400000
s_mov_b32 s60, 8192
s_cmp_ge_u32 s43, 48
s_cselect_b32 s16, s52, s16
s_cselect_b32 s17, s53, s17
s_cselect_b32 s18, 0x1c0000, s18
s_cselect_b32 s60, 3584, s60
s_mov_b32 s19, 0x20000
s_and_b32 s61, s43, 15
s_lshl_b32 s56, s61, 9
s_lshl_b32 s58, s38, 7
s_add_u32 s56, s56, s58
s_lshl_b32 s58, s60, 3
v_mul_lo_u32 v120, s58, v2
v_lshlrev_b32 v5, 2, v1
v_add3_u32 v120, v120, v5, s56
s_sub_u32 s56, s43, 16
s_cmp_lt_u32 s56, 32
s_cbranch_scc1 L_s1_first
s_mov_b32 s57, 0
v_mov_b32 v121, 64
L_wd_34:
global_load_dword v122, v121, s[36:37] sc1
s_add_u32 s57, s57, 1
s_cmp_ge_u32 s57, 524288
s_cbranch_scc1 L_end
s_waitcnt vmcnt(0)
v_cmp_gt_u32 vcc, 12, v122
s_cbranch_vccnz L_wd_34
s_and_b32 s58, s42, 31
s_lshl_b32 s58, s58, 2
s_add_u32 s58, s58, 384
v_mov_b32 v121, 0
s_mov_b32 s57, 0
L_wf_35:
buffer_load_dword v8, v121, s[4:7], s58 offen offset:0 sc1
s_add_u32 s57, s57, 1
s_cmp_ge_u32 s57, 524288
s_cbranch_scc1 L_end
s_waitcnt vmcnt(0)
v_cmp_ge_u32 vcc, 0, v8
s_cbranch_vccz L_wfx_36
s_sleep 8
s_branch L_wf_35
L_wfx_36:
L_s1_first:
s_mul_i32 s56, s60, 0
buffer_load_dword v128, v120, s[16:19], s56 offen offset:0
s_mul_i32 s56, s60, 1
buffer_load_dword v129, v120, s[16:19], s56 offen offset:0
s_mul_i32 s56, s60, 2
buffer_load_dword v130, v120, s[16:19], s56 offen offset:0
s_mul_i32 s56, s60, 3
buffer_load_dword v131, v120, s[16:19], s56 offen offset:0
s_mul_i32 s56, s60, 4
buffer_load_dword v132, v120, s[16:19], s56 offen offset:0
s_mul_i32 s56, s60, 5
buffer_load_dword v133, v120, s[16:19], s56 offen offset:0
s_mul_i32 s56, s60, 6
buffer_load_dword v134, v120, s[16:19], s56 offen offset:0
s_mul_i32 s56, s60, 7
buffer_load_dword v135, v120, s[16:19], s56 offen offset:0
s_mul_i32 s56, s60, 0
buffer_load_dword v136, v120, s[16:19], s56 offen offset:64
s_mul_i32 s56, s60, 1
buffer_load_dword v137, v120, s[16:19], s56 offen offset:64
s_mul_i32 s56, s60, 2
buffer_load_dword v138, v120, s[16:19], s56 offen offset:64
s_mul_i32 s56, s60, 3
buffer_load_dword v139, v120, s[16:19], s56 offen offset:64
s_mul_i32 s56, s60, 4
buffer_load_dword v140, v120, s[16:19], s56 offen offset:64
s_mul_i32 s56, s60, 5
buffer_load_dword v141, v120, s[16:19], s56 offen offset:64
s_mul_i32 s56, s60, 6
buffer_load_dword v142, v120, s[16:19], s56 offen offset:64
s_mul_i32 s56, s60, 7
buffer_load_dword v143, v120, s[16:19], s56 offen offset:64
s_mul_i32 s56, s60, 32
buffer_load_dword v144, v120, s[16:19], s56 offen offset:0
s_mul_i32 s56, s60, 33
buffer_load_dword v145, v120, s[16:19], s56 offen offset:0
s_mul_i32 s56, s60, 34
buffer_load_dword v146, v120, s[16:19], s56 offen offset:0
s_mul_i32 s56, s60, 35
buffer_load_dword v147, v120, s[16:19], s56 offen offset:0
s_mul_i32 s56, s60, 36
buffer_load_dword v148, v120, s[16:19], s56 offen offset:0
s_mul_i32 s56, s60, 37
buffer_load_dword v149, v120, s[16:19], s56 offen offset:0
s_mul_i32 s56, s60, 38
buffer_load_dword v150, v120, s[16:19], s56 offen offset:0
s_mul_i32 s56, s60, 39
buffer_load_dword v151, v120, s[16:19], s56 offen offset:0
s_mul_i32 s56, s60, 32
buffer_load_dword v152, v120, s[16:19], s56 offen offset:64
s_mul_i32 s56, s60, 33
buffer_load_dword v153, v120, s[16:19], s56 offen offset:64
s_mul_i32 s56, s60, 34
buffer_load_dword v154, v120, s[16:19], s56 offen offset:64
s_mul_i32 s56, s60, 35
buffer_load_dword v155, v120, s[16:19], s56 offen offset:64
s_mul_i32 s56, s60, 36
buffer_load_dword v156, v120, s[16:19], s56 offen offset:64
s_mul_i32 s56, s60, 37
buffer_load_dword v157, v120, s[16:19], s56 offen offset:64
s_mul_i32 s56, s60, 38
buffer_load_dword v158, v120, s[16:19], s56 offen offset:64
s_mul_i32 s56, s60, 39
buffer_load_dword v159, v120, s[16:19], s56 offen offset:64
s_lshl_b32 s56, s61, 14
s_lshr_b32 s58, s38, 1
s_lshl_b32 s58, s58, 13
s_add_u32 s56, s56, s58
s_and_b32 s58, s38, 1
s_lshl_b32 s58, s58, 12
s_add_u32 s56, s56, s58
s_lshr_b32 s58, s43, 4
s_add_u32 s58, s58, 1
s_lshl_b32 s58, s58, 24
s_add_u32 s62, s56, s58
s_mov_b32 s63, 0x40000
s_mov_b32 s64, 1024
s_mov_b32 s65, 2048
s_mov_b32 s66, 0x80008000
s_cmp_lt_u32 s43, 48
s_cbranch_scc1 L_s1_addr
s_lshl_b32 s56, s61, 13
s_lshl_b32 s58, s38, 11
s_add_u32 s56, s56, s58
s_add_u32 s62, s56, 83886080
s_mov_b32 s63, 114688
s_mov_b32 s64, 57344
s_mov_b32 s65, 1024
s_mov_b32 s66, 0
L_s1_addr:
s_mul_i32 s56, s63, s59
s_add_u32 s62, s62, s56
s_mul_i32 s63, s63, s78
s_lshl_b32 s41, s78, 15
s_sub_u32 s62, s62, s63
s_sub_u32 s62, s62, s63
s_lshl_b32 s56, s38, 13
v_add_u32 v5, s56, v3
v_mov_b32 v11, v5
v_mov_b32 v10, 0x7fffff00
s_cmp_eq_u32 s38, 0
s_cselect_b32 s56, 0, 0x7fffff00
v_mov_b32 v9, s56
v_and_b32 v6, 1, v0
v_lshlrev_b32 v6, 2, v6
v_lshrrev_b32 v8, 1, v0
s_sub_u32 s56, s73, 1
s_lshl_b32 s58, s78, 3
v_min_u32 v12, s56, v8
v_mul_u32_u24 v12, s58, v12
v_add_u32 v12, v12, v6
v_min_u32 v8, 4, v8
v_mul_u32_u24 v8, 24, v8
v_add_u32 v6, v8, v6
s_lshl_b32 s67, s59, 15
s_add_u32 s67, s67, 2097152
s_add_u32 s77, s67, 0x1000
s_lshl_b32 s68, s59, 3
s_add_u32 s68, s68, 0
s_lshl_b32 s69, s79, 8
s_lshl_b32 s56, s43, 2
s_add_u32 s69, s69, s56
s_add_u32 s69, s69, 1024
s_mov_b32 s72, 0
s_mul_i32 s56, s60, 64
buffer_load_dword v160, v120, s[16:19], s56 offen offset:0
s_mul_i32 s56, s60, 65
buffer_load_dword v161, v120, s[16:19], s56 offen offset:0
s_mul_i32 s56, s60, 66
buffer_load_dword v162, v120, s[16:19], s56 offen offset:0
s_mul_i32 s56, s60, 67
buffer_load_dword v163, v120, s[16:19], s56 offen offset:0
s_mul_i32 s56, s60, 68
buffer_load_dword v164, v120, s[16:19], s56 offen offset:0
s_mul_i32 s56, s60, 69
buffer_load_dword v165, v120, s[16:19], s56 offen offset:0
s_mul_i32 s56, s60, 70
buffer_load_dword v166, v120, s[16:19], s56 offen offset:0
s_mul_i32 s56, s60, 71
buffer_load_dword v167, v120, s[16:19], s56 offen offset:0
s_mul_i32 s56, s60, 64
buffer_load_dword v168, v120, s[16:19], s56 offen offset:64
s_mul_i32 s56, s60, 65
buffer_load_dword v169, v120, s[16:19], s56 offen offset:64
s_mul_i32 s56, s60, 66
buffer_load_dword v170, v120, s[16:19], s56 offen offset:64
s_mul_i32 s56, s60, 67
buffer_load_dword v171, v120, s[16:19], s56 offen offset:64
s_mul_i32 s56, s60, 68
buffer_load_dword v172, v120, s[16:19], s56 offen offset:64
s_mul_i32 s56, s60, 69
buffer_load_dword v173, v120, s[16:19], s56 offen offset:64
s_mul_i32 s56, s60, 70
buffer_load_dword v174, v120, s[16:19], s56 offen offset:64
s_mul_i32 s56, s60, 71
buffer_load_dword v175, v120, s[16:19], s56 offen offset:64
s_waitcnt vmcnt(32)
v_perm_b32 v123, v129, v128, s70
v_accvgpr_write_b32 a0, v123
v_perm_b32 v123, v129, v128, s71
v_accvgpr_write_b32 a64, v123
v_perm_b32 v123, v131, v130, s70
v_accvgpr_write_b32 a1, v123
v_perm_b32 v123, v131, v130, s71
v_accvgpr_write_b32 a65, v123
v_perm_b32 v123, v133, v132, s70
v_accvgpr_write_b32 a2, v123
v_perm_b32 v123, v133, v132, s71
v_accvgpr_write_b32 a66, v123
v_perm_b32 v123, v135, v134, s70
v_accvgpr_write_b32 a3, v123
v_perm_b32 v123, v135, v134, s71
v_accvgpr_write_b32 a67, v123
v_perm_b32 v123, v137, v136, s70
v_accvgpr_write_b32 a128, v123
v_perm_b32 v123, v137, v136, s71
v_accvgpr_write_b32 a192, v123
v_perm_b32 v123, v139, v138, s70
v_accvgpr_write_b32 a129, v123
v_perm_b32 v123, v139, v138, s71
v_accvgpr_write_b32 a193, v123
v_perm_b32 v123, v141, v140, s70
v_accvgpr_write_b32 a130, v123
v_perm_b32 v123, v141, v140, s71
v_accvgpr_write_b32 a194, v123
v_perm_b32 v123, v143, v142, s70
v_accvgpr_write_b32 a131, v123
v_perm_b32 v123, v143, v142, s71
v_accvgpr_write_b32 a195, v123
s_mul_i32 s56, s60, 96
buffer_load_dword v128, v120, s[16:19], s56 offen offset:0
s_mul_i32 s56, s60, 97
buffer_load_dword v129, v120, s[16:19], s56 offen offset:0
s_mul_i32 s56, s60, 98
buffer_load_dword v130, v120, s[16:19], s56 offen offset:0
s_mul_i32 s56, s60, 99
buffer_load_dword v131, v120, s[16:19], s56 offen offset:0
s_mul_i32 s56, s60, 100
buffer_load_dword v132, v120, s[16:19], s56 offen offset:0
s_mul_i32 s56, s60, 101
buffer_load_dword v133, v120, s[16:19], s56 offen offset:0
s_mul_i32 s56, s60, 102
buffer_load_dword v134, v120, s[16:19], s56 offen offset:0
s_mul_i32 s56, s60, 103
buffer_load_dword v135, v120, s[16:19], s56 offen offset:0
s_mul_i32 s56, s60, 96
buffer_load_dword v136, v120, s[16:19], s56 offen offset:64
s_mul_i32 s56, s60, 97
buffer_load_dword v137, v120, s[16:19], s56 offen offset:64
s_mul_i32 s56, s60, 98
buffer_load_dword v138, v120, s[16:19], s56 offen offset:64
s_mul_i32 s56, s60, 99
buffer_load_dword v139, v120, s[16:19], s56 offen offset:64
s_mul_i32 s56, s60, 100
buffer_load_dword v140, v120, s[16:19], s56 offen offset:64
s_mul_i32 s56, s60, 101
buffer_load_dword v141, v120, s[16:19], s56 offen offset:64
s_mul_i32 s56, s60, 102
buffer_load_dword v142, v120, s[16:19], s56 offen offset:64
s_mul_i32 s56, s60, 103
buffer_load_dword v143, v120, s[16:19], s56 offen offset:64
s_waitcnt vmcnt(32)
v_perm_b32 v123, v145, v144, s70
v_accvgpr_write_b32 a4, v123
v_perm_b32 v123, v145, v144, s71
v_accvgpr_write_b32 a68, v123
v_perm_b32 v123, v147, v146, s70
v_accvgpr_write_b32 a5, v123
v_perm_b32 v123, v147, v146, s71
v_accvgpr_write_b32 a69, v123
v_perm_b32 v123, v149, v148, s70
v_accvgpr_write_b32 a6, v123
v_perm_b32 v123, v149, v148, s71
v_accvgpr_write_b32 a70, v123
v_perm_b32 v123, v151, v150, s70
v_accvgpr_write_b32 a7, v123
v_perm_b32 v123, v151, v150, s71
v_accvgpr_write_b32 a71, v123
v_perm_b32 v123, v153, v152, s70
v_accvgpr_write_b32 a132, v123
v_perm_b32 v123, v153, v152, s71
v_accvgpr_write_b32 a196, v123
v_perm_b32 v123, v155, v154, s70
v_accvgpr_write_b32 a133, v123
v_perm_b32 v123, v155, v154, s71
v_accvgpr_write_b32 a197, v123
v_perm_b32 v123, v157, v156, s70
v_accvgpr_write_b32 a134, v123
v_perm_b32 v123, v157, v156, s71
v_accvgpr_write_b32 a198, v123
v_perm_b32 v123, v159, v158, s70
v_accvgpr_write_b32 a135, v123
v_perm_b32 v123, v159, v158, s71
v_accvgpr_write_b32 a199, v123
s_mul_i32 s56, s60, 128
buffer_load_dword v144, v120, s[16:19], s56 offen offset:0
s_mul_i32 s56, s60, 129
buffer_load_dword v145, v120, s[16:19], s56 offen offset:0
s_mul_i32 s56, s60, 130
buffer_load_dword v146, v120, s[16:19], s56 offen offset:0
s_mul_i32 s56, s60, 131
buffer_load_dword v147, v120, s[16:19], s56 offen offset:0
s_mul_i32 s56, s60, 132
buffer_load_dword v148, v120, s[16:19], s56 offen offset:0
s_mul_i32 s56, s60, 133
buffer_load_dword v149, v120, s[16:19], s56 offen offset:0
s_mul_i32 s56, s60, 134
buffer_load_dword v150, v120, s[16:19], s56 offen offset:0
s_mul_i32 s56, s60, 135
buffer_load_dword v151, v120, s[16:19], s56 offen offset:0
s_mul_i32 s56, s60, 128
buffer_load_dword v152, v120, s[16:19], s56 offen offset:64
s_mul_i32 s56, s60, 129
buffer_load_dword v153, v120, s[16:19], s56 offen offset:64
s_mul_i32 s56, s60, 130
buffer_load_dword v154, v120, s[16:19], s56 offen offset:64
s_mul_i32 s56, s60, 131
buffer_load_dword v155, v120, s[16:19], s56 offen offset:64
s_mul_i32 s56, s60, 132
buffer_load_dword v156, v120, s[16:19], s56 offen offset:64
s_mul_i32 s56, s60, 133
buffer_load_dword v157, v120, s[16:19], s56 offen offset:64
s_mul_i32 s56, s60, 134
buffer_load_dword v158, v120, s[16:19], s56 offen offset:64
s_mul_i32 s56, s60, 135
buffer_load_dword v159, v120, s[16:19], s56 offen offset:64
s_waitcnt vmcnt(32)
v_perm_b32 v123, v161, v160, s70
v_accvgpr_write_b32 a8, v123
v_perm_b32 v123, v161, v160, s71
v_accvgpr_write_b32 a72, v123
v_perm_b32 v123, v163, v162, s70
v_accvgpr_write_b32 a9, v123
v_perm_b32 v123, v163, v162, s71
v_accvgpr_write_b32 a73, v123
v_perm_b32 v123, v165, v164, s70
v_accvgpr_write_b32 a10, v123
v_perm_b32 v123, v165, v164, s71
v_accvgpr_write_b32 a74, v123
v_perm_b32 v123, v167, v166, s70
v_accvgpr_write_b32 a11, v123
v_perm_b32 v123, v167, v166, s71
v_accvgpr_write_b32 a75, v123
v_perm_b32 v123, v169, v168, s70
v_accvgpr_write_b32 a136, v123
v_perm_b32 v123, v169, v168, s71
v_accvgpr_write_b32 a200, v123
v_perm_b32 v123, v171, v170, s70
v_accvgpr_write_b32 a137, v123
v_perm_b32 v123, v171, v170, s71
v_accvgpr_write_b32 a201, v123
v_perm_b32 v123, v173, v172, s70
v_accvgpr_write_b32 a138, v123
v_perm_b32 v123, v173, v172, s71
v_accvgpr_write_b32 a202, v123
v_perm_b32 v123, v175, v174, s70
v_accvgpr_write_b32 a139, v123
v_perm_b32 v123, v175, v174, s71
v_accvgpr_write_b32 a203, v123
s_mul_i32 s56, s60, 160
buffer_load_dword v160, v120, s[16:19], s56 offen offset:0
s_mul_i32 s56, s60, 161
buffer_load_dword v161, v120, s[16:19], s56 offen offset:0
s_mul_i32 s56, s60, 162
buffer_load_dword v162, v120, s[16:19], s56 offen offset:0
s_mul_i32 s56, s60, 163
buffer_load_dword v163, v120, s[16:19], s56 offen offset:0
s_mul_i32 s56, s60, 164
buffer_load_dword v164, v120, s[16:19], s56 offen offset:0
s_mul_i32 s56, s60, 165
buffer_load_dword v165, v120, s[16:19], s56 offen offset:0
s_mul_i32 s56, s60, 166
buffer_load_dword v166, v120, s[16:19], s56 offen offset:0
s_mul_i32 s56, s60, 167
buffer_load_dword v167, v120, s[16:19], s56 offen offset:0
s_mul_i32 s56, s60, 160
buffer_load_dword v168, v120, s[16:19], s56 offen offset:64
s_mul_i32 s56, s60, 161
buffer_load_dword v169, v120, s[16:19], s56 offen offset:64
s_mul_i32 s56, s60, 162
buffer_load_dword v170, v120, s[16:19], s56 offen offset:64
s_mul_i32 s56, s60, 163
buffer_load_dword v171, v120, s[16:19], s56 offen offset:64
s_mul_i32 s56, s60, 164
buffer_load_dword v172, v120, s[16:19], s56 offen offset:64
s_mul_i32 s56, s60, 165
buffer_load_dword v173, v120, s[16:19], s56 offen offset:64
s_mul_i32 s56, s60, 166
buffer_load_dword v174, v120, s[16:19], s56 offen offset:64
s_mul_i32 s56, s60, 167
buffer_load_dword v175, v120, s[16:19], s56 offen offset:64
s_waitcnt vmcnt(32)
v_perm_b32 v123, v129, v128, s70
v_accvgpr_write_b32 a12, v123
v_perm_b32 v123, v129, v128, s71
v_accvgpr_write_b32 a76, v123
v_perm_b32 v123, v131, v130, s70
v_accvgpr_write_b32 a13, v123
v_perm_b32 v123, v131, v130, s71
v_accvgpr_write_b32 a77, v123
v_perm_b32 v123, v133, v132, s70
v_accvgpr_write_b32 a14, v123
v_perm_b32 v123, v133, v132, s71
v_accvgpr_write_b32 a78, v123
v_perm_b32 v123, v135, v134, s70
v_accvgpr_write_b32 a15, v123
v_perm_b32 v123, v135, v134, s71
v_accvgpr_write_b32 a79, v123
v_perm_b32 v123, v137, v136, s70
v_accvgpr_write_b32 a140, v123
v_perm_b32 v123, v137, v136, s71
v_accvgpr_write_b32 a204, v123
v_perm_b32 v123, v139, v138, s70
v_accvgpr_write_b32 a141, v123
v_perm_b32 v123, v139, v138, s71
v_accvgpr_write_b32 a205, v123
v_perm_b32 v123, v141, v140, s70
v_accvgpr_write_b32 a142, v123
v_perm_b32 v123, v141, v140, s71
v_accvgpr_write_b32 a206, v123
v_perm_b32 v123, v143, v142, s70
v_accvgpr_write_b32 a143, v123
v_perm_b32 v123, v143, v142, s71
v_accvgpr_write_b32 a207, v123
s_mul_i32 s56, s60, 192
buffer_load_dword v128, v120, s[16:19], s56 offen offset:0
s_mul_i32 s56, s60, 193
buffer_load_dword v129, v120, s[16:19], s56 offen offset:0
s_mul_i32 s56, s60, 194
buffer_load_dword v130, v120, s[16:19], s56 offen offset:0
s_mul_i32 s56, s60, 195
buffer_load_dword v131, v120, s[16:19], s56 offen offset:0
s_mul_i32 s56, s60, 196
buffer_load_dword v132, v120, s[16:19], s56 offen offset:0
s_mul_i32 s56, s60, 197
buffer_load_dword v133, v120, s[16:19], s56 offen offset:0
s_mul_i32 s56, s60, 198
buffer_load_dword v134, v120, s[16:19], s56 offen offset:0
s_mul_i32 s56, s60, 199
buffer_load_dword v135, v120, s[16:19], s56 offen offset:0
s_mul_i32 s56, s60, 192
buffer_load_dword v136, v120, s[16:19], s56 offen offset:64
s_mul_i32 s56, s60, 193
buffer_load_dword v137, v120, s[16:19], s56 offen offset:64
s_mul_i32 s56, s60, 194
buffer_load_dword v138, v120, s[16:19], s56 offen offset:64
s_mul_i32 s56, s60, 195
buffer_load_dword v139, v120, s[16:19], s56 offen offset:64
s_mul_i32 s56, s60, 196
buffer_load_dword v140, v120, s[16:19], s56 offen offset:64
s_mul_i32 s56, s60, 197
buffer_load_dword v141, v120, s[16:19], s56 offen offset:64
s_mul_i32 s56, s60, 198
buffer_load_dword v142, v120, s[16:19], s56 offen offset:64
s_mul_i32 s56, s60, 199
buffer_load_dword v143, v120, s[16:19], s56 offen offset:64
s_waitcnt vmcnt(32)
v_perm_b32 v123, v145, v144, s70
v_accvgpr_write_b32 a16, v123
v_perm_b32 v123, v145, v144, s71
v_accvgpr_write_b32 a80, v123
v_perm_b32 v123, v147, v146, s70
v_accvgpr_write_b32 a17, v123
v_perm_b32 v123, v147, v146, s71
v_accvgpr_write_b32 a81, v123
v_perm_b32 v123, v149, v148, s70
v_accvgpr_write_b32 a18, v123
v_perm_b32 v123, v149, v148, s71
v_accvgpr_write_b32 a82, v123
v_perm_b32 v123, v151, v150, s70
v_accvgpr_write_b32 a19, v123
v_perm_b32 v123, v151, v150, s71
v_accvgpr_write_b32 a83, v123
v_perm_b32 v123, v153, v152, s70
v_accvgpr_write_b32 a144, v123
v_perm_b32 v123, v153, v152, s71
v_accvgpr_write_b32 a208, v123
v_perm_b32 v123, v155, v154, s70
v_accvgpr_write_b32 a145, v123
v_perm_b32 v123, v155, v154, s71
v_accvgpr_write_b32 a209, v123
v_perm_b32 v123, v157, v156, s70
v_accvgpr_write_b32 a146, v123
v_perm_b32 v123, v157, v156, s71
v_accvgpr_write_b32 a210, v123
v_perm_b32 v123, v159, v158, s70
v_accvgpr_write_b32 a147, v123
v_perm_b32 v123, v159, v158, s71
v_accvgpr_write_b32 a211, v123
s_mul_i32 s56, s60, 224
buffer_load_dword v144, v120, s[16:19], s56 offen offset:0
s_mul_i32 s56, s60, 225
buffer_load_dword v145, v120, s[16:19], s56 offen offset:0
s_mul_i32 s56, s60, 226
buffer_load_dword v146, v120, s[16:19], s56 offen offset:0
s_mul_i32 s56, s60, 227
buffer_load_dword v147, v120, s[16:19], s56 offen offset:0
s_mul_i32 s56, s60, 228
buffer_load_dword v148, v120, s[16:19], s56 offen offset:0
s_mul_i32 s56, s60, 229
buffer_load_dword v149, v120, s[16:19], s56 offen offset:0
s_mul_i32 s56, s60, 230
buffer_load_dword v150, v120, s[16:19], s56 offen offset:0
s_mul_i32 s56, s60, 231
buffer_load_dword v151, v120, s[16:19], s56 offen offset:0
s_mul_i32 s56, s60, 224
buffer_load_dword v152, v120, s[16:19], s56 offen offset:64
s_mul_i32 s56, s60, 225
buffer_load_dword v153, v120, s[16:19], s56 offen offset:64
s_mul_i32 s56, s60, 226
buffer_load_dword v154, v120, s[16:19], s56 offen offset:64
s_mul_i32 s56, s60, 227
buffer_load_dword v155, v120, s[16:19], s56 offen offset:64
s_mul_i32 s56, s60, 228
buffer_load_dword v156, v120, s[16:19], s56 offen offset:64
s_mul_i32 s56, s60, 229
buffer_load_dword v157, v120, s[16:19], s56 offen offset:64
s_mul_i32 s56, s60, 230
buffer_load_dword v158, v120, s[16:19], s56 offen offset:64
s_mul_i32 s56, s60, 231
buffer_load_dword v159, v120, s[16:19], s56 offen offset:64
s_waitcnt vmcnt(32)
v_perm_b32 v123, v161, v160, s70
v_accvgpr_write_b32 a20, v123
v_perm_b32 v123, v161, v160, s71
v_accvgpr_write_b32 a84, v123
v_perm_b32 v123, v163, v162, s70
v_accvgpr_write_b32 a21, v123
v_perm_b32 v123, v163, v162, s71
v_accvgpr_write_b32 a85, v123
v_perm_b32 v123, v165, v164, s70
v_accvgpr_write_b32 a22, v123
v_perm_b32 v123, v165, v164, s71
v_accvgpr_write_b32 a86, v123
v_perm_b32 v123, v167, v166, s70
v_accvgpr_write_b32 a23, v123
v_perm_b32 v123, v167, v166, s71
v_accvgpr_write_b32 a87, v123
v_perm_b32 v123, v169, v168, s70
v_accvgpr_write_b32 a148, v123
v_perm_b32 v123, v169, v168, s71
v_accvgpr_write_b32 a212, v123
v_perm_b32 v123, v171, v170, s70
v_accvgpr_write_b32 a149, v123
v_perm_b32 v123, v171, v170, s71
v_accvgpr_write_b32 a213, v123
v_perm_b32 v123, v173, v172, s70
v_accvgpr_write_b32 a150, v123
v_perm_b32 v123, v173, v172, s71
v_accvgpr_write_b32 a214, v123
v_perm_b32 v123, v175, v174, s70
v_accvgpr_write_b32 a151, v123
v_perm_b32 v123, v175, v174, s71
v_accvgpr_write_b32 a215, v123
s_mul_i32 s56, s60, 256
buffer_load_dword v160, v120, s[16:19], s56 offen offset:0
s_mul_i32 s56, s60, 257
buffer_load_dword v161, v120, s[16:19], s56 offen offset:0
s_mul_i32 s56, s60, 258
buffer_load_dword v162, v120, s[16:19], s56 offen offset:0
s_mul_i32 s56, s60, 259
buffer_load_dword v163, v120, s[16:19], s56 offen offset:0
s_mul_i32 s56, s60, 260
buffer_load_dword v164, v120, s[16:19], s56 offen offset:0
s_mul_i32 s56, s60, 261
buffer_load_dword v165, v120, s[16:19], s56 offen offset:0
s_mul_i32 s56, s60, 262
buffer_load_dword v166, v120, s[16:19], s56 offen offset:0
s_mul_i32 s56, s60, 263
buffer_load_dword v167, v120, s[16:19], s56 offen offset:0
s_mul_i32 s56, s60, 256
buffer_load_dword v168, v120, s[16:19], s56 offen offset:64
s_mul_i32 s56, s60, 257
buffer_load_dword v169, v120, s[16:19], s56 offen offset:64
s_mul_i32 s56, s60, 258
buffer_load_dword v170, v120, s[16:19], s56 offen offset:64
s_mul_i32 s56, s60, 259
buffer_load_dword v171, v120, s[16:19], s56 offen offset:64
s_mul_i32 s56, s60, 260
buffer_load_dword v172, v120, s[16:19], s56 offen offset:64
s_mul_i32 s56, s60, 261
buffer_load_dword v173, v120, s[16:19], s56 offen offset:64
s_mul_i32 s56, s60, 262
buffer_load_dword v174, v120, s[16:19], s56 offen offset:64
s_mul_i32 s56, s60, 263
buffer_load_dword v175, v120, s[16:19], s56 offen offset:64
v_mov_b32 v121, 64
global_load_dword v122, v121, s[36:37] sc1
s_waitcnt vmcnt(33)
v_perm_b32 v123, v129, v128, s70
v_accvgpr_write_b32 a24, v123
v_perm_b32 v123, v129, v128, s71
v_accvgpr_write_b32 a88, v123
v_perm_b32 v123, v131, v130, s70
v_accvgpr_write_b32 a25, v123
v_perm_b32 v123, v131, v130, s71
v_accvgpr_write_b32 a89, v123
v_perm_b32 v123, v133, v132, s70
v_accvgpr_write_b32 a26, v123
v_perm_b32 v123, v133, v132, s71
v_accvgpr_write_b32 a90, v123
v_perm_b32 v123, v135, v134, s70
v_accvgpr_write_b32 a27, v123
v_perm_b32 v123, v135, v134, s71
v_accvgpr_write_b32 a91, v123
v_perm_b32 v123, v137, v136, s70
v_accvgpr_write_b32 a152, v123
v_perm_b32 v123, v137, v136, s71
v_accvgpr_write_b32 a216, v123
v_perm_b32 v123, v139, v138, s70
v_accvgpr_write_b32 a153, v123
v_perm_b32 v123, v139, v138, s71
v_accvgpr_write_b32 a217, v123
v_perm_b32 v123, v141, v140, s70
v_accvgpr_write_b32 a154, v123
v_perm_b32 v123, v141, v140, s71
v_accvgpr_write_b32 a218, v123
v_perm_b32 v123, v143, v142, s70
v_accvgpr_write_b32 a155, v123
v_perm_b32 v123, v143, v142, s71
v_accvgpr_write_b32 a219, v123
s_mul_i32 s56, s60, 288
buffer_load_dword v128, v120, s[16:19], s56 offen offset:0
s_mul_i32 s56, s60, 289
buffer_load_dword v129, v120, s[16:19], s56 offen offset:0
s_mul_i32 s56, s60, 290
buffer_load_dword v130, v120, s[16:19], s56 offen offset:0
s_mul_i32 s56, s60, 291
buffer_load_dword v131, v120, s[16:19], s56 offen offset:0
s_mul_i32 s56, s60, 292
buffer_load_dword v132, v120, s[16:19], s56 offen offset:0
s_mul_i32 s56, s60, 293
buffer_load_dword v133, v120, s[16:19], s56 offen offset:0
s_mul_i32 s56, s60, 294
buffer_load_dword v134, v120, s[16:19], s56 offen offset:0
s_mul_i32 s56, s60, 295
buffer_load_dword v135, v120, s[16:19], s56 offen offset:0
s_mul_i32 s56, s60, 288
buffer_load_dword v136, v120, s[16:19], s56 offen offset:64
s_mul_i32 s56, s60, 289
buffer_load_dword v137, v120, s[16:19], s56 offen offset:64
s_mul_i32 s56, s60, 290
buffer_load_dword v138, v120, s[16:19], s56 offen offset:64
s_mul_i32 s56, s60, 291
buffer_load_dword v139, v120, s[16:19], s56 offen offset:64
s_mul_i32 s56, s60, 292
buffer_load_dword v140, v120, s[16:19], s56 offen offset:64
s_mul_i32 s56, s60, 293
buffer_load_dword v141, v120, s[16:19], s56 offen offset:64
s_mul_i32 s56, s60, 294
buffer_load_dword v142, v120, s[16:19], s56 offen offset:64
s_mul_i32 s56, s60, 295
buffer_load_dword v143, v120, s[16:19], s56 offen offset:64
s_waitcnt vmcnt(33)
v_perm_b32 v123, v145, v144, s70
v_accvgpr_write_b32 a28, v123
v_perm_b32 v123, v145, v144, s71
v_accvgpr_write_b32 a92, v123
v_perm_b32 v123, v147, v146, s70
v_accvgpr_write_b32 a29, v123
v_perm_b32 v123, v147, v146, s71
v_accvgpr_write_b32 a93, v123
v_perm_b32 v123, v149, v148, s70
v_accvgpr_write_b32 a30, v123
v_perm_b32 v123, v149, v148, s71
v_accvgpr_write_b32 a94, v123
v_perm_b32 v123, v151, v150, s70
v_accvgpr_write_b32 a31, v123
v_perm_b32 v123, v151, v150, s71
v_accvgpr_write_b32 a95, v123
v_perm_b32 v123, v153, v152, s70
v_accvgpr_write_b32 a156, v123
v_perm_b32 v123, v153, v152, s71
v_accvgpr_write_b32 a220, v123
v_perm_b32 v123, v155, v154, s70
v_accvgpr_write_b32 a157, v123
v_perm_b32 v123, v155, v154, s71
v_accvgpr_write_b32 a221, v123
v_perm_b32 v123, v157, v156, s70
v_accvgpr_write_b32 a158, v123
v_perm_b32 v123, v157, v156, s71
v_accvgpr_write_b32 a222, v123
v_perm_b32 v123, v159, v158, s70
v_accvgpr_write_b32 a159, v123
v_perm_b32 v123, v159, v158, s71
v_accvgpr_write_b32 a223, v123
s_mul_i32 s56, s60, 320
buffer_load_dword v144, v120, s[16:19], s56 offen offset:0
s_mul_i32 s56, s60, 321
buffer_load_dword v145, v120, s[16:19], s56 offen offset:0
s_mul_i32 s56, s60, 322
buffer_load_dword v146, v120, s[16:19], s56 offen offset:0
s_mul_i32 s56, s60, 323
buffer_load_dword v147, v120, s[16:19], s56 offen offset:0
s_mul_i32 s56, s60, 324
buffer_load_dword v148, v120, s[16:19], s56 offen offset:0
s_mul_i32 s56, s60, 325
buffer_load_dword v149, v120, s[16:19], s56 offen offset:0
s_mul_i32 s56, s60, 326
buffer_load_dword v150, v120, s[16:19], s56 offen offset:0
s_mul_i32 s56, s60, 327
buffer_load_dword v151, v120, s[16:19], s56 offen offset:0
s_mul_i32 s56, s60, 320
buffer_load_dword v152, v120, s[16:19], s56 offen offset:64
s_mul_i32 s56, s60, 321
buffer_load_dword v153, v120, s[16:19], s56 offen offset:64
s_mul_i32 s56, s60, 322
buffer_load_dword v154, v120, s[16:19], s56 offen offset:64
s_mul_i32 s56, s60, 323
buffer_load_dword v155, v120, s[16:19], s56 offen offset:64
s_mul_i32 s56, s60, 324
buffer_load_dword v156, v120, s[16:19], s56 offen offset:64
s_mul_i32 s56, s60, 325
buffer_load_dword v157, v120, s[16:19], s56 offen offset:64
s_mul_i32 s56, s60, 326
buffer_load_dword v158, v120, s[16:19], s56 offen offset:64
s_mul_i32 s56, s60, 327
buffer_load_dword v159, v120, s[16:19], s56 offen offset:64
s_waitcnt vmcnt(33)
v_perm_b32 v123, v161, v160, s70
v_accvgpr_write_b32 a32, v123
v_perm_b32 v123, v161, v160, s71
v_accvgpr_write_b32 a96, v123
v_perm_b32 v123, v163, v162, s70
v_accvgpr_write_b32 a33, v123
v_perm_b32 v123, v163, v162, s71
v_accvgpr_write_b32 a97, v123
v_perm_b32 v123, v165, v164, s70
v_accvgpr_write_b32 a34, v123
v_perm_b32 v123, v165, v164, s71
v_accvgpr_write_b32 a98, v123
v_perm_b32 v123, v167, v166, s70
v_accvgpr_write_b32 a35, v123
v_perm_b32 v123, v167, v166, s71
v_accvgpr_write_b32 a99, v123
v_perm_b32 v123, v169, v168, s70
v_accvgpr_write_b32 a160, v123
v_perm_b32 v123, v169, v168, s71
v_accvgpr_write_b32 a224, v123
v_perm_b32 v123, v171, v170, s70
v_accvgpr_write_b32 a161, v123
v_perm_b32 v123, v171, v170, s71
v_accvgpr_write_b32 a225, v123
v_perm_b32 v123, v173, v172, s70
v_accvgpr_write_b32 a162, v123
v_perm_b32 v123, v173, v172, s71
v_accvgpr_write_b32 a226, v123
v_perm_b32 v123, v175, v174, s70
v_accvgpr_write_b32 a163, v123
v_perm_b32 v123, v175, v174, s71
v_accvgpr_write_b32 a227, v123
s_mul_i32 s56, s60, 352
buffer_load_dword v160, v120, s[16:19], s56 offen offset:0
s_mul_i32 s56, s60, 353
buffer_load_dword v161, v120, s[16:19], s56 offen offset:0
s_mul_i32 s56, s60, 354
buffer_load_dword v162, v120, s[16:19], s56 offen offset:0
s_mul_i32 s56, s60, 355
buffer_load_dword v163, v120, s[16:19], s56 offen offset:0
s_mul_i32 s56, s60, 356
buffer_load_dword v164, v120, s[16:19], s56 offen offset:0
s_mul_i32 s56, s60, 357
buffer_load_dword v165, v120, s[16:19], s56 offen offset:0
s_mul_i32 s56, s60, 358
buffer_load_dword v166, v120, s[16:19], s56 offen offset:0
s_mul_i32 s56, s60, 359
buffer_load_dword v167, v120, s[16:19], s56 offen offset:0
s_mul_i32 s56, s60, 352
buffer_load_dword v168, v120, s[16:19], s56 offen offset:64
s_mul_i32 s56, s60, 353
buffer_load_dword v169, v120, s[16:19], s56 offen offset:64
s_mul_i32 s56, s60, 354
buffer_load_dword v170, v120, s[16:19], s56 offen offset:64
s_mul_i32 s56, s60, 355
buffer_load_dword v171, v120, s[16:19], s56 offen offset:64
s_mul_i32 s56, s60, 356
buffer_load_dword v172, v120, s[16:19], s56 offen offset:64
s_mul_i32 s56, s60, 357
buffer_load_dword v173, v120, s[16:19], s56 offen offset:64
s_mul_i32 s56, s60, 358
buffer_load_dword v174, v120, s[16:19], s56 offen offset:64
s_mul_i32 s56, s60, 359
buffer_load_dword v175, v120, s[16:19], s56 offen offset:64
s_waitcnt vmcnt(48)
v_cmp_gt_u32 vcc, 12, v122
s_cbranch_vccz L_w_clr
s_mov_b32 s57, 0
v_mov_b32 v121, 64
L_wd_37:
global_load_dword v122, v121, s[36:37] sc1
s_add_u32 s57, s57, 1
s_cmp_ge_u32 s57, 524288
s_cbranch_scc1 L_end
s_waitcnt vmcnt(0)
v_cmp_gt_u32 vcc, 12, v122
s_cbranch_vccnz L_wd_37
L_w_clr:
s_waitcnt vmcnt(32)
v_perm_b32 v123, v129, v128, s70
v_accvgpr_write_b32 a36, v123
v_perm_b32 v123, v129, v128, s71
v_accvgpr_write_b32 a100, v123
v_perm_b32 v123, v131, v130, s70
v_accvgpr_write_b32 a37, v123
v_perm_b32 v123, v131, v130, s71
v_accvgpr_write_b32 a101, v123
v_perm_b32 v123, v133, v132, s70
v_accvgpr_write_b32 a38, v123
v_perm_b32 v123, v133, v132, s71
v_accvgpr_write_b32 a102, v123
v_perm_b32 v123, v135, v134, s70
v_accvgpr_write_b32 a39, v123
v_perm_b32 v123, v135, v134, s71
v_accvgpr_write_b32 a103, v123
v_perm_b32 v123, v137, v136, s70
v_accvgpr_write_b32 a164, v123
v_perm_b32 v123, v137, v136, s71
v_accvgpr_write_b32 a228, v123
v_perm_b32 v123, v139, v138, s70
v_accvgpr_write_b32 a165, v123
v_perm_b32 v123, v139, v138, s71
v_accvgpr_write_b32 a229, v123
v_perm_b32 v123, v141, v140, s70
v_accvgpr_write_b32 a166, v123
v_perm_b32 v123, v141, v140, s71
v_accvgpr_write_b32 a230, v123
v_perm_b32 v123, v143, v142, s70
v_accvgpr_write_b32 a167, v123
v_perm_b32 v123, v143, v142, s71
v_accvgpr_write_b32 a231, v123
s_mul_i32 s56, s60, 384
buffer_load_dword v128, v120, s[16:19], s56 offen offset:0
s_mul_i32 s56, s60, 385
buffer_load_dword v129, v120, s[16:19], s56 offen offset:0
s_mul_i32 s56, s60, 386
buffer_load_dword v130, v120, s[16:19], s56 offen offset:0
s_mul_i32 s56, s60, 387
buffer_load_dword v131, v120, s[16:19], s56 offen offset:0
s_mul_i32 s56, s60, 388
buffer_load_dword v132, v120, s[16:19], s56 offen offset:0
s_mul_i32 s56, s60, 389
buffer_load_dword v133, v120, s[16:19], s56 offen offset:0
s_mul_i32 s56, s60, 390
buffer_load_dword v134, v120, s[16:19], s56 offen offset:0
s_mul_i32 s56, s60, 391
buffer_load_dword v135, v120, s[16:19], s56 offen offset:0
s_mul_i32 s56, s60, 384
buffer_load_dword v136, v120, s[16:19], s56 offen offset:64
s_mul_i32 s56, s60, 385
buffer_load_dword v137, v120, s[16:19], s56 offen offset:64
s_mul_i32 s56, s60, 386
buffer_load_dword v138, v120, s[16:19], s56 offen offset:64
s_mul_i32 s56, s60, 387
buffer_load_dword v139, v120, s[16:19], s56 offen offset:64
s_mul_i32 s56, s60, 388
buffer_load_dword v140, v120, s[16:19], s56 offen offset:64
s_mul_i32 s56, s60, 389
buffer_load_dword v141, v120, s[16:19], s56 offen offset:64
s_mul_i32 s56, s60, 390
buffer_load_dword v142, v120, s[16:19], s56 offen offset:64
s_mul_i32 s56, s60, 391
buffer_load_dword v143, v120, s[16:19], s56 offen offset:64
s_waitcnt vmcnt(32)
v_perm_b32 v123, v145, v144, s70
v_accvgpr_write_b32 a40, v123
v_perm_b32 v123, v145, v144, s71
v_accvgpr_write_b32 a104, v123
v_perm_b32 v123, v147, v146, s70
v_accvgpr_write_b32 a41, v123
v_perm_b32 v123, v147, v146, s71
v_accvgpr_write_b32 a105, v123
v_perm_b32 v123, v149, v148, s70
v_accvgpr_write_b32 a42, v123
v_perm_b32 v123, v149, v148, s71
v_accvgpr_write_b32 a106, v123
v_perm_b32 v123, v151, v150, s70
v_accvgpr_write_b32 a43, v123
v_perm_b32 v123, v151, v150, s71
v_accvgpr_write_b32 a107, v123
v_perm_b32 v123, v153, v152, s70
v_accvgpr_write_b32 a168, v123
v_perm_b32 v123, v153, v152, s71
v_accvgpr_write_b32 a232, v123
v_perm_b32 v123, v155, v154, s70
v_accvgpr_write_b32 a169, v123
v_perm_b32 v123, v155, v154, s71
v_accvgpr_write_b32 a233, v123
v_perm_b32 v123, v157, v156, s70
v_accvgpr_write_b32 a170, v123
v_perm_b32 v123, v157, v156, s71
v_accvgpr_write_b32 a234, v123
v_perm_b32 v123, v159, v158, s70
v_accvgpr_write_b32 a171, v123
v_perm_b32 v123, v159, v158, s71
v_accvgpr_write_b32 a235, v123
s_mul_i32 s56, s60, 416
buffer_load_dword v144, v120, s[16:19], s56 offen offset:0
s_mul_i32 s56, s60, 417
buffer_load_dword v145, v120, s[16:19], s56 offen offset:0
s_mul_i32 s56, s60, 418
buffer_load_dword v146, v120, s[16:19], s56 offen offset:0
s_mul_i32 s56, s60, 419
buffer_load_dword v147, v120, s[16:19], s56 offen offset:0
s_mul_i32 s56, s60, 420
buffer_load_dword v148, v120, s[16:19], s56 offen offset:0
s_mul_i32 s56, s60, 421
buffer_load_dword v149, v120, s[16:19], s56 offen offset:0
s_mul_i32 s56, s60, 422
buffer_load_dword v150, v120, s[16:19], s56 offen offset:0
s_mul_i32 s56, s60, 423
buffer_load_dword v151, v120, s[16:19], s56 offen offset:0
s_mul_i32 s56, s60, 416
buffer_load_dword v152, v120, s[16:19], s56 offen offset:64
s_mul_i32 s56, s60, 417
buffer_load_dword v153, v120, s[16:19], s56 offen offset:64
s_mul_i32 s56, s60, 418
buffer_load_dword v154, v120, s[16:19], s56 offen offset:64
s_mul_i32 s56, s60, 419
buffer_load_dword v155, v120, s[16:19], s56 offen offset:64
s_mul_i32 s56, s60, 420
buffer_load_dword v156, v120, s[16:19], s56 offen offset:64
s_mul_i32 s56, s60, 421
buffer_load_dword v157, v120, s[16:19], s56 offen offset:64
s_mul_i32 s56, s60, 422
buffer_load_dword v158, v120, s[16:19], s56 offen offset:64
s_mul_i32 s56, s60, 423
buffer_load_dword v159, v120, s[16:19], s56 offen offset:64
buffer_load_dword v8, v6, s[4:7], s68 offen sc1
s_waitcnt vmcnt(33)
v_perm_b32 v123, v161, v160, s70
v_accvgpr_write_b32 a44, v123
v_perm_b32 v123, v161, v160, s71
v_accvgpr_write_b32 a108, v123
v_perm_b32 v123, v163, v162, s70
v_accvgpr_write_b32 a45, v123
v_perm_b32 v123, v163, v162, s71
v_accvgpr_write_b32 a109, v123
v_perm_b32 v123, v165, v164, s70
v_accvgpr_write_b32 a46, v123
v_perm_b32 v123, v165, v164, s71
v_accvgpr_write_b32 a110, v123
v_perm_b32 v123, v167, v166, s70
v_accvgpr_write_b32 a47, v123
v_perm_b32 v123, v167, v166, s71
v_accvgpr_write_b32 a111, v123
v_perm_b32 v123, v169, v168, s70
v_accvgpr_write_b32 a172, v123
v_perm_b32 v123, v169, v168, s71
v_accvgpr_write_b32 a236, v123
v_perm_b32 v123, v171, v170, s70
v_accvgpr_write_b32 a173, v123
v_perm_b32 v123, v171, v170, s71
v_accvgpr_write_b32 a237, v123
v_perm_b32 v123, v173, v172, s70
v_accvgpr_write_b32 a174, v123
v_perm_b32 v123, v173, v172, s71
v_accvgpr_write_b32 a238, v123
v_perm_b32 v123, v175, v174, s70
v_accvgpr_write_b32 a175, v123
v_perm_b32 v123, v175, v174, s71
v_accvgpr_write_b32 a239, v123
s_mul_i32 s56, s60, 448
buffer_load_dword v160, v120, s[16:19], s56 offen offset:0
s_mul_i32 s56, s60, 449
buffer_load_dword v161, v120, s[16:19], s56 offen offset:0
s_mul_i32 s56, s60, 450
buffer_load_dword v162, v120, s[16:19], s56 offen offset:0
s_mul_i32 s56, s60, 451
buffer_load_dword v163, v120, s[16:19], s56 offen offset:0
s_mul_i32 s56, s60, 452
buffer_load_dword v164, v120, s[16:19], s56 offen offset:0
s_mul_i32 s56, s60, 453
buffer_load_dword v165, v120, s[16:19], s56 offen offset:0
s_mul_i32 s56, s60, 454
buffer_load_dword v166, v120, s[16:19], s56 offen offset:0
s_mul_i32 s56, s60, 455
buffer_load_dword v167, v120, s[16:19], s56 offen offset:0
s_mul_i32 s56, s60, 448
buffer_load_dword v168, v120, s[16:19], s56 offen offset:64
s_mul_i32 s56, s60, 449
buffer_load_dword v169, v120, s[16:19], s56 offen offset:64
s_mul_i32 s56, s60, 450
buffer_load_dword v170, v120, s[16:19], s56 offen offset:64
s_mul_i32 s56, s60, 451
buffer_load_dword v171, v120, s[16:19], s56 offen offset:64
s_mul_i32 s56, s60, 452
buffer_load_dword v172, v120, s[16:19], s56 offen offset:64
s_mul_i32 s56, s60, 453
buffer_load_dword v173, v120, s[16:19], s56 offen offset:64
s_mul_i32 s56, s60, 454
buffer_load_dword v174, v120, s[16:19], s56 offen offset:64
s_mul_i32 s56, s60, 455
buffer_load_dword v175, v120, s[16:19], s56 offen offset:64
s_waitcnt vmcnt(33)
v_perm_b32 v123, v129, v128, s70
v_accvgpr_write_b32 a48, v123
v_perm_b32 v123, v129, v128, s71
v_accvgpr_write_b32 a112, v123
v_perm_b32 v123, v131, v130, s70
v_accvgpr_write_b32 a49, v123
v_perm_b32 v123, v131, v130, s71
v_accvgpr_write_b32 a113, v123
v_perm_b32 v123, v133, v132, s70
v_accvgpr_write_b32 a50, v123
v_perm_b32 v123, v133, v132, s71
v_accvgpr_write_b32 a114, v123
v_perm_b32 v123, v135, v134, s70
v_accvgpr_write_b32 a51, v123
v_perm_b32 v123, v135, v134, s71
v_accvgpr_write_b32 a115, v123
v_perm_b32 v123, v137, v136, s70
v_accvgpr_write_b32 a176, v123
v_perm_b32 v123, v137, v136, s71
v_accvgpr_write_b32 a240, v123
v_perm_b32 v123, v139, v138, s70
v_accvgpr_write_b32 a177, v123
v_perm_b32 v123, v139, v138, s71
v_accvgpr_write_b32 a241, v123
v_perm_b32 v123, v141, v140, s70
v_accvgpr_write_b32 a178, v123
v_perm_b32 v123, v141, v140, s71
v_accvgpr_write_b32 a242, v123
v_perm_b32 v123, v143, v142, s70
v_accvgpr_write_b32 a179, v123
v_perm_b32 v123, v143, v142, s71
v_accvgpr_write_b32 a243, v123
s_mul_i32 s56, s60, 480
buffer_load_dword v128, v120, s[16:19], s56 offen offset:0
s_mul_i32 s56, s60, 481
buffer_load_dword v129, v120, s[16:19], s56 offen offset:0
s_mul_i32 s56, s60, 482
buffer_load_dword v130, v120, s[16:19], s56 offen offset:0
s_mul_i32 s56, s60, 483
buffer_load_dword v131, v120, s[16:19], s56 offen offset:0
s_mul_i32 s56, s60, 484
buffer_load_dword v132, v120, s[16:19], s56 offen offset:0
s_mul_i32 s56, s60, 485
buffer_load_dword v133, v120, s[16:19], s56 offen offset:0
s_mul_i32 s56, s60, 486
buffer_load_dword v134, v120, s[16:19], s56 offen offset:0
s_mul_i32 s56, s60, 487
buffer_load_dword v135, v120, s[16:19], s56 offen offset:0
s_mul_i32 s56, s60, 480
buffer_load_dword v136, v120, s[16:19], s56 offen offset:64
s_mul_i32 s56, s60, 481
buffer_load_dword v137, v120, s[16:19], s56 offen offset:64
s_mul_i32 s56, s60, 482
buffer_load_dword v138, v120, s[16:19], s56 offen offset:64
s_mul_i32 s56, s60, 483
buffer_load_dword v139, v120, s[16:19], s56 offen offset:64
s_mul_i32 s56, s60, 484
buffer_load_dword v140, v120, s[16:19], s56 offen offset:64
s_mul_i32 s56, s60, 485
buffer_load_dword v141, v120, s[16:19], s56 offen offset:64
s_mul_i32 s56, s60, 486
buffer_load_dword v142, v120, s[16:19], s56 offen offset:64
s_mul_i32 s56, s60, 487
buffer_load_dword v143, v120, s[16:19], s56 offen offset:64
s_waitcnt vmcnt(32)
v_cmp_ge_u32 vcc, 0, v8
s_cbranch_vccz L_w_xn
s_mov_b32 s57, 0
L_wf_38:
buffer_load_dword v8, v6, s[4:7], s68 offen offset:0 sc1
s_add_u32 s57, s57, 1
s_cmp_ge_u32 s57, 524288
s_cbranch_scc1 L_end
s_waitcnt vmcnt(0)
v_cmp_ge_u32 vcc, 0, v8
s_cbranch_vccnz L_wf_38
L_w_xn:
buffer_load_dwordx4 v[32:35], v11, s[4:7], s67 offen offset:0 sc1
buffer_load_dwordx4 v[36:39], v11, s[4:7], s67 offen offset:1024 sc1
buffer_load_dwordx4 v[40:43], v11, s[4:7], s67 offen offset:2048 sc1
buffer_load_dwordx4 v[44:47], v11, s[4:7], s67 offen offset:3072 sc1
buffer_load_dwordx4 v[48:51], v11, s[4:7], s77 offen offset:0 sc1
buffer_load_dwordx4 v[52:55], v11, s[4:7], s77 offen offset:1024 sc1
buffer_load_dwordx4 v[56:59], v11, s[4:7], s77 offen offset:2048 sc1
buffer_load_dwordx4 v[60:63], v11, s[4:7], s77 offen offset:3072 sc1
s_add_u32 s67, s67, s41
s_add_u32 s77, s67, 0x1000
v_perm_b32 v123, v145, v144, s70
v_accvgpr_write_b32 a52, v123
v_perm_b32 v123, v145, v144, s71
v_accvgpr_write_b32 a116, v123
v_perm_b32 v123, v147, v146, s70
v_accvgpr_write_b32 a53, v123
v_perm_b32 v123, v147, v146, s71
v_accvgpr_write_b32 a117, v123
v_perm_b32 v123, v149, v148, s70
v_accvgpr_write_b32 a54, v123
v_perm_b32 v123, v149, v148, s71
v_accvgpr_write_b32 a118, v123
v_perm_b32 v123, v151, v150, s70
v_accvgpr_write_b32 a55, v123
v_perm_b32 v123, v151, v150, s71
v_accvgpr_write_b32 a119, v123
v_perm_b32 v123, v153, v152, s70
v_accvgpr_write_b32 a180, v123
v_perm_b32 v123, v153, v152, s71
v_accvgpr_write_b32 a244, v123
v_perm_b32 v123, v155, v154, s70
v_accvgpr_write_b32 a181, v123
v_perm_b32 v123, v155, v154, s71
v_accvgpr_write_b32 a245, v123
v_perm_b32 v123, v157, v156, s70
v_accvgpr_write_b32 a182, v123
v_perm_b32 v123, v157, v156, s71
v_accvgpr_write_b32 a246, v123
v_perm_b32 v123, v159, v158, s70
v_accvgpr_write_b32 a183, v123
v_perm_b32 v123, v159, v158, s71
v_accvgpr_write_b32 a247, v123
s_waitcnt vmcnt(24)
v_perm_b32 v123, v161, v160, s70
v_accvgpr_write_b32 a56, v123
v_perm_b32 v123, v161, v160, s71
v_accvgpr_write_b32 a120, v123
v_perm_b32 v123, v163, v162, s70
v_accvgpr_write_b32 a57, v123
v_perm_b32 v123, v163, v162, s71
v_accvgpr_write_b32 a121, v123
v_perm_b32 v123, v165, v164, s70
v_accvgpr_write_b32 a58, v123
v_perm_b32 v123, v165, v164, s71
v_accvgpr_write_b32 a122, v123
v_perm_b32 v123, v167, v166, s70
v_accvgpr_write_b32 a59, v123
v_perm_b32 v123, v167, v166, s71
v_accvgpr_write_b32 a123, v123
v_perm_b32 v123, v169, v168, s70
v_accvgpr_write_b32 a184, v123
v_perm_b32 v123, v169, v168, s71
v_accvgpr_write_b32 a248, v123
v_perm_b32 v123, v171, v170, s70
v_accvgpr_write_b32 a185, v123
v_perm_b32 v123, v171, v170, s71
v_accvgpr_write_b32 a249, v123
v_perm_b32 v123, v173, v172, s70
v_accvgpr_write_b32 a186, v123
v_perm_b32 v123, v173, v172, s71
v_accvgpr_write_b32 a250, v123
v_perm_b32 v123, v175, v174, s70
v_accvgpr_write_b32 a187, v123
v_perm_b32 v123, v175, v174, s71
v_accvgpr_write_b32 a251, v123
s_waitcnt vmcnt(8)
v_perm_b32 v123, v129, v128, s70
v_accvgpr_write_b32 a60, v123
v_perm_b32 v123, v129, v128, s71
v_accvgpr_write_b32 a124, v123
v_perm_b32 v123, v131, v130, s70
v_accvgpr_write_b32 a61, v123
v_perm_b32 v123, v131, v130, s71
v_accvgpr_write_b32 a125, v123
v_perm_b32 v123, v133, v132, s70
v_accvgpr_write_b32 a62, v123
v_perm_b32 v123, v133, v132, s71
v_accvgpr_write_b32 a126, v123
v_perm_b32 v123, v135, v134, s70
v_accvgpr_write_b32 a63, v123
v_perm_b32 v123, v135, v134, s71
v_accvgpr_write_b32 a127, v123
v_perm_b32 v123, v137, v136, s70
v_accvgpr_write_b32 a188, v123
v_perm_b32 v123, v137, v136, s71
v_accvgpr_write_b32 a252, v123
v_perm_b32 v123, v139, v138, s70
v_accvgpr_write_b32 a189, v123
v_perm_b32 v123, v139, v138, s71
v_accvgpr_write_b32 a253, v123
v_perm_b32 v123, v141, v140, s70
v_accvgpr_write_b32 a190, v123
v_perm_b32 v123, v141, v140, s71
v_accvgpr_write_b32 a254, v123
v_perm_b32 v123, v143, v142, s70
v_accvgpr_write_b32 a191, v123
v_perm_b32 v123, v143, v142, s71
v_accvgpr_write_b32 a255, v123
s_waitcnt vmcnt(0)
ds_write_b128 v5, v[32:35] offset:0
ds_write_b128 v5, v[36:39] offset:1024
ds_write_b128 v5, v[40:43] offset:2048
ds_write_b128 v5, v[44:47] offset:3072
ds_write_b128 v5, v[48:51] offset:4096
ds_write_b128 v5, v[52:55] offset:5120
ds_write_b128 v5, v[56:59] offset:6144
ds_write_b128 v5, v[60:63] offset:7168
s_waitcnt lgkmcnt(0)
buffer_load_dwordx4 v[32:35], v11, s[4:7], s67 offen offset:0 sc1
buffer_load_dwordx4 v[36:39], v11, s[4:7], s67 offen offset:1024 sc1
buffer_load_dwordx4 v[40:43], v11, s[4:7], s67 offen offset:2048 sc1
buffer_load_dwordx4 v[44:47], v11, s[4:7], s67 offen offset:3072 sc1
buffer_load_dwordx4 v[48:51], v11, s[4:7], s77 offen offset:0 sc1
buffer_load_dwordx4 v[52:55], v11, s[4:7], s77 offen offset:1024 sc1
buffer_load_dwordx4 v[56:59], v11, s[4:7], s77 offen offset:2048 sc1
buffer_load_dwordx4 v[60:63], v11, s[4:7], s77 offen offset:3072 sc1
s_add_u32 s67, s67, s41
s_add_u32 s77, s67, 0x1000
v_mov_b32 v7, s59
s_mov_b64 exec, 1
buffer_store_dword v7, v9, s[4:7], s69 offen sc1
s_mov_b64 exec, -1
s_barrier
s_lshr_b32 s56, s43, 4
s_cmp_eq_u32 s56, 2
s_cbranch_scc1 L_s1_V0
L_s1_K0:
ds_read_b128 v[96:99], v3 offset:0
ds_read_b128 v[100:103], v3 offset:16384
ds_read_b128 v[104:107], v3 offset:1024
ds_read_b128 v[108:111], v3 offset:17408
s_waitcnt lgkmcnt(2)
v_mfma_f32_16x16x32_bf16 v[64:67], a[0:3], v[96:99], 0
ds_read_b128 v[112:115], v3 offset:2048
ds_read_b128 v[116:119], v3 offset:18432
v_mfma_f32_16x16x32_bf16 v[68:71], a[64:67], v[96:99], 0
s_add_u32 s62, s62, s63
v_mfma_f32_16x16x32_bf16 v[72:75], a[128:131], v[96:99], 0
s_add_u32 s74, s62, s64
v_mfma_f32_16x16x32_bf16 v[76:79], a[192:195], v[96:99], 0
s_add_u32 s75, s62, s65
v_mfma_f32_16x16x32_bf16 v[80:83], a[0:3], v[100:103], 0
s_add_u32 s76, s74, s65
v_mfma_f32_16x16x32_bf16 v[84:87], a[64:67], v[100:103], 0
v_mfma_f32_16x16x32_bf16 v[88:91], a[128:131], v[100:103], 0
v_mfma_f32_16x16x32_bf16 v[92:95], a[192:195], v[100:103], 0
s_waitcnt lgkmcnt(2)
v_mfma_f32_16x16x32_bf16 v[64:67], a[4:7], v[104:107], v[64:67]
ds_read_b128 v[96:99], v3 offset:3072
ds_read_b128 v[100:103], v3 offset:19456
v_mfma_f32_16x16x32_bf16 v[68:71], a[68:71], v[104:107], v[68:71]
v_cvt_pk_bf16_f32 v128, v128, v129
v_cvt_pk_bf16_f32 v129, v130, v131
v_mfma_f32_16x16x32_bf16 v[72:75], a[132:135], v[104:107], v[72:75]
v_cvt_pk_bf16_f32 v130, v132, v133
v_cvt_pk_bf16_f32 v131, v134, v135
v_mfma_f32_16x16x32_bf16 v[76:79], a[196:199], v[104:107], v[76:79]
v_pk_max_i16 v128, v128, s66
v_pk_max_i16 v129, v129, s66
v_mfma_f32_16x16x32_bf16 v[80:83], a[4:7], v[108:111], v[80:83]
v_pk_max_i16 v130, v130, s66
v_pk_max_i16 v131, v131, s66
v_mfma_f32_16x16x32_bf16 v[84:87], a[68:71], v[108:111], v[84:87]
buffer_store_dwordx4 v[128:131], v10, s[4:7], s62 offen sc1
v_mfma_f32_16x16x32_bf16 v[88:91], a[132:135], v[108:111], v[88:91]
v_mfma_f32_16x16x32_bf16 v[92:95], a[196:199], v[108:111], v[92:95]
s_waitcnt lgkmcnt(2)
v_mfma_f32_16x16x32_bf16 v[64:67], a[8:11], v[112:115], v[64:67]
ds_read_b128 v[104:107], v3 offset:4096
ds_read_b128 v[108:111], v3 offset:20480
v_mfma_f32_16x16x32_bf16 v[68:71], a[72:75], v[112:115], v[68:71]
v_cvt_pk_bf16_f32 v136, v136, v137
v_cvt_pk_bf16_f32 v137, v138, v139
v_mfma_f32_16x16x32_bf16 v[72:75], a[136:139], v[112:115], v[72:75]
v_cvt_pk_bf16_f32 v138, v140, v141
v_cvt_pk_bf16_f32 v139, v142, v143
v_mfma_f32_16x16x32_bf16 v[76:79], a[200:203], v[112:115], v[76:79]
v_pk_max_i16 v136, v136, s66
v_pk_max_i16 v137, v137, s66
v_mfma_f32_16x16x32_bf16 v[80:83], a[8:11], v[116:119], v[80:83]
v_pk_max_i16 v138, v138, s66
v_pk_max_i16 v139, v139, s66
v_mfma_f32_16x16x32_bf16 v[84:87], a[72:75], v[116:119], v[84:87]
buffer_store_dwordx4 v[136:139], v10, s[4:7], s75 offen sc1
v_mfma_f32_16x16x32_bf16 v[88:91], a[136:139], v[116:119], v[88:91]
v_mfma_f32_16x16x32_bf16 v[92:95], a[200:203], v[116:119], v[92:95]
s_waitcnt lgkmcnt(2)
v_mfma_f32_16x16x32_bf16 v[64:67], a[12:15], v[96:99], v[64:67]
ds_read_b128 v[112:115], v3 offset:5120
ds_read_b128 v[116:119], v3 offset:21504
v_mfma_f32_16x16x32_bf16 v[68:71], a[76:79], v[96:99], v[68:71]
v_cvt_pk_bf16_f32 v144, v144, v145
v_cvt_pk_bf16_f32 v145, v146, v147
v_mfma_f32_16x16x32_bf16 v[72:75], a[140:143], v[96:99], v[72:75]
v_cvt_pk_bf16_f32 v146, v148, v149
v_cvt_pk_bf16_f32 v147, v150, v151
v_mfma_f32_16x16x32_bf16 v[76:79], a[204:207], v[96:99], v[76:79]
v_pk_max_i16 v144, v144, s66
v_pk_max_i16 v145, v145, s66
v_mfma_f32_16x16x32_bf16 v[80:83], a[12:15], v[100:103], v[80:83]
v_pk_max_i16 v146, v146, s66
v_pk_max_i16 v147, v147, s66
v_mfma_f32_16x16x32_bf16 v[84:87], a[76:79], v[100:103], v[84:87]
buffer_store_dwordx4 v[144:147], v10, s[4:7], s74 offen sc1
v_mfma_f32_16x16x32_bf16 v[88:91], a[140:143], v[100:103], v[88:91]
v_mfma_f32_16x16x32_bf16 v[92:95], a[204:207], v[100:103], v[92:95]
s_waitcnt lgkmcnt(2)
v_mfma_f32_16x16x32_bf16 v[64:67], a[16:19], v[104:107], v[64:67]
ds_read_b128 v[96:99], v3 offset:6144
ds_read_b128 v[100:103], v3 offset:22528
v_mfma_f32_16x16x32_bf16 v[68:71], a[80:83], v[104:107], v[68:71]
v_cvt_pk_bf16_f32 v152, v152, v153
v_cvt_pk_bf16_f32 v153, v154, v155
v_mfma_f32_16x16x32_bf16 v[72:75], a[144:147], v[104:107], v[72:75]
v_cvt_pk_bf16_f32 v154, v156, v157
v_cvt_pk_bf16_f32 v155, v158, v159
v_mfma_f32_16x16x32_bf16 v[76:79], a[208:211], v[104:107], v[76:79]
v_pk_max_i16 v152, v152, s66
v_pk_max_i16 v153, v153, s66
v_mfma_f32_16x16x32_bf16 v[80:83], a[16:19], v[108:111], v[80:83]
v_pk_max_i16 v154, v154, s66
v_pk_max_i16 v155, v155, s66
v_mfma_f32_16x16x32_bf16 v[84:87], a[80:83], v[108:111], v[84:87]
buffer_store_dwordx4 v[152:155], v10, s[4:7], s76 offen sc1
v_mfma_f32_16x16x32_bf16 v[88:91], a[144:147], v[108:111], v[88:91]
v_mfma_f32_16x16x32_bf16 v[92:95], a[208:211], v[108:111], v[92:95]
s_waitcnt lgkmcnt(2)
v_mfma_f32_16x16x32_bf16 v[64:67], a[20:23], v[112:115], v[64:67]
ds_read_b128 v[104:107], v3 offset:7168
ds_read_b128 v[108:111], v3 offset:23552
v_mfma_f32_16x16x32_bf16 v[68:71], a[84:87], v[112:115], v[68:71]
v_mfma_f32_16x16x32_bf16 v[72:75], a[148:151], v[112:115], v[72:75]
v_mfma_f32_16x16x32_bf16 v[76:79], a[212:215], v[112:115], v[76:79]
v_mfma_f32_16x16x32_bf16 v[80:83], a[20:23], v[116:119], v[80:83]
v_mfma_f32_16x16x32_bf16 v[84:87], a[84:87], v[116:119], v[84:87]
v_mfma_f32_16x16x32_bf16 v[88:91], a[148:151], v[116:119], v[88:91]
v_mfma_f32_16x16x32_bf16 v[92:95], a[212:215], v[116:119], v[92:95]
s_waitcnt lgkmcnt(2)
v_mfma_f32_16x16x32_bf16 v[64:67], a[24:27], v[96:99], v[64:67]
ds_read_b128 v[112:115], v3 offset:8192
ds_read_b128 v[116:119], v3 offset:24576
v_mfma_f32_16x16x32_bf16 v[68:71], a[88:91], v[96:99], v[68:71]
v_mfma_f32_16x16x32_bf16 v[72:75], a[152:155], v[96:99], v[72:75]
v_mfma_f32_16x16x32_bf16 v[76:79], a[216:219], v[96:99], v[76:79]
v_mfma_f32_16x16x32_bf16 v[80:83], a[24:27], v[100:103], v[80:83]
v_mfma_f32_16x16x32_bf16 v[84:87], a[88:91], v[100:103], v[84:87]
v_mfma_f32_16x16x32_bf16 v[88:91], a[152:155], v[100:103], v[88:91]
v_mfma_f32_16x16x32_bf16 v[92:95], a[216:219], v[100:103], v[92:95]
s_waitcnt lgkmcnt(2)
v_mfma_f32_16x16x32_bf16 v[64:67], a[28:31], v[104:107], v[64:67]
ds_read_b128 v[96:99], v3 offset:9216
ds_read_b128 v[100:103], v3 offset:25600
v_mfma_f32_16x16x32_bf16 v[68:71], a[92:95], v[104:107], v[68:71]
s_waitcnt vmcnt(5)
v_mfma_f32_16x16x32_bf16 v[72:75], a[156:159], v[104:107], v[72:75]
ds_write_b128 v5, v[32:35] offset:32768
v_mfma_f32_16x16x32_bf16 v[76:79], a[220:223], v[104:107], v[76:79]
ds_write_b128 v5, v[36:39] offset:33792
v_mfma_f32_16x16x32_bf16 v[80:83], a[28:31], v[108:111], v[80:83]
v_mfma_f32_16x16x32_bf16 v[84:87], a[92:95], v[108:111], v[84:87]
v_mfma_f32_16x16x32_bf16 v[88:91], a[156:159], v[108:111], v[88:91]
v_mfma_f32_16x16x32_bf16 v[92:95], a[220:223], v[108:111], v[92:95]
s_waitcnt lgkmcnt(4)
v_mfma_f32_16x16x32_bf16 v[64:67], a[32:35], v[112:115], v[64:67]
ds_read_b128 v[104:107], v3 offset:10240
ds_read_b128 v[108:111], v3 offset:26624
v_mfma_f32_16x16x32_bf16 v[68:71], a[96:99], v[112:115], v[68:71]
ds_write_b128 v5, v[40:43] offset:34816
v_mfma_f32_16x16x32_bf16 v[72:75], a[160:163], v[112:115], v[72:75]
ds_write_b128 v5, v[44:47] offset:35840
v_mfma_f32_16x16x32_bf16 v[76:79], a[224:227], v[112:115], v[76:79]
v_mfma_f32_16x16x32_bf16 v[80:83], a[32:35], v[116:119], v[80:83]
v_mfma_f32_16x16x32_bf16 v[84:87], a[96:99], v[116:119], v[84:87]
v_mfma_f32_16x16x32_bf16 v[88:91], a[160:163], v[116:119], v[88:91]
v_mfma_f32_16x16x32_bf16 v[92:95], a[224:227], v[116:119], v[92:95]
s_waitcnt lgkmcnt(6)
v_mfma_f32_16x16x32_bf16 v[64:67], a[36:39], v[96:99], v[64:67]
ds_read_b128 v[112:115], v3 offset:11264
ds_read_b128 v[116:119], v3 offset:27648
v_mfma_f32_16x16x32_bf16 v[68:71], a[100:103], v[96:99], v[68:71]
ds_write_b128 v5, v[48:51] offset:36864
v_mfma_f32_16x16x32_bf16 v[72:75], a[164:167], v[96:99], v[72:75]
ds_write_b128 v5, v[52:55] offset:37888
v_mfma_f32_16x16x32_bf16 v[76:79], a[228:231], v[96:99], v[76:79]
v_mfma_f32_16x16x32_bf16 v[80:83], a[36:39], v[100:103], v[80:83]
v_mfma_f32_16x16x32_bf16 v[84:87], a[100:103], v[100:103], v[84:87]
v_mfma_f32_16x16x32_bf16 v[88:91], a[164:167], v[100:103], v[88:91]
v_mfma_f32_16x16x32_bf16 v[92:95], a[228:231], v[100:103], v[92:95]
s_waitcnt lgkmcnt(6)
v_mfma_f32_16x16x32_bf16 v[64:67], a[40:43], v[104:107], v[64:67]
ds_read_b128 v[96:99], v3 offset:12288
ds_read_b128 v[100:103], v3 offset:28672
v_mfma_f32_16x16x32_bf16 v[68:71], a[104:107], v[104:107], v[68:71]
ds_write_b128 v5, v[56:59] offset:38912
v_mfma_f32_16x16x32_bf16 v[72:75], a[168:171], v[104:107], v[72:75]
ds_write_b128 v5, v[60:63] offset:39936
v_mfma_f32_16x16x32_bf16 v[76:79], a[232:235], v[104:107], v[76:79]
v_mfma_f32_16x16x32_bf16 v[80:83], a[40:43], v[108:111], v[80:83]
v_mfma_f32_16x16x32_bf16 v[84:87], a[104:107], v[108:111], v[84:87]
v_mfma_f32_16x16x32_bf16 v[88:91], a[168:171], v[108:111], v[88:91]
v_mfma_f32_16x16x32_bf16 v[92:95], a[232:235], v[108:111], v[92:95]
s_waitcnt lgkmcnt(6)
v_mfma_f32_16x16x32_bf16 v[64:67], a[44:47], v[112:115], v[64:67]
ds_read_b128 v[104:107], v3 offset:13312
ds_read_b128 v[108:111], v3 offset:29696
v_mfma_f32_16x16x32_bf16 v[68:71], a[108:111], v[112:115], v[68:71]
s_add_u32 s56, s72, 2
v_mfma_f32_16x16x32_bf16 v[72:75], a[172:175], v[112:115], v[72:75]
s_cmp_lt_u32 s56, s73
v_mfma_f32_16x16x32_bf16 v[76:79], a[236:239], v[112:115], v[76:79]
s_cselect_b32 s56, 0, 0x7ff00000
v_mfma_f32_16x16x32_bf16 v[80:83], a[44:47], v[116:119], v[80:83]
v_or_b32 v11, s56, v5
v_mfma_f32_16x16x32_bf16 v[84:87], a[108:111], v[116:119], v[84:87]
v_mov_b32 v10, v3
v_mfma_f32_16x16x32_bf16 v[88:91], a[172:175], v[116:119], v[88:91]
v_mfma_f32_16x16x32_bf16 v[92:95], a[236:239], v[116:119], v[92:95]
s_waitcnt lgkmcnt(4)
v_mfma_f32_16x16x32_bf16 v[64:67], a[48:51], v[96:99], v[64:67]
ds_read_b128 v[112:115], v3 offset:14336
ds_read_b128 v[116:119], v3 offset:30720
v_mfma_f32_16x16x32_bf16 v[68:71], a[112:115], v[96:99], v[68:71]
s_waitcnt lgkmcnt(4)
buffer_load_dwordx4 v[32:35], v11, s[4:7], s67 offen offset:0 sc1
v_mfma_f32_16x16x32_bf16 v[72:75], a[176:179], v[96:99], v[72:75]
buffer_load_dwordx4 v[36:39], v11, s[4:7], s67 offen offset:1024 sc1
v_mfma_f32_16x16x32_bf16 v[76:79], a[240:243], v[96:99], v[76:79]
buffer_load_dwordx4 v[40:43], v11, s[4:7], s67 offen offset:2048 sc1
v_mfma_f32_16x16x32_bf16 v[80:83], a[48:51], v[100:103], v[80:83]
v_mfma_f32_16x16x32_bf16 v[84:87], a[112:115], v[100:103], v[84:87]
v_mfma_f32_16x16x32_bf16 v[88:91], a[176:179], v[100:103], v[88:91]
v_mfma_f32_16x16x32_bf16 v[92:95], a[240:243], v[100:103], v[92:95]
s_waitcnt lgkmcnt(2)
v_mfma_f32_16x16x32_bf16 v[64:67], a[52:55], v[104:107], v[64:67]
ds_read_b128 v[96:99], v3 offset:15360
ds_read_b128 v[100:103], v3 offset:31744
v_mfma_f32_16x16x32_bf16 v[68:71], a[116:119], v[104:107], v[68:71]
buffer_load_dwordx4 v[44:47], v11, s[4:7], s67 offen offset:3072 sc1
v_mfma_f32_16x16x32_bf16 v[72:75], a[180:183], v[104:107], v[72:75]
buffer_load_dwordx4 v[48:51], v11, s[4:7], s77 offen offset:0 sc1
v_mfma_f32_16x16x32_bf16 v[76:79], a[244:247], v[104:107], v[76:79]
buffer_load_dwordx4 v[52:55], v11, s[4:7], s77 offen offset:1024 sc1
v_mfma_f32_16x16x32_bf16 v[80:83], a[52:55], v[108:111], v[80:83]
v_mfma_f32_16x16x32_bf16 v[84:87], a[116:119], v[108:111], v[84:87]
v_mfma_f32_16x16x32_bf16 v[88:91], a[180:183], v[108:111], v[88:91]
v_mfma_f32_16x16x32_bf16 v[92:95], a[244:247], v[108:111], v[92:95]
s_waitcnt lgkmcnt(2)
v_mfma_f32_16x16x32_bf16 v[64:67], a[56:59], v[112:115], v[64:67]
v_mfma_f32_16x16x32_bf16 v[68:71], a[120:123], v[112:115], v[68:71]
buffer_load_dwordx4 v[56:59], v11, s[4:7], s77 offen offset:2048 sc1
v_mfma_f32_16x16x32_bf16 v[72:75], a[184:187], v[112:115], v[72:75]
buffer_load_dwordx4 v[60:63], v11, s[4:7], s77 offen offset:3072 sc1
v_mfma_f32_16x16x32_bf16 v[76:79], a[248:251], v[112:115], v[76:79]
v_mfma_f32_16x16x32_bf16 v[80:83], a[56:59], v[116:119], v[80:83]
v_mfma_f32_16x16x32_bf16 v[84:87], a[120:123], v[116:119], v[84:87]
v_mfma_f32_16x16x32_bf16 v[88:91], a[184:187], v[116:119], v[88:91]
v_mfma_f32_16x16x32_bf16 v[92:95], a[248:251], v[116:119], v[92:95]
s_waitcnt lgkmcnt(0)
v_mfma_f32_16x16x32_bf16 v[64:67], a[60:63], v[96:99], v[64:67]
v_mfma_f32_16x16x32_bf16 v[68:71], a[124:127], v[96:99], v[68:71]
s_add_u32 s67, s67, s41
v_mfma_f32_16x16x32_bf16 v[72:75], a[188:191], v[96:99], v[72:75]
s_add_u32 s77, s67, 0x1000
v_mfma_f32_16x16x32_bf16 v[76:79], a[252:255], v[96:99], v[76:79]
v_mfma_f32_16x16x32_bf16 v[80:83], a[60:63], v[100:103], v[80:83]
v_mfma_f32_16x16x32_bf16 v[84:87], a[124:127], v[100:103], v[84:87]
v_mfma_f32_16x16x32_bf16 v[88:91], a[188:191], v[100:103], v[88:91]
v_mfma_f32_16x16x32_bf16 v[92:95], a[252:255], v[100:103], v[92:95]
s_mul_i32 s56, s72, s78
s_add_u32 s56, s56, s59
s_cmp_ge_u32 s72, 4
s_cbranch_scc1 L_s1nw_39
s_waitcnt vmcnt(8)
s_add_u32 s56, s56, s78
L_s1nw_39:
s_sub_u32 s56, s56, s78
v_mov_b32 v7, s56
s_add_u32 s72, s72, 1
s_cmp_lt_u32 s72, s73
s_waitcnt lgkmcnt(0)
s_barrier
s_mov_b64 exec, 1
buffer_store_dword v7, v9, s[4:7], s69 offen sc1
s_mov_b64 exec, -1
s_cbranch_scc0 L_s1_Ke0
L_s1_K1:
s_cmp_lg_u32 s72, 3
s_cbranch_scc1 L_s1_K_xn
s_mov_b32 s57, 0
L_wf_40:
buffer_load_dword v8, v12, s[4:7], s68 offen offset:0 sc1
s_add_u32 s57, s57, 1
s_cmp_ge_u32 s57, 524288
s_cbranch_scc1 L_end
s_waitcnt vmcnt(0)
v_cmp_ge_u32 vcc, 0, v8
s_cbranch_vccnz L_wf_40
L_s1_K_xn:
s_cmp_lg_u32 s72, 3
s_cbranch_scc1 L_s1_K_go
s_lshr_b32 s58, s42, 4
s_lshl_b32 s58, s58, 7
v_mov_b32 v121, 0
s_mov_b32 s57, 0
L_wf_41:
buffer_load_dword v8, v121, s[4:7], s58 offen offset:2048 sc1
s_add_u32 s57, s57, 1
s_cmp_ge_u32 s57, 524288
s_cbranch_scc1 L_end
s_waitcnt vmcnt(0)
v_cmp_ge_u32 vcc, 0, v8
s_cbranch_vccz L_wfx_42
s_sleep 8
s_branch L_wf_41
L_wfx_42:
L_s1_K_go:
ds_read_b128 v[96:99], v3 offset:32768
ds_read_b128 v[100:103], v3 offset:49152
ds_read_b128 v[104:107], v3 offset:33792
ds_read_b128 v[108:111], v3 offset:50176
s_waitcnt lgkmcnt(2)
v_mfma_f32_16x16x32_bf16 v[128:131], a[0:3], v[96:99], 0
ds_read_b128 v[112:115], v3 offset:34816
ds_read_b128 v[116:119], v3 offset:51200
v_mfma_f32_16x16x32_bf16 v[132:135], a[64:67], v[96:99], 0
s_add_u32 s62, s62, s63
v_mfma_f32_16x16x32_bf16 v[136:139], a[128:131], v[96:99], 0
s_add_u32 s74, s62, s64
v_mfma_f32_16x16x32_bf16 v[140:143], a[192:195], v[96:99], 0
s_add_u32 s75, s62, s65
v_mfma_f32_16x16x32_bf16 v[144:147], a[0:3], v[100:103], 0
s_add_u32 s76, s74, s65
v_mfma_f32_16x16x32_bf16 v[148:151], a[64:67], v[100:103], 0
v_mfma_f32_16x16x32_bf16 v[152:155], a[128:131], v[100:103], 0
v_mfma_f32_16x16x32_bf16 v[156:159], a[192:195], v[100:103], 0
s_waitcnt lgkmcnt(2)
v_mfma_f32_16x16x32_bf16 v[128:131], a[4:7], v[104:107], v[128:131]
ds_read_b128 v[96:99], v3 offset:35840
ds_read_b128 v[100:103], v3 offset:52224
v_mfma_f32_16x16x32_bf16 v[132:135], a[68:71], v[104:107], v[132:135]
v_cvt_pk_bf16_f32 v64, v64, v65
v_cvt_pk_bf16_f32 v65, v66, v67
v_mfma_f32_16x16x32_bf16 v[136:139], a[132:135], v[104:107], v[136:139]
v_cvt_pk_bf16_f32 v66, v68, v69
v_cvt_pk_bf16_f32 v67, v70, v71
v_mfma_f32_16x16x32_bf16 v[140:143], a[196:199], v[104:107], v[140:143]
v_pk_max_i16 v64, v64, s66
v_pk_max_i16 v65, v65, s66
v_mfma_f32_16x16x32_bf16 v[144:147], a[4:7], v[108:111], v[144:147]
v_pk_max_i16 v66, v66, s66
v_pk_max_i16 v67, v67, s66
v_mfma_f32_16x16x32_bf16 v[148:151], a[68:71], v[108:111], v[148:151]
buffer_store_dwordx4 v[64:67], v10, s[4:7], s62 offen sc1
v_mfma_f32_16x16x32_bf16 v[152:155], a[132:135], v[108:111], v[152:155]
v_mfma_f32_16x16x32_bf16 v[156:159], a[196:199], v[108:111], v[156:159]
s_waitcnt lgkmcnt(2)
v_mfma_f32_16x16x32_bf16 v[128:131], a[8:11], v[112:115], v[128:131]
ds_read_b128 v[104:107], v3 offset:36864
ds_read_b128 v[108:111], v3 offset:53248
v_mfma_f32_16x16x32_bf16 v[132:135], a[72:75], v[112:115], v[132:135]
v_cvt_pk_bf16_f32 v72, v72, v73
v_cvt_pk_bf16_f32 v73, v74, v75
v_mfma_f32_16x16x32_bf16 v[136:139], a[136:139], v[112:115], v[136:139]
v_cvt_pk_bf16_f32 v74, v76, v77
v_cvt_pk_bf16_f32 v75, v78, v79
v_mfma_f32_16x16x32_bf16 v[140:143], a[200:203], v[112:115], v[140:143]
v_pk_max_i16 v72, v72, s66
v_pk_max_i16 v73, v73, s66
v_mfma_f32_16x16x32_bf16 v[144:147], a[8:11], v[116:119], v[144:147]
v_pk_max_i16 v74, v74, s66
v_pk_max_i16 v75, v75, s66
v_mfma_f32_16x16x32_bf16 v[148:151], a[72:75], v[116:119], v[148:151]
buffer_store_dwordx4 v[72:75], v10, s[4:7], s75 offen sc1
v_mfma_f32_16x16x32_bf16 v[152:155], a[136:139], v[116:119], v[152:155]
v_mfma_f32_16x16x32_bf16 v[156:159], a[200:203], v[116:119], v[156:159]
s_waitcnt lgkmcnt(2)
v_mfma_f32_16x16x32_bf16 v[128:131], a[12:15], v[96:99], v[128:131]
ds_read_b128 v[112:115], v3 offset:37888
ds_read_b128 v[116:119], v3 offset:54272
v_mfma_f32_16x16x32_bf16 v[132:135], a[76:79], v[96:99], v[132:135]
v_cvt_pk_bf16_f32 v80, v80, v81
v_cvt_pk_bf16_f32 v81, v82, v83
v_mfma_f32_16x16x32_bf16 v[136:139], a[140:143], v[96:99], v[136:139]
v_cvt_pk_bf16_f32 v82, v84, v85
v_cvt_pk_bf16_f32 v83, v86, v87
v_mfma_f32_16x16x32_bf16 v[140:143], a[204:207], v[96:99], v[140:143]
v_pk_max_i16 v80, v80, s66
v_pk_max_i16 v81, v81, s66
v_mfma_f32_16x16x32_bf16 v[144:147], a[12:15], v[100:103], v[144:147]
v_pk_max_i16 v82, v82, s66
v_pk_max_i16 v83, v83, s66
v_mfma_f32_16x16x32_bf16 v[148:151], a[76:79], v[100:103], v[148:151]
buffer_store_dwordx4 v[80:83], v10, s[4:7], s74 offen sc1
v_mfma_f32_16x16x32_bf16 v[152:155], a[140:143], v[100:103], v[152:155]
v_mfma_f32_16x16x32_bf16 v[156:159], a[204:207], v[100:103], v[156:159]
s_waitcnt lgkmcnt(2)
v_mfma_f32_16x16x32_bf16 v[128:131], a[16:19], v[104:107], v[128:131]
ds_read_b128 v[96:99], v3 offset:38912
ds_read_b128 v[100:103], v3 offset:55296
v_mfma_f32_16x16x32_bf16 v[132:135], a[80:83], v[104:107], v[132:135]
v_cvt_pk_bf16_f32 v88, v88, v89
v_cvt_pk_bf16_f32 v89, v90, v91
v_mfma_f32_16x16x32_bf16 v[136:139], a[144:147], v[104:107], v[136:139]
v_cvt_pk_bf16_f32 v90, v92, v93
v_cvt_pk_bf16_f32 v91, v94, v95
v_mfma_f32_16x16x32_bf16 v[140:143], a[208:211], v[104:107], v[140:143]
v_pk_max_i16 v88, v88, s66
v_pk_max_i16 v89, v89, s66
v_mfma_f32_16x16x32_bf16 v[144:147], a[16:19], v[108:111], v[144:147]
v_pk_max_i16 v90, v90, s66
v_pk_max_i16 v91, v91, s66
v_mfma_f32_16x16x32_bf16 v[148:151], a[80:83], v[108:111], v[148:151]
buffer_store_dwordx4 v[88:91], v10, s[4:7], s76 offen sc1
v_mfma_f32_16x16x32_bf16 v[152:155], a[144:147], v[108:111], v[152:155]
v_mfma_f32_16x16x32_bf16 v[156:159], a[208:211], v[108:111], v[156:159]
s_waitcnt lgkmcnt(2)
v_mfma_f32_16x16x32_bf16 v[128:131], a[20:23], v[112:115], v[128:131]
ds_read_b128 v[104:107], v3 offset:39936
ds_read_b128 v[108:111], v3 offset:56320
v_mfma_f32_16x16x32_bf16 v[132:135], a[84:87], v[112:115], v[132:135]
v_mfma_f32_16x16x32_bf16 v[136:139], a[148:151], v[112:115], v[136:139]
v_mfma_f32_16x16x32_bf16 v[140:143], a[212:215], v[112:115], v[140:143]
v_mfma_f32_16x16x32_bf16 v[144:147], a[20:23], v[116:119], v[144:147]
v_mfma_f32_16x16x32_bf16 v[148:151], a[84:87], v[116:119], v[148:151]
v_mfma_f32_16x16x32_bf16 v[152:155], a[148:151], v[116:119], v[152:155]
v_mfma_f32_16x16x32_bf16 v[156:159], a[212:215], v[116:119], v[156:159]
s_waitcnt lgkmcnt(2)
v_mfma_f32_16x16x32_bf16 v[128:131], a[24:27], v[96:99], v[128:131]
ds_read_b128 v[112:115], v3 offset:40960
ds_read_b128 v[116:119], v3 offset:57344
v_mfma_f32_16x16x32_bf16 v[132:135], a[88:91], v[96:99], v[132:135]
v_mfma_f32_16x16x32_bf16 v[136:139], a[152:155], v[96:99], v[136:139]
v_mfma_f32_16x16x32_bf16 v[140:143], a[216:219], v[96:99], v[140:143]
v_mfma_f32_16x16x32_bf16 v[144:147], a[24:27], v[100:103], v[144:147]
v_mfma_f32_16x16x32_bf16 v[148:151], a[88:91], v[100:103], v[148:151]
v_mfma_f32_16x16x32_bf16 v[152:155], a[152:155], v[100:103], v[152:155]
v_mfma_f32_16x16x32_bf16 v[156:159], a[216:219], v[100:103], v[156:159]
s_waitcnt lgkmcnt(2)
v_mfma_f32_16x16x32_bf16 v[128:131], a[28:31], v[104:107], v[128:131]
ds_read_b128 v[96:99], v3 offset:41984
ds_read_b128 v[100:103], v3 offset:58368
v_mfma_f32_16x16x32_bf16 v[132:135], a[92:95], v[104:107], v[132:135]
s_waitcnt vmcnt(5)
v_mfma_f32_16x16x32_bf16 v[136:139], a[156:159], v[104:107], v[136:139]
ds_write_b128 v5, v[32:35] offset:0
v_mfma_f32_16x16x32_bf16 v[140:143], a[220:223], v[104:107], v[140:143]
ds_write_b128 v5, v[36:39] offset:1024
v_mfma_f32_16x16x32_bf16 v[144:147], a[28:31], v[108:111], v[144:147]
v_mfma_f32_16x16x32_bf16 v[148:151], a[92:95], v[108:111], v[148:151]
v_mfma_f32_16x16x32_bf16 v[152:155], a[156:159], v[108:111], v[152:155]
v_mfma_f32_16x16x32_bf16 v[156:159], a[220:223], v[108:111], v[156:159]
s_waitcnt lgkmcnt(4)
v_mfma_f32_16x16x32_bf16 v[128:131], a[32:35], v[112:115], v[128:131]
ds_read_b128 v[104:107], v3 offset:43008
ds_read_b128 v[108:111], v3 offset:59392
v_mfma_f32_16x16x32_bf16 v[132:135], a[96:99], v[112:115], v[132:135]
ds_write_b128 v5, v[40:43] offset:2048
v_mfma_f32_16x16x32_bf16 v[136:139], a[160:163], v[112:115], v[136:139]
ds_write_b128 v5, v[44:47] offset:3072
v_mfma_f32_16x16x32_bf16 v[140:143], a[224:227], v[112:115], v[140:143]
v_mfma_f32_16x16x32_bf16 v[144:147], a[32:35], v[116:119], v[144:147]
v_mfma_f32_16x16x32_bf16 v[148:151], a[96:99], v[116:119], v[148:151]
v_mfma_f32_16x16x32_bf16 v[152:155], a[160:163], v[116:119], v[152:155]
v_mfma_f32_16x16x32_bf16 v[156:159], a[224:227], v[116:119], v[156:159]
s_waitcnt lgkmcnt(6)
v_mfma_f32_16x16x32_bf16 v[128:131], a[36:39], v[96:99], v[128:131]
ds_read_b128 v[112:115], v3 offset:44032
ds_read_b128 v[116:119], v3 offset:60416
v_mfma_f32_16x16x32_bf16 v[132:135], a[100:103], v[96:99], v[132:135]
ds_write_b128 v5, v[48:51] offset:4096
v_mfma_f32_16x16x32_bf16 v[136:139], a[164:167], v[96:99], v[136:139]
ds_write_b128 v5, v[52:55] offset:5120
v_mfma_f32_16x16x32_bf16 v[140:143], a[228:231], v[96:99], v[140:143]
v_mfma_f32_16x16x32_bf16 v[144:147], a[36:39], v[100:103], v[144:147]
v_mfma_f32_16x16x32_bf16 v[148:151], a[100:103], v[100:103], v[148:151]
v_mfma_f32_16x16x32_bf16 v[152:155], a[164:167], v[100:103], v[152:155]
v_mfma_f32_16x16x32_bf16 v[156:159], a[228:231], v[100:103], v[156:159]
s_waitcnt lgkmcnt(6)
v_mfma_f32_16x16x32_bf16 v[128:131], a[40:43], v[104:107], v[128:131]
ds_read_b128 v[96:99], v3 offset:45056
ds_read_b128 v[100:103], v3 offset:61440
v_mfma_f32_16x16x32_bf16 v[132:135], a[104:107], v[104:107], v[132:135]
ds_write_b128 v5, v[56:59] offset:6144
v_mfma_f32_16x16x32_bf16 v[136:139], a[168:171], v[104:107], v[136:139]
ds_write_b128 v5, v[60:63] offset:7168
v_mfma_f32_16x16x32_bf16 v[140:143], a[232:235], v[104:107], v[140:143]
v_mfma_f32_16x16x32_bf16 v[144:147], a[40:43], v[108:111], v[144:147]
v_mfma_f32_16x16x32_bf16 v[148:151], a[104:107], v[108:111], v[148:151]
v_mfma_f32_16x16x32_bf16 v[152:155], a[168:171], v[108:111], v[152:155]
v_mfma_f32_16x16x32_bf16 v[156:159], a[232:235], v[108:111], v[156:159]
s_waitcnt lgkmcnt(6)
v_mfma_f32_16x16x32_bf16 v[128:131], a[44:47], v[112:115], v[128:131]
ds_read_b128 v[104:107], v3 offset:46080
ds_read_b128 v[108:111], v3 offset:62464
v_mfma_f32_16x16x32_bf16 v[132:135], a[108:111], v[112:115], v[132:135]
s_add_u32 s56, s72, 2
v_mfma_f32_16x16x32_bf16 v[136:139], a[172:175], v[112:115], v[136:139]
s_cmp_lt_u32 s56, s73
v_mfma_f32_16x16x32_bf16 v[140:143], a[236:239], v[112:115], v[140:143]
s_cselect_b32 s56, 0, 0x7ff00000
v_mfma_f32_16x16x32_bf16 v[144:147], a[44:47], v[116:119], v[144:147]
v_or_b32 v11, s56, v5
v_mfma_f32_16x16x32_bf16 v[148:151], a[108:111], v[116:119], v[148:151]
v_mov_b32 v10, v3
v_mfma_f32_16x16x32_bf16 v[152:155], a[172:175], v[116:119], v[152:155]
v_mfma_f32_16x16x32_bf16 v[156:159], a[236:239], v[116:119], v[156:159]
s_waitcnt lgkmcnt(4)
v_mfma_f32_16x16x32_bf16 v[128:131], a[48:51], v[96:99], v[128:131]
ds_read_b128 v[112:115], v3 offset:47104
ds_read_b128 v[116:119], v3 offset:63488
v_mfma_f32_16x16x32_bf16 v[132:135], a[112:115], v[96:99], v[132:135]
s_waitcnt lgkmcnt(4)
buffer_load_dwordx4 v[32:35], v11, s[4:7], s67 offen offset:0 sc1
v_mfma_f32_16x16x32_bf16 v[136:139], a[176:179], v[96:99], v[136:139]
buffer_load_dwordx4 v[36:39], v11, s[4:7], s67 offen offset:1024 sc1
v_mfma_f32_16x16x32_bf16 v[140:143], a[240:243], v[96:99], v[140:143]
buffer_load_dwordx4 v[40:43], v11, s[4:7], s67 offen offset:2048 sc1
v_mfma_f32_16x16x32_bf16 v[144:147], a[48:51], v[100:103], v[144:147]
v_mfma_f32_16x16x32_bf16 v[148:151], a[112:115], v[100:103], v[148:151]
v_mfma_f32_16x16x32_bf16 v[152:155], a[176:179], v[100:103], v[152:155]
v_mfma_f32_16x16x32_bf16 v[156:159], a[240:243], v[100:103], v[156:159]
s_waitcnt lgkmcnt(2)
v_mfma_f32_16x16x32_bf16 v[128:131], a[52:55], v[104:107], v[128:131]
ds_read_b128 v[96:99], v3 offset:48128
ds_read_b128 v[100:103], v3 offset:64512
v_mfma_f32_16x16x32_bf16 v[132:135], a[116:119], v[104:107], v[132:135]
buffer_load_dwordx4 v[44:47], v11, s[4:7], s67 offen offset:3072 sc1
v_mfma_f32_16x16x32_bf16 v[136:139], a[180:183], v[104:107], v[136:139]
buffer_load_dwordx4 v[48:51], v11, s[4:7], s77 offen offset:0 sc1
v_mfma_f32_16x16x32_bf16 v[140:143], a[244:247], v[104:107], v[140:143]
buffer_load_dwordx4 v[52:55], v11, s[4:7], s77 offen offset:1024 sc1
v_mfma_f32_16x16x32_bf16 v[144:147], a[52:55], v[108:111], v[144:147]
v_mfma_f32_16x16x32_bf16 v[148:151], a[116:119], v[108:111], v[148:151]
v_mfma_f32_16x16x32_bf16 v[152:155], a[180:183], v[108:111], v[152:155]
v_mfma_f32_16x16x32_bf16 v[156:159], a[244:247], v[108:111], v[156:159]
s_waitcnt lgkmcnt(2)
v_mfma_f32_16x16x32_bf16 v[128:131], a[56:59], v[112:115], v[128:131]
v_mfma_f32_16x16x32_bf16 v[132:135], a[120:123], v[112:115], v[132:135]
buffer_load_dwordx4 v[56:59], v11, s[4:7], s77 offen offset:2048 sc1
v_mfma_f32_16x16x32_bf16 v[136:139], a[184:187], v[112:115], v[136:139]
buffer_load_dwordx4 v[60:63], v11, s[4:7], s77 offen offset:3072 sc1
v_mfma_f32_16x16x32_bf16 v[140:143], a[248:251], v[112:115], v[140:143]
v_mfma_f32_16x16x32_bf16 v[144:147], a[56:59], v[116:119], v[144:147]
v_mfma_f32_16x16x32_bf16 v[148:151], a[120:123], v[116:119], v[148:151]
v_mfma_f32_16x16x32_bf16 v[152:155], a[184:187], v[116:119], v[152:155]
v_mfma_f32_16x16x32_bf16 v[156:159], a[248:251], v[116:119], v[156:159]
s_waitcnt lgkmcnt(0)
v_mfma_f32_16x16x32_bf16 v[128:131], a[60:63], v[96:99], v[128:131]
v_mfma_f32_16x16x32_bf16 v[132:135], a[124:127], v[96:99], v[132:135]
s_add_u32 s67, s67, s41
v_mfma_f32_16x16x32_bf16 v[136:139], a[188:191], v[96:99], v[136:139]
s_add_u32 s77, s67, 0x1000
v_mfma_f32_16x16x32_bf16 v[140:143], a[252:255], v[96:99], v[140:143]
v_mfma_f32_16x16x32_bf16 v[144:147], a[60:63], v[100:103], v[144:147]
v_mfma_f32_16x16x32_bf16 v[148:151], a[124:127], v[100:103], v[148:151]
v_mfma_f32_16x16x32_bf16 v[152:155], a[188:191], v[100:103], v[152:155]
v_mfma_f32_16x16x32_bf16 v[156:159], a[252:255], v[100:103], v[156:159]
s_mul_i32 s56, s72, s78
s_add_u32 s56, s56, s59
s_cmp_ge_u32 s72, 4
s_cbranch_scc1 L_s1nw_43
s_waitcnt vmcnt(8)
s_add_u32 s56, s56, s78
L_s1nw_43:
s_sub_u32 s56, s56, s78
v_mov_b32 v7, s56
s_add_u32 s72, s72, 1
s_cmp_lt_u32 s72, s73
s_waitcnt lgkmcnt(0)
s_barrier
s_mov_b64 exec, 1
buffer_store_dword v7, v9, s[4:7], s69 offen sc1
s_mov_b64 exec, -1
s_cbranch_scc1 L_s1_K0
s_add_u32 s62, s62, s63
s_add_u32 s74, s62, s64
s_add_u32 s75, s62, s65
s_add_u32 s76, s74, s65
v_cvt_pk_bf16_f32 v128, v128, v129
v_cvt_pk_bf16_f32 v129, v130, v131
v_cvt_pk_bf16_f32 v130, v132, v133
v_cvt_pk_bf16_f32 v131, v134, v135
v_pk_max_i16 v128, v128, s66
v_pk_max_i16 v129, v129, s66
v_pk_max_i16 v130, v130, s66
v_pk_max_i16 v131, v131, s66
buffer_store_dwordx4 v[128:131], v10, s[4:7], s62 offen sc1
v_cvt_pk_bf16_f32 v136, v136, v137
v_cvt_pk_bf16_f32 v137, v138, v139
v_cvt_pk_bf16_f32 v138, v140, v141
v_cvt_pk_bf16_f32 v139, v142, v143
v_pk_max_i16 v136, v136, s66
v_pk_max_i16 v137, v137, s66
v_pk_max_i16 v138, v138, s66
v_pk_max_i16 v139, v139, s66
buffer_store_dwordx4 v[136:139], v10, s[4:7], s75 offen sc1
v_cvt_pk_bf16_f32 v144, v144, v145
v_cvt_pk_bf16_f32 v145, v146, v147
v_cvt_pk_bf16_f32 v146, v148, v149
v_cvt_pk_bf16_f32 v147, v150, v151
v_pk_max_i16 v144, v144, s66
v_pk_max_i16 v145, v145, s66
v_pk_max_i16 v146, v146, s66
v_pk_max_i16 v147, v147, s66
buffer_store_dwordx4 v[144:147], v10, s[4:7], s74 offen sc1
v_cvt_pk_bf16_f32 v152, v152, v153
v_cvt_pk_bf16_f32 v153, v154, v155
v_cvt_pk_bf16_f32 v154, v156, v157
v_cvt_pk_bf16_f32 v155, v158, v159
v_pk_max_i16 v152, v152, s66
v_pk_max_i16 v153, v153, s66
v_pk_max_i16 v154, v154, s66
v_pk_max_i16 v155, v155, s66
buffer_store_dwordx4 v[152:155], v10, s[4:7], s76 offen sc1
s_branch L_s1_tail
L_s1_Ke0:
s_add_u32 s62, s62, s63
s_add_u32 s74, s62, s64
s_add_u32 s75, s62, s65
s_add_u32 s76, s74, s65
v_cvt_pk_bf16_f32 v64, v64, v65
v_cvt_pk_bf16_f32 v65, v66, v67
v_cvt_pk_bf16_f32 v66, v68, v69
v_cvt_pk_bf16_f32 v67, v70, v71
v_pk_max_i16 v64, v64, s66
v_pk_max_i16 v65, v65, s66
v_pk_max_i16 v66, v66, s66
v_pk_max_i16 v67, v67, s66
buffer_store_dwordx4 v[64:67], v10, s[4:7], s62 offen sc1
v_cvt_pk_bf16_f32 v72, v72, v73
v_cvt_pk_bf16_f32 v73, v74, v75
v_cvt_pk_bf16_f32 v74, v76, v77
v_cvt_pk_bf16_f32 v75, v78, v79
v_pk_max_i16 v72, v72, s66
v_pk_max_i16 v73, v73, s66
v_pk_max_i16 v74, v74, s66
v_pk_max_i16 v75, v75, s66
buffer_store_dwordx4 v[72:75], v10, s[4:7], s75 offen sc1
v_cvt_pk_bf16_f32 v80, v80, v81
v_cvt_pk_bf16_f32 v81, v82, v83
v_cvt_pk_bf16_f32 v82, v84, v85
v_cvt_pk_bf16_f32 v83, v86, v87
v_pk_max_i16 v80, v80, s66
v_pk_max_i16 v81, v81, s66
v_pk_max_i16 v82, v82, s66
v_pk_max_i16 v83, v83, s66
buffer_store_dwordx4 v[80:83], v10, s[4:7], s74 offen sc1
v_cvt_pk_bf16_f32 v88, v88, v89
v_cvt_pk_bf16_f32 v89, v90, v91
v_cvt_pk_bf16_f32 v90, v92, v93
v_cvt_pk_bf16_f32 v91, v94, v95
v_pk_max_i16 v88, v88, s66
v_pk_max_i16 v89, v89, s66
v_pk_max_i16 v90, v90, s66
v_pk_max_i16 v91, v91, s66
buffer_store_dwordx4 v[88:91], v10, s[4:7], s76 offen sc1
s_branch L_s1_tail
L_s1_V0:
ds_read_b128 v[96:99], v3 offset:0
ds_read_b128 v[100:103], v3 offset:16384
ds_read_b128 v[104:107], v3 offset:1024
ds_read_b128 v[108:111], v3 offset:17408
s_waitcnt lgkmcnt(2)
v_mfma_f32_16x16x32_bf16 v[64:67], v[96:99], a[0:3], 0
ds_read_b128 v[112:115], v3 offset:2048
ds_read_b128 v[116:119], v3 offset:18432
v_mfma_f32_16x16x32_bf16 v[68:71], v[96:99], a[64:67], 0
s_add_u32 s62, s62, s63
v_mfma_f32_16x16x32_bf16 v[72:75], v[96:99], a[128:131], 0
s_add_u32 s74, s62, s64
v_mfma_f32_16x16x32_bf16 v[76:79], v[96:99], a[192:195], 0
s_add_u32 s75, s62, s65
v_mfma_f32_16x16x32_bf16 v[80:83], v[100:103], a[0:3], 0
s_add_u32 s76, s74, s65
v_mfma_f32_16x16x32_bf16 v[84:87], v[100:103], a[64:67], 0
v_mfma_f32_16x16x32_bf16 v[88:91], v[100:103], a[128:131], 0
v_mfma_f32_16x16x32_bf16 v[92:95], v[100:103], a[192:195], 0
s_waitcnt lgkmcnt(2)
v_mfma_f32_16x16x32_bf16 v[64:67], v[104:107], a[4:7], v[64:67]
ds_read_b128 v[96:99], v3 offset:3072
ds_read_b128 v[100:103], v3 offset:19456
v_mfma_f32_16x16x32_bf16 v[68:71], v[104:107], a[68:71], v[68:71]
v_cvt_pk_bf16_f32 v128, v128, v129
v_mfma_f32_16x16x32_bf16 v[72:75], v[104:107], a[132:135], v[72:75]
v_cvt_pk_bf16_f32 v129, v130, v131
v_mfma_f32_16x16x32_bf16 v[76:79], v[104:107], a[196:199], v[76:79]
v_cvt_pk_bf16_f32 v130, v144, v145
v_mfma_f32_16x16x32_bf16 v[80:83], v[108:111], a[4:7], v[80:83]
v_cvt_pk_bf16_f32 v131, v146, v147
v_mfma_f32_16x16x32_bf16 v[84:87], v[108:111], a[68:71], v[84:87]
buffer_store_dwordx4 v[128:131], v10, s[4:7], s62 offen sc1
v_mfma_f32_16x16x32_bf16 v[88:91], v[108:111], a[132:135], v[88:91]
v_mfma_f32_16x16x32_bf16 v[92:95], v[108:111], a[196:199], v[92:95]
s_waitcnt lgkmcnt(2)
v_mfma_f32_16x16x32_bf16 v[64:67], v[112:115], a[8:11], v[64:67]
ds_read_b128 v[104:107], v3 offset:4096
ds_read_b128 v[108:111], v3 offset:20480
v_mfma_f32_16x16x32_bf16 v[68:71], v[112:115], a[72:75], v[68:71]
v_cvt_pk_bf16_f32 v136, v136, v137
v_mfma_f32_16x16x32_bf16 v[72:75], v[112:115], a[136:139], v[72:75]
v_cvt_pk_bf16_f32 v137, v138, v139
v_mfma_f32_16x16x32_bf16 v[76:79], v[112:115], a[200:203], v[76:79]
v_cvt_pk_bf16_f32 v138, v152, v153
v_mfma_f32_16x16x32_bf16 v[80:83], v[116:119], a[8:11], v[80:83]
v_cvt_pk_bf16_f32 v139, v154, v155
v_mfma_f32_16x16x32_bf16 v[84:87], v[116:119], a[72:75], v[84:87]
buffer_store_dwordx4 v[136:139], v10, s[4:7], s75 offen sc1
v_mfma_f32_16x16x32_bf16 v[88:91], v[116:119], a[136:139], v[88:91]
v_mfma_f32_16x16x32_bf16 v[92:95], v[116:119], a[200:203], v[92:95]
s_waitcnt lgkmcnt(2)
v_mfma_f32_16x16x32_bf16 v[64:67], v[96:99], a[12:15], v[64:67]
ds_read_b128 v[112:115], v3 offset:5120
ds_read_b128 v[116:119], v3 offset:21504
v_mfma_f32_16x16x32_bf16 v[68:71], v[96:99], a[76:79], v[68:71]
v_cvt_pk_bf16_f32 v132, v132, v133
v_mfma_f32_16x16x32_bf16 v[72:75], v[96:99], a[140:143], v[72:75]
v_cvt_pk_bf16_f32 v133, v134, v135
v_mfma_f32_16x16x32_bf16 v[76:79], v[96:99], a[204:207], v[76:79]
v_cvt_pk_bf16_f32 v134, v148, v149
v_mfma_f32_16x16x32_bf16 v[80:83], v[100:103], a[12:15], v[80:83]
v_cvt_pk_bf16_f32 v135, v150, v151
v_mfma_f32_16x16x32_bf16 v[84:87], v[100:103], a[76:79], v[84:87]
buffer_store_dwordx4 v[132:135], v10, s[4:7], s74 offen sc1
v_mfma_f32_16x16x32_bf16 v[88:91], v[100:103], a[140:143], v[88:91]
v_mfma_f32_16x16x32_bf16 v[92:95], v[100:103], a[204:207], v[92:95]
s_waitcnt lgkmcnt(2)
v_mfma_f32_16x16x32_bf16 v[64:67], v[104:107], a[16:19], v[64:67]
ds_read_b128 v[96:99], v3 offset:6144
ds_read_b128 v[100:103], v3 offset:22528
v_mfma_f32_16x16x32_bf16 v[68:71], v[104:107], a[80:83], v[68:71]
v_cvt_pk_bf16_f32 v140, v140, v141
v_mfma_f32_16x16x32_bf16 v[72:75], v[104:107], a[144:147], v[72:75]
v_cvt_pk_bf16_f32 v141, v142, v143
v_mfma_f32_16x16x32_bf16 v[76:79], v[104:107], a[208:211], v[76:79]
v_cvt_pk_bf16_f32 v142, v156, v157
v_mfma_f32_16x16x32_bf16 v[80:83], v[108:111], a[16:19], v[80:83]
v_cvt_pk_bf16_f32 v143, v158, v159
v_mfma_f32_16x16x32_bf16 v[84:87], v[108:111], a[80:83], v[84:87]
buffer_store_dwordx4 v[140:143], v10, s[4:7], s76 offen sc1
v_mfma_f32_16x16x32_bf16 v[88:91], v[108:111], a[144:147], v[88:91]
v_mfma_f32_16x16x32_bf16 v[92:95], v[108:111], a[208:211], v[92:95]
s_waitcnt lgkmcnt(2)
v_mfma_f32_16x16x32_bf16 v[64:67], v[112:115], a[20:23], v[64:67]
ds_read_b128 v[104:107], v3 offset:7168
ds_read_b128 v[108:111], v3 offset:23552
v_mfma_f32_16x16x32_bf16 v[68:71], v[112:115], a[84:87], v[68:71]
v_mfma_f32_16x16x32_bf16 v[72:75], v[112:115], a[148:151], v[72:75]
v_mfma_f32_16x16x32_bf16 v[76:79], v[112:115], a[212:215], v[76:79]
v_mfma_f32_16x16x32_bf16 v[80:83], v[116:119], a[20:23], v[80:83]
v_mfma_f32_16x16x32_bf16 v[84:87], v[116:119], a[84:87], v[84:87]
v_mfma_f32_16x16x32_bf16 v[88:91], v[116:119], a[148:151], v[88:91]
v_mfma_f32_16x16x32_bf16 v[92:95], v[116:119], a[212:215], v[92:95]
s_waitcnt lgkmcnt(2)
v_mfma_f32_16x16x32_bf16 v[64:67], v[96:99], a[24:27], v[64:67]
ds_read_b128 v[112:115], v3 offset:8192
ds_read_b128 v[116:119], v3 offset:24576
v_mfma_f32_16x16x32_bf16 v[68:71], v[96:99], a[88:91], v[68:71]
v_mfma_f32_16x16x32_bf16 v[72:75], v[96:99], a[152:155], v[72:75]
v_mfma_f32_16x16x32_bf16 v[76:79], v[96:99], a[216:219], v[76:79]
v_mfma_f32_16x16x32_bf16 v[80:83], v[100:103], a[24:27], v[80:83]
v_mfma_f32_16x16x32_bf16 v[84:87], v[100:103], a[88:91], v[84:87]
v_mfma_f32_16x16x32_bf16 v[88:91], v[100:103], a[152:155], v[88:91]
v_mfma_f32_16x16x32_bf16 v[92:95], v[100:103], a[216:219], v[92:95]
s_waitcnt lgkmcnt(2)
v_mfma_f32_16x16x32_bf16 v[64:67], v[104:107], a[28:31], v[64:67]
ds_read_b128 v[96:99], v3 offset:9216
ds_read_b128 v[100:103], v3 offset:25600
v_mfma_f32_16x16x32_bf16 v[68:71], v[104:107], a[92:95], v[68:71]
s_waitcnt vmcnt(5)
v_mfma_f32_16x16x32_bf16 v[72:75], v[104:107], a[156:159], v[72:75]
ds_write_b128 v5, v[32:35] offset:32768
v_mfma_f32_16x16x32_bf16 v[76:79], v[104:107], a[220:223], v[76:79]
ds_write_b128 v5, v[36:39] offset:33792
v_mfma_f32_16x16x32_bf16 v[80:83], v[108:111], a[28:31], v[80:83]
v_mfma_f32_16x16x32_bf16 v[84:87], v[108:111], a[92:95], v[84:87]
v_mfma_f32_16x16x32_bf16 v[88:91], v[108:111], a[156:159], v[88:91]
v_mfma_f32_16x16x32_bf16 v[92:95], v[108:111], a[220:223], v[92:95]
s_waitcnt lgkmcnt(4)
v_mfma_f32_16x16x32_bf16 v[64:67], v[112:115], a[32:35], v[64:67]
ds_read_b128 v[104:107], v3 offset:10240
ds_read_b128 v[108:111], v3 offset:26624
v_mfma_f32_16x16x32_bf16 v[68:71], v[112:115], a[96:99], v[68:71]
ds_write_b128 v5, v[40:43] offset:34816
v_mfma_f32_16x16x32_bf16 v[72:75], v[112:115], a[160:163], v[72:75]
ds_write_b128 v5, v[44:47] offset:35840
v_mfma_f32_16x16x32_bf16 v[76:79], v[112:115], a[224:227], v[76:79]
v_mfma_f32_16x16x32_bf16 v[80:83], v[116:119], a[32:35], v[80:83]
v_mfma_f32_16x16x32_bf16 v[84:87], v[116:119], a[96:99], v[84:87]
v_mfma_f32_16x16x32_bf16 v[88:91], v[116:119], a[160:163], v[88:91]
v_mfma_f32_16x16x32_bf16 v[92:95], v[116:119], a[224:227], v[92:95]
s_waitcnt lgkmcnt(6)
v_mfma_f32_16x16x32_bf16 v[64:67], v[96:99], a[36:39], v[64:67]
ds_read_b128 v[112:115], v3 offset:11264
ds_read_b128 v[116:119], v3 offset:27648
v_mfma_f32_16x16x32_bf16 v[68:71], v[96:99], a[100:103], v[68:71]
ds_write_b128 v5, v[48:51] offset:36864
v_mfma_f32_16x16x32_bf16 v[72:75], v[96:99], a[164:167], v[72:75]
ds_write_b128 v5, v[52:55] offset:37888
v_mfma_f32_16x16x32_bf16 v[76:79], v[96:99], a[228:231], v[76:79]
v_mfma_f32_16x16x32_bf16 v[80:83], v[100:103], a[36:39], v[80:83]
v_mfma_f32_16x16x32_bf16 v[84:87], v[100:103], a[100:103], v[84:87]
v_mfma_f32_16x16x32_bf16 v[88:91], v[100:103], a[164:167], v[88:91]
v_mfma_f32_16x16x32_bf16 v[92:95], v[100:103], a[228:231], v[92:95]
s_waitcnt lgkmcnt(6)
v_mfma_f32_16x16x32_bf16 v[64:67], v[104:107], a[40:43], v[64:67]
ds_read_b128 v[96:99], v3 offset:12288
ds_read_b128 v[100:103], v3 offset:28672
v_mfma_f32_16x16x32_bf16 v[68:71], v[104:107], a[104:107], v[68:71]
ds_write_b128 v5, v[56:59] offset:38912
v_mfma_f32_16x16x32_bf16 v[72:75], v[104:107], a[168:171], v[72:75]
ds_write_b128 v5, v[60:63] offset:39936
v_mfma_f32_16x16x32_bf16 v[76:79], v[104:107], a[232:235], v[76:79]
v_mfma_f32_16x16x32_bf16 v[80:83], v[108:111], a[40:43], v[80:83]
v_mfma_f32_16x16x32_bf16 v[84:87], v[108:111], a[104:107], v[84:87]
v_mfma_f32_16x16x32_bf16 v[88:91], v[108:111], a[168:171], v[88:91]
v_mfma_f32_16x16x32_bf16 v[92:95], v[108:111], a[232:235], v[92:95]
s_waitcnt lgkmcnt(6)
v_mfma_f32_16x16x32_bf16 v[64:67], v[112:115], a[44:47], v[64:67]
ds_read_b128 v[104:107], v3 offset:13312
ds_read_b128 v[108:111], v3 offset:29696
v_mfma_f32_16x16x32_bf16 v[68:71], v[112:115], a[108:111], v[68:71]
s_add_u32 s56, s72, 2
v_mfma_f32_16x16x32_bf16 v[72:75], v[112:115], a[172:175], v[72:75]
s_cmp_lt_u32 s56, s73
v_mfma_f32_16x16x32_bf16 v[76:79], v[112:115], a[236:239], v[76:79]
s_cselect_b32 s56, 0, 0x7ff00000
v_mfma_f32_16x16x32_bf16 v[80:83], v[116:119], a[44:47], v[80:83]
v_or_b32 v11, s56, v5
v_mfma_f32_16x16x32_bf16 v[84:87], v[116:119], a[108:111], v[84:87]
v_mov_b32 v10, v3
v_mfma_f32_16x16x32_bf16 v[88:91], v[116:119], a[172:175], v[88:91]
v_mfma_f32_16x16x32_bf16 v[92:95], v[116:119], a[236:239], v[92:95]
s_waitcnt lgkmcnt(4)
v_mfma_f32_16x16x32_bf16 v[64:67], v[96:99], a[48:51], v[64:67]
ds_read_b128 v[112:115], v3 offset:14336
ds_read_b128 v[116:119], v3 offset:30720
v_mfma_f32_16x16x32_bf16 v[68:71], v[96:99], a[112:115], v[68:71]
s_waitcnt lgkmcnt(4)
buffer_load_dwordx4 v[32:35], v11, s[4:7], s67 offen offset:0 sc1
v_mfma_f32_16x16x32_bf16 v[72:75], v[96:99], a[176:179], v[72:75]
buffer_load_dwordx4 v[36:39], v11, s[4:7], s67 offen offset:1024 sc1
v_mfma_f32_16x16x32_bf16 v[76:79], v[96:99], a[240:243], v[76:79]
buffer_load_dwordx4 v[40:43], v11, s[4:7], s67 offen offset:2048 sc1
v_mfma_f32_16x16x32_bf16 v[80:83], v[100:103], a[48:51], v[80:83]
v_mfma_f32_16x16x32_bf16 v[84:87], v[100:103], a[112:115], v[84:87]
v_mfma_f32_16x16x32_bf16 v[88:91], v[100:103], a[176:179], v[88:91]
v_mfma_f32_16x16x32_bf16 v[92:95], v[100:103], a[240:243], v[92:95]
s_waitcnt lgkmcnt(2)
v_mfma_f32_16x16x32_bf16 v[64:67], v[104:107], a[52:55], v[64:67]
ds_read_b128 v[96:99], v3 offset:15360
ds_read_b128 v[100:103], v3 offset:31744
v_mfma_f32_16x16x32_bf16 v[68:71], v[104:107], a[116:119], v[68:71]
buffer_load_dwordx4 v[44:47], v11, s[4:7], s67 offen offset:3072 sc1
v_mfma_f32_16x16x32_bf16 v[72:75], v[104:107], a[180:183], v[72:75]
buffer_load_dwordx4 v[48:51], v11, s[4:7], s77 offen offset:0 sc1
v_mfma_f32_16x16x32_bf16 v[76:79], v[104:107], a[244:247], v[76:79]
buffer_load_dwordx4 v[52:55], v11, s[4:7], s77 offen offset:1024 sc1
v_mfma_f32_16x16x32_bf16 v[80:83], v[108:111], a[52:55], v[80:83]
v_mfma_f32_16x16x32_bf16 v[84:87], v[108:111], a[116:119], v[84:87]
v_mfma_f32_16x16x32_bf16 v[88:91], v[108:111], a[180:183], v[88:91]
v_mfma_f32_16x16x32_bf16 v[92:95], v[108:111], a[244:247], v[92:95]
s_waitcnt lgkmcnt(2)
v_mfma_f32_16x16x32_bf16 v[64:67], v[112:115], a[56:59], v[64:67]
v_mfma_f32_16x16x32_bf16 v[68:71], v[112:115], a[120:123], v[68:71]
buffer_load_dwordx4 v[56:59], v11, s[4:7], s77 offen offset:2048 sc1
v_mfma_f32_16x16x32_bf16 v[72:75], v[112:115], a[184:187], v[72:75]
buffer_load_dwordx4 v[60:63], v11, s[4:7], s77 offen offset:3072 sc1
v_mfma_f32_16x16x32_bf16 v[76:79], v[112:115], a[248:251], v[76:79]
v_mfma_f32_16x16x32_bf16 v[80:83], v[116:119], a[56:59], v[80:83]
v_mfma_f32_16x16x32_bf16 v[84:87], v[116:119], a[120:123], v[84:87]
v_mfma_f32_16x16x32_bf16 v[88:91], v[116:119], a[184:187], v[88:91]
v_mfma_f32_16x16x32_bf16 v[92:95], v[116:119], a[248:251], v[92:95]
s_waitcnt lgkmcnt(0)
v_mfma_f32_16x16x32_bf16 v[64:67], v[96:99], a[60:63], v[64:67]
v_mfma_f32_16x16x32_bf16 v[68:71], v[96:99], a[124:127], v[68:71]
s_add_u32 s67, s67, s41
v_mfma_f32_16x16x32_bf16 v[72:75], v[96:99], a[188:191], v[72:75]
s_add_u32 s77, s67, 0x1000
v_mfma_f32_16x16x32_bf16 v[76:79], v[96:99], a[252:255], v[76:79]
v_mfma_f32_16x16x32_bf16 v[80:83], v[100:103], a[60:63], v[80:83]
v_mfma_f32_16x16x32_bf16 v[84:87], v[100:103], a[124:127], v[84:87]
v_mfma_f32_16x16x32_bf16 v[88:91], v[100:103], a[188:191], v[88:91]
v_mfma_f32_16x16x32_bf16 v[92:95], v[100:103], a[252:255], v[92:95]
s_mul_i32 s56, s72, s78
s_add_u32 s56, s56, s59
s_cmp_ge_u32 s72, 4
s_cbranch_scc1 L_s1nw_44
s_waitcnt vmcnt(8)
s_add_u32 s56, s56, s78
L_s1nw_44:
s_sub_u32 s56, s56, s78
v_mov_b32 v7, s56
s_add_u32 s72, s72, 1
s_cmp_lt_u32 s72, s73
s_waitcnt lgkmcnt(0)
s_barrier
s_mov_b64 exec, 1
buffer_store_dword v7, v9, s[4:7], s69 offen sc1
s_mov_b64 exec, -1
s_cbranch_scc0 L_s1_Ve0
L_s1_V1:
s_cmp_lg_u32 s72, 3
s_cbranch_scc1 L_s1_V_xn
s_mov_b32 s57, 0
L_wf_45:
buffer_load_dword v8, v12, s[4:7], s68 offen offset:0 sc1
s_add_u32 s57, s57, 1
s_cmp_ge_u32 s57, 524288
s_cbranch_scc1 L_end
s_waitcnt vmcnt(0)
v_cmp_ge_u32 vcc, 0, v8
s_cbranch_vccnz L_wf_45
L_s1_V_xn:
s_cmp_lg_u32 s72, 3
s_cbranch_scc1 L_s1_V_go
s_lshr_b32 s58, s42, 4
s_lshl_b32 s58, s58, 7
v_mov_b32 v121, 0
s_mov_b32 s57, 0
L_wf_46:
buffer_load_dword v8, v121, s[4:7], s58 offen offset:2048 sc1
s_add_u32 s57, s57, 1
s_cmp_ge_u32 s57, 524288
s_cbranch_scc1 L_end
s_waitcnt vmcnt(0)
v_cmp_ge_u32 vcc, 0, v8
s_cbranch_vccz L_wfx_47
s_sleep 8
s_branch L_wf_46
L_wfx_47:
L_s1_V_go:
ds_read_b128 v[96:99], v3 offset:32768
ds_read_b128 v[100:103], v3 offset:49152
ds_read_b128 v[104:107], v3 offset:33792
ds_read_b128 v[108:111], v3 offset:50176
s_waitcnt lgkmcnt(2)
v_mfma_f32_16x16x32_bf16 v[128:131], v[96:99], a[0:3], 0
ds_read_b128 v[112:115], v3 offset:34816
ds_read_b128 v[116:119], v3 offset:51200
v_mfma_f32_16x16x32_bf16 v[132:135], v[96:99], a[64:67], 0
s_add_u32 s62, s62, s63
v_mfma_f32_16x16x32_bf16 v[136:139], v[96:99], a[128:131], 0
s_add_u32 s74, s62, s64
v_mfma_f32_16x16x32_bf16 v[140:143], v[96:99], a[192:195], 0
s_add_u32 s75, s62, s65
v_mfma_f32_16x16x32_bf16 v[144:147], v[100:103], a[0:3], 0
s_add_u32 s76, s74, s65
v_mfma_f32_16x16x32_bf16 v[148:151], v[100:103], a[64:67], 0
v_mfma_f32_16x16x32_bf16 v[152:155], v[100:103], a[128:131], 0
v_mfma_f32_16x16x32_bf16 v[156:159], v[100:103], a[192:195], 0
s_waitcnt lgkmcnt(2)
v_mfma_f32_16x16x32_bf16 v[128:131], v[104:107], a[4:7], v[128:131]
ds_read_b128 v[96:99], v3 offset:35840
ds_read_b128 v[100:103], v3 offset:52224
v_mfma_f32_16x16x32_bf16 v[132:135], v[104:107], a[68:71], v[132:135]
v_cvt_pk_bf16_f32 v64, v64, v65
v_mfma_f32_16x16x32_bf16 v[136:139], v[104:107], a[132:135], v[136:139]
v_cvt_pk_bf16_f32 v65, v66, v67
v_mfma_f32_16x16x32_bf16 v[140:143], v[104:107], a[196:199], v[140:143]
v_cvt_pk_bf16_f32 v66, v80, v81
v_mfma_f32_16x16x32_bf16 v[144:147], v[108:111], a[4:7], v[144:147]
v_cvt_pk_bf16_f32 v67, v82, v83
v_mfma_f32_16x16x32_bf16 v[148:151], v[108:111], a[68:71], v[148:151]
buffer_store_dwordx4 v[64:67], v10, s[4:7], s62 offen sc1
v_mfma_f32_16x16x32_bf16 v[152:155], v[108:111], a[132:135], v[152:155]
v_mfma_f32_16x16x32_bf16 v[156:159], v[108:111], a[196:199], v[156:159]
s_waitcnt lgkmcnt(2)
v_mfma_f32_16x16x32_bf16 v[128:131], v[112:115], a[8:11], v[128:131]
ds_read_b128 v[104:107], v3 offset:36864
ds_read_b128 v[108:111], v3 offset:53248
v_mfma_f32_16x16x32_bf16 v[132:135], v[112:115], a[72:75], v[132:135]
v_cvt_pk_bf16_f32 v72, v72, v73
v_mfma_f32_16x16x32_bf16 v[136:139], v[112:115], a[136:139], v[136:139]
v_cvt_pk_bf16_f32 v73, v74, v75
v_mfma_f32_16x16x32_bf16 v[140:143], v[112:115], a[200:203], v[140:143]
v_cvt_pk_bf16_f32 v74, v88, v89
v_mfma_f32_16x16x32_bf16 v[144:147], v[116:119], a[8:11], v[144:147]
v_cvt_pk_bf16_f32 v75, v90, v91
v_mfma_f32_16x16x32_bf16 v[148:151], v[116:119], a[72:75], v[148:151]
buffer_store_dwordx4 v[72:75], v10, s[4:7], s75 offen sc1
v_mfma_f32_16x16x32_bf16 v[152:155], v[116:119], a[136:139], v[152:155]
v_mfma_f32_16x16x32_bf16 v[156:159], v[116:119], a[200:203], v[156:159]
s_waitcnt lgkmcnt(2)
v_mfma_f32_16x16x32_bf16 v[128:131], v[96:99], a[12:15], v[128:131]
ds_read_b128 v[112:115], v3 offset:37888
ds_read_b128 v[116:119], v3 offset:54272
v_mfma_f32_16x16x32_bf16 v[132:135], v[96:99], a[76:79], v[132:135]
v_cvt_pk_bf16_f32 v68, v68, v69
v_mfma_f32_16x16x32_bf16 v[136:139], v[96:99], a[140:143], v[136:139]
v_cvt_pk_bf16_f32 v69, v70, v71
v_mfma_f32_16x16x32_bf16 v[140:143], v[96:99], a[204:207], v[140:143]
v_cvt_pk_bf16_f32 v70, v84, v85
v_mfma_f32_16x16x32_bf16 v[144:147], v[100:103], a[12:15], v[144:147]
v_cvt_pk_bf16_f32 v71, v86, v87
v_mfma_f32_16x16x32_bf16 v[148:151], v[100:103], a[76:79], v[148:151]
buffer_store_dwordx4 v[68:71], v10, s[4:7], s74 offen sc1
v_mfma_f32_16x16x32_bf16 v[152:155], v[100:103], a[140:143], v[152:155]
v_mfma_f32_16x16x32_bf16 v[156:159], v[100:103], a[204:207], v[156:159]
s_waitcnt lgkmcnt(2)
v_mfma_f32_16x16x32_bf16 v[128:131], v[104:107], a[16:19], v[128:131]
ds_read_b128 v[96:99], v3 offset:38912
ds_read_b128 v[100:103], v3 offset:55296
v_mfma_f32_16x16x32_bf16 v[132:135], v[104:107], a[80:83], v[132:135]
v_cvt_pk_bf16_f32 v76, v76, v77
v_mfma_f32_16x16x32_bf16 v[136:139], v[104:107], a[144:147], v[136:139]
v_cvt_pk_bf16_f32 v77, v78, v79
v_mfma_f32_16x16x32_bf16 v[140:143], v[104:107], a[208:211], v[140:143]
v_cvt_pk_bf16_f32 v78, v92, v93
v_mfma_f32_16x16x32_bf16 v[144:147], v[108:111], a[16:19], v[144:147]
v_cvt_pk_bf16_f32 v79, v94, v95
v_mfma_f32_16x16x32_bf16 v[148:151], v[108:111], a[80:83], v[148:151]
buffer_store_dwordx4 v[76:79], v10, s[4:7], s76 offen sc1
v_mfma_f32_16x16x32_bf16 v[152:155], v[108:111], a[144:147], v[152:155]
v_mfma_f32_16x16x32_bf16 v[156:159], v[108:111], a[208:211], v[156:159]
s_waitcnt lgkmcnt(2)
v_mfma_f32_16x16x32_bf16 v[128:131], v[112:115], a[20:23], v[128:131]
ds_read_b128 v[104:107], v3 offset:39936
ds_read_b128 v[108:111], v3 offset:56320
v_mfma_f32_16x16x32_bf16 v[132:135], v[112:115], a[84:87], v[132:135]
v_mfma_f32_16x16x32_bf16 v[136:139], v[112:115], a[148:151], v[136:139]
v_mfma_f32_16x16x32_bf16 v[140:143], v[112:115], a[212:215], v[140:143]
v_mfma_f32_16x16x32_bf16 v[144:147], v[116:119], a[20:23], v[144:147]
v_mfma_f32_16x16x32_bf16 v[148:151], v[116:119], a[84:87], v[148:151]
v_mfma_f32_16x16x32_bf16 v[152:155], v[116:119], a[148:151], v[152:155]
v_mfma_f32_16x16x32_bf16 v[156:159], v[116:119], a[212:215], v[156:159]
s_waitcnt lgkmcnt(2)
v_mfma_f32_16x16x32_bf16 v[128:131], v[96:99], a[24:27], v[128:131]
ds_read_b128 v[112:115], v3 offset:40960
ds_read_b128 v[116:119], v3 offset:57344
v_mfma_f32_16x16x32_bf16 v[132:135], v[96:99], a[88:91], v[132:135]
v_mfma_f32_16x16x32_bf16 v[136:139], v[96:99], a[152:155], v[136:139]
v_mfma_f32_16x16x32_bf16 v[140:143], v[96:99], a[216:219], v[140:143]
v_mfma_f32_16x16x32_bf16 v[144:147], v[100:103], a[24:27], v[144:147]
v_mfma_f32_16x16x32_bf16 v[148:151], v[100:103], a[88:91], v[148:151]
v_mfma_f32_16x16x32_bf16 v[152:155], v[100:103], a[152:155], v[152:155]
v_mfma_f32_16x16x32_bf16 v[156:159], v[100:103], a[216:219], v[156:159]
s_waitcnt lgkmcnt(2)
v_mfma_f32_16x16x32_bf16 v[128:131], v[104:107], a[28:31], v[128:131]
ds_read_b128 v[96:99], v3 offset:41984
ds_read_b128 v[100:103], v3 offset:58368
v_mfma_f32_16x16x32_bf16 v[132:135], v[104:107], a[92:95], v[132:135]
s_waitcnt vmcnt(5)
v_mfma_f32_16x16x32_bf16 v[136:139], v[104:107], a[156:159], v[136:139]
ds_write_b128 v5, v[32:35] offset:0
v_mfma_f32_16x16x32_bf16 v[140:143], v[104:107], a[220:223], v[140:143]
ds_write_b128 v5, v[36:39] offset:1024
v_mfma_f32_16x16x32_bf16 v[144:147], v[108:111], a[28:31], v[144:147]
v_mfma_f32_16x16x32_bf16 v[148:151], v[108:111], a[92:95], v[148:151]
v_mfma_f32_16x16x32_bf16 v[152:155], v[108:111], a[156:159], v[152:155]
v_mfma_f32_16x16x32_bf16 v[156:159], v[108:111], a[220:223], v[156:159]
s_waitcnt lgkmcnt(4)
v_mfma_f32_16x16x32_bf16 v[128:131], v[112:115], a[32:35], v[128:131]
ds_read_b128 v[104:107], v3 offset:43008
ds_read_b128 v[108:111], v3 offset:59392
v_mfma_f32_16x16x32_bf16 v[132:135], v[112:115], a[96:99], v[132:135]
ds_write_b128 v5, v[40:43] offset:2048
v_mfma_f32_16x16x32_bf16 v[136:139], v[112:115], a[160:163], v[136:139]
ds_write_b128 v5, v[44:47] offset:3072
v_mfma_f32_16x16x32_bf16 v[140:143], v[112:115], a[224:227], v[140:143]
v_mfma_f32_16x16x32_bf16 v[144:147], v[116:119], a[32:35], v[144:147]
v_mfma_f32_16x16x32_bf16 v[148:151], v[116:119], a[96:99], v[148:151]
v_mfma_f32_16x16x32_bf16 v[152:155], v[116:119], a[160:163], v[152:155]
v_mfma_f32_16x16x32_bf16 v[156:159], v[116:119], a[224:227], v[156:159]
s_waitcnt lgkmcnt(6)
v_mfma_f32_16x16x32_bf16 v[128:131], v[96:99], a[36:39], v[128:131]
ds_read_b128 v[112:115], v3 offset:44032
ds_read_b128 v[116:119], v3 offset:60416
v_mfma_f32_16x16x32_bf16 v[132:135], v[96:99], a[100:103], v[132:135]
ds_write_b128 v5, v[48:51] offset:4096
v_mfma_f32_16x16x32_bf16 v[136:139], v[96:99], a[164:167], v[136:139]
ds_write_b128 v5, v[52:55] offset:5120
v_mfma_f32_16x16x32_bf16 v[140:143], v[96:99], a[228:231], v[140:143]
v_mfma_f32_16x16x32_bf16 v[144:147], v[100:103], a[36:39], v[144:147]
v_mfma_f32_16x16x32_bf16 v[148:151], v[100:103], a[100:103], v[148:151]
v_mfma_f32_16x16x32_bf16 v[152:155], v[100:103], a[164:167], v[152:155]
v_mfma_f32_16x16x32_bf16 v[156:159], v[100:103], a[228:231], v[156:159]
s_waitcnt lgkmcnt(6)
v_mfma_f32_16x16x32_bf16 v[128:131], v[104:107], a[40:43], v[128:131]
ds_read_b128 v[96:99], v3 offset:45056
ds_read_b128 v[100:103], v3 offset:61440
v_mfma_f32_16x16x32_bf16 v[132:135], v[104:107], a[104:107], v[132:135]
ds_write_b128 v5, v[56:59] offset:6144
v_mfma_f32_16x16x32_bf16 v[136:139], v[104:107], a[168:171], v[136:139]
ds_write_b128 v5, v[60:63] offset:7168
v_mfma_f32_16x16x32_bf16 v[140:143], v[104:107], a[232:235], v[140:143]
v_mfma_f32_16x16x32_bf16 v[144:147], v[108:111], a[40:43], v[144:147]
v_mfma_f32_16x16x32_bf16 v[148:151], v[108:111], a[104:107], v[148:151]
v_mfma_f32_16x16x32_bf16 v[152:155], v[108:111], a[168:171], v[152:155]
v_mfma_f32_16x16x32_bf16 v[156:159], v[108:111], a[232:235], v[156:159]
s_waitcnt lgkmcnt(6)
v_mfma_f32_16x16x32_bf16 v[128:131], v[112:115], a[44:47], v[128:131]
ds_read_b128 v[104:107], v3 offset:46080
ds_read_b128 v[108:111], v3 offset:62464
v_mfma_f32_16x16x32_bf16 v[132:135], v[112:115], a[108:111], v[132:135]
s_add_u32 s56, s72, 2
v_mfma_f32_16x16x32_bf16 v[136:139], v[112:115], a[172:175], v[136:139]
s_cmp_lt_u32 s56, s73
v_mfma_f32_16x16x32_bf16 v[140:143], v[112:115], a[236:239], v[140:143]
s_cselect_b32 s56, 0, 0x7ff00000
v_mfma_f32_16x16x32_bf16 v[144:147], v[116:119], a[44:47], v[144:147]
v_or_b32 v11, s56, v5
v_mfma_f32_16x16x32_bf16 v[148:151], v[116:119], a[108:111], v[148:151]
v_mov_b32 v10, v3
v_mfma_f32_16x16x32_bf16 v[152:155], v[116:119], a[172:175], v[152:155]
v_mfma_f32_16x16x32_bf16 v[156:159], v[116:119], a[236:239], v[156:159]
s_waitcnt lgkmcnt(4)
v_mfma_f32_16x16x32_bf16 v[128:131], v[96:99], a[48:51], v[128:131]
ds_read_b128 v[112:115], v3 offset:47104
ds_read_b128 v[116:119], v3 offset:63488
v_mfma_f32_16x16x32_bf16 v[132:135], v[96:99], a[112:115], v[132:135]
s_waitcnt lgkmcnt(4)
buffer_load_dwordx4 v[32:35], v11, s[4:7], s67 offen offset:0 sc1
v_mfma_f32_16x16x32_bf16 v[136:139], v[96:99], a[176:179], v[136:139]
buffer_load_dwordx4 v[36:39], v11, s[4:7], s67 offen offset:1024 sc1
v_mfma_f32_16x16x32_bf16 v[140:143], v[96:99], a[240:243], v[140:143]
buffer_load_dwordx4 v[40:43], v11, s[4:7], s67 offen offset:2048 sc1
v_mfma_f32_16x16x32_bf16 v[144:147], v[100:103], a[48:51], v[144:147]
v_mfma_f32_16x16x32_bf16 v[148:151], v[100:103], a[112:115], v[148:151]
v_mfma_f32_16x16x32_bf16 v[152:155], v[100:103], a[176:179], v[152:155]
v_mfma_f32_16x16x32_bf16 v[156:159], v[100:103], a[240:243], v[156:159]
s_waitcnt lgkmcnt(2)
v_mfma_f32_16x16x32_bf16 v[128:131], v[104:107], a[52:55], v[128:131]
ds_read_b128 v[96:99], v3 offset:48128
ds_read_b128 v[100:103], v3 offset:64512
v_mfma_f32_16x16x32_bf16 v[132:135], v[104:107], a[116:119], v[132:135]
buffer_load_dwordx4 v[44:47], v11, s[4:7], s67 offen offset:3072 sc1
v_mfma_f32_16x16x32_bf16 v[136:139], v[104:107], a[180:183], v[136:139]
buffer_load_dwordx4 v[48:51], v11, s[4:7], s77 offen offset:0 sc1
v_mfma_f32_16x16x32_bf16 v[140:143], v[104:107], a[244:247], v[140:143]
buffer_load_dwordx4 v[52:55], v11, s[4:7], s77 offen offset:1024 sc1
v_mfma_f32_16x16x32_bf16 v[144:147], v[108:111], a[52:55], v[144:147]
v_mfma_f32_16x16x32_bf16 v[148:151], v[108:111], a[116:119], v[148:151]
v_mfma_f32_16x16x32_bf16 v[152:155], v[108:111], a[180:183], v[152:155]
v_mfma_f32_16x16x32_bf16 v[156:159], v[108:111], a[244:247], v[156:159]
s_waitcnt lgkmcnt(2)
v_mfma_f32_16x16x32_bf16 v[128:131], v[112:115], a[56:59], v[128:131]
v_mfma_f32_16x16x32_bf16 v[132:135], v[112:115], a[120:123], v[132:135]
buffer_load_dwordx4 v[56:59], v11, s[4:7], s77 offen offset:2048 sc1
v_mfma_f32_16x16x32_bf16 v[136:139], v[112:115], a[184:187], v[136:139]
buffer_load_dwordx4 v[60:63], v11, s[4:7], s77 offen offset:3072 sc1
v_mfma_f32_16x16x32_bf16 v[140:143], v[112:115], a[248:251], v[140:143]
v_mfma_f32_16x16x32_bf16 v[144:147], v[116:119], a[56:59], v[144:147]
v_mfma_f32_16x16x32_bf16 v[148:151], v[116:119], a[120:123], v[148:151]
v_mfma_f32_16x16x32_bf16 v[152:155], v[116:119], a[184:187], v[152:155]
v_mfma_f32_16x16x32_bf16 v[156:159], v[116:119], a[248:251], v[156:159]
s_waitcnt lgkmcnt(0)
v_mfma_f32_16x16x32_bf16 v[128:131], v[96:99], a[60:63], v[128:131]
v_mfma_f32_16x16x32_bf16 v[132:135], v[96:99], a[124:127], v[132:135]
s_add_u32 s67, s67, s41
v_mfma_f32_16x16x32_bf16 v[136:139], v[96:99], a[188:191], v[136:139]
s_add_u32 s77, s67, 0x1000
v_mfma_f32_16x16x32_bf16 v[140:143], v[96:99], a[252:255], v[140:143]
v_mfma_f32_16x16x32_bf16 v[144:147], v[100:103], a[60:63], v[144:147]
v_mfma_f32_16x16x32_bf16 v[148:151], v[100:103], a[124:127], v[148:151]
v_mfma_f32_16x16x32_bf16 v[152:155], v[100:103], a[188:191], v[152:155]
v_mfma_f32_16x16x32_bf16 v[156:159], v[100:103], a[252:255], v[156:159]
s_mul_i32 s56, s72, s78
s_add_u32 s56, s56, s59
s_cmp_ge_u32 s72, 4
s_cbranch_scc1 L_s1nw_48
s_waitcnt vmcnt(8)
s_add_u32 s56, s56, s78
L_s1nw_48:
s_sub_u32 s56, s56, s78
v_mov_b32 v7, s56
s_add_u32 s72, s72, 1
s_cmp_lt_u32 s72, s73
s_waitcnt lgkmcnt(0)
s_barrier
s_mov_b64 exec, 1
buffer_store_dword v7, v9, s[4:7], s69 offen sc1
s_mov_b64 exec, -1
s_cbranch_scc1 L_s1_V0
s_add_u32 s62, s62, s63
s_add_u32 s74, s62, s64
s_add_u32 s75, s62, s65
s_add_u32 s76, s74, s65
v_cvt_pk_bf16_f32 v128, v128, v129
v_cvt_pk_bf16_f32 v129, v130, v131
v_cvt_pk_bf16_f32 v130, v144, v145
v_cvt_pk_bf16_f32 v131, v146, v147
buffer_store_dwordx4 v[128:131], v10, s[4:7], s62 offen sc1
v_cvt_pk_bf16_f32 v136, v136, v137
v_cvt_pk_bf16_f32 v137, v138, v139
v_cvt_pk_bf16_f32 v138, v152, v153
v_cvt_pk_bf16_f32 v139, v154, v155
buffer_store_dwordx4 v[136:139], v10, s[4:7], s75 offen sc1
v_cvt_pk_bf16_f32 v132, v132, v133
v_cvt_pk_bf16_f32 v133, v134, v135
v_cvt_pk_bf16_f32 v134, v148, v149
v_cvt_pk_bf16_f32 v135, v150, v151
buffer_store_dwordx4 v[132:135], v10, s[4:7], s74 offen sc1
v_cvt_pk_bf16_f32 v140, v140, v141
v_cvt_pk_bf16_f32 v141, v142, v143
v_cvt_pk_bf16_f32 v142, v156, v157
v_cvt_pk_bf16_f32 v143, v158, v159
buffer_store_dwordx4 v[140:143], v10, s[4:7], s76 offen sc1
s_branch L_s1_tail
L_s1_Ve0:
s_add_u32 s62, s62, s63
s_add_u32 s74, s62, s64
s_add_u32 s75, s62, s65
s_add_u32 s76, s74, s65
v_cvt_pk_bf16_f32 v64, v64, v65
v_cvt_pk_bf16_f32 v65, v66, v67
v_cvt_pk_bf16_f32 v66, v80, v81
v_cvt_pk_bf16_f32 v67, v82, v83
buffer_store_dwordx4 v[64:67], v10, s[4:7], s62 offen sc1
v_cvt_pk_bf16_f32 v72, v72, v73
v_cvt_pk_bf16_f32 v73, v74, v75
v_cvt_pk_bf16_f32 v74, v88, v89
v_cvt_pk_bf16_f32 v75, v90, v91
buffer_store_dwordx4 v[72:75], v10, s[4:7], s75 offen sc1
v_cvt_pk_bf16_f32 v68, v68, v69
v_cvt_pk_bf16_f32 v69, v70, v71
v_cvt_pk_bf16_f32 v70, v84, v85
v_cvt_pk_bf16_f32 v71, v86, v87
buffer_store_dwordx4 v[68:71], v10, s[4:7], s74 offen sc1
v_cvt_pk_bf16_f32 v76, v76, v77
v_cvt_pk_bf16_f32 v77, v78, v79
v_cvt_pk_bf16_f32 v78, v92, v93
v_cvt_pk_bf16_f32 v79, v94, v95
buffer_store_dwordx4 v[76:79], v10, s[4:7], s76 offen sc1
L_s1_tail:
s_mul_i32 s56, s73, s78
s_add_u32 s56, s56, s59
s_max_u32 s56, s56, 64
v_mov_b32 v7, s56
s_waitcnt vmcnt(0)
s_barrier
s_mov_b64 exec, 1
buffer_store_dword v7, v9, s[4:7], s69 offen sc1
s_mov_b64 exec, -1
s_branch L_s1_done
L_s1_none:
s_mov_b32 s57, 0
v_mov_b32 v8, 64
L_wd_49:
global_load_dword v9, v8, s[36:37] sc1
s_add_u32 s57, s57, 1
s_cmp_ge_u32 s57, 524288
s_cbranch_scc1 L_end
s_waitcnt vmcnt(0)
v_cmp_gt_u32 vcc, 12, v9
s_cbranch_vccnz L_wd_49
s_lshr_b32 s58, s42, 4
s_lshl_b32 s58, s58, 7
v_mov_b32 v121, 0
s_mov_b32 s57, 0
L_wf_50:
buffer_load_dword v8, v121, s[4:7], s58 offen offset:2048 sc1
s_add_u32 s57, s57, 1
s_cmp_ge_u32 s57, 524288
s_cbranch_scc1 L_end
s_waitcnt vmcnt(0)
v_cmp_ge_u32 vcc, 0, v8
s_cbranch_vccz L_wfx_51
s_sleep 8
s_branch L_wf_50
L_wfx_51:
s_and_b32 s56, s42, 31
s_cmp_lt_u32 s56, 30
s_cbranch_scc1 L_s1_done
s_lshr_b32 s58, s42, 5
s_lshl_b32 s58, s58, 1
s_add_u32 s59, s56, s58
s_sub_u32 s59, s59, 32
s_lshl_b32 s56, s59, 12
s_lshl_b32 s58, s38, 10
s_add_u32 s56, s56, s58
s_mul_i32 s56, s56, 32
s_add_u32 s56, s56, 0x6ec0000
v_mov_b32 v12, -1
v_mov_b32 v13, -1
v_mov_b32 v14, -1
v_mov_b32 v15, -1
buffer_store_dwordx4 v[12:15], v3, s[4:7], s56 offen offset:0 sc1
buffer_store_dwordx4 v[12:15], v3, s[4:7], s56 offen offset:1024 sc1
buffer_store_dwordx4 v[12:15], v3, s[4:7], s56 offen offset:2048 sc1
buffer_store_dwordx4 v[12:15], v3, s[4:7], s56 offen offset:3072 sc1
s_add_u32 s56, s56, 0x1000
buffer_store_dwordx4 v[12:15], v3, s[4:7], s56 offen offset:0 sc1
buffer_store_dwordx4 v[12:15], v3, s[4:7], s56 offen offset:1024 sc1
buffer_store_dwordx4 v[12:15], v3, s[4:7], s56 offen offset:2048 sc1
buffer_store_dwordx4 v[12:15], v3, s[4:7], s56 offen offset:3072 sc1
s_add_u32 s56, s56, 0x1000
buffer_store_dwordx4 v[12:15], v3, s[4:7], s56 offen offset:0 sc1
buffer_store_dwordx4 v[12:15], v3, s[4:7], s56 offen offset:1024 sc1
buffer_store_dwordx4 v[12:15], v3, s[4:7], s56 offen offset:2048 sc1
buffer_store_dwordx4 v[12:15], v3, s[4:7], s56 offen offset:3072 sc1
s_add_u32 s56, s56, 0x1000
buffer_store_dwordx4 v[12:15], v3, s[4:7], s56 offen offset:0 sc1
buffer_store_dwordx4 v[12:15], v3, s[4:7], s56 offen offset:1024 sc1
buffer_store_dwordx4 v[12:15], v3, s[4:7], s56 offen offset:2048 sc1
buffer_store_dwordx4 v[12:15], v3, s[4:7], s56 offen offset:3072 sc1
s_add_u32 s56, s56, 0x1000
buffer_store_dwordx4 v[12:15], v3, s[4:7], s56 offen offset:0 sc1
buffer_store_dwordx4 v[12:15], v3, s[4:7], s56 offen offset:1024 sc1
buffer_store_dwordx4 v[12:15], v3, s[4:7], s56 offen offset:2048 sc1
buffer_store_dwordx4 v[12:15], v3, s[4:7], s56 offen offset:3072 sc1
s_add_u32 s56, s56, 0x1000
buffer_store_dwordx4 v[12:15], v3, s[4:7], s56 offen offset:0 sc1
buffer_store_dwordx4 v[12:15], v3, s[4:7], s56 offen offset:1024 sc1
buffer_store_dwordx4 v[12:15], v3, s[4:7], s56 offen offset:2048 sc1
buffer_store_dwordx4 v[12:15], v3, s[4:7], s56 offen offset:3072 sc1
s_add_u32 s56, s56, 0x1000
buffer_store_dwordx4 v[12:15], v3, s[4:7], s56 offen offset:0 sc1
buffer_store_dwordx4 v[12:15], v3, s[4:7], s56 offen offset:1024 sc1
buffer_store_dwordx4 v[12:15], v3, s[4:7], s56 offen offset:2048 sc1
buffer_store_dwordx4 v[12:15], v3, s[4:7], s56 offen offset:3072 sc1
s_add_u32 s56, s56, 0x1000
buffer_store_dwordx4 v[12:15], v3, s[4:7], s56 offen offset:0 sc1
buffer_store_dwordx4 v[12:15], v3, s[4:7], s56 offen offset:1024 sc1
buffer_store_dwordx4 v[12:15], v3, s[4:7], s56 offen offset:2048 sc1
buffer_store_dwordx4 v[12:15], v3, s[4:7], s56 offen offset:3072 sc1
v_mov_b32 v8, 64
s_lshl_b32 s59, s59, 2
s_waitcnt vmcnt(0)
s_barrier
s_cmp_lg_u32 s38, 0
s_cbranch_scc1 L_s1_done
s_mov_b64 exec, 1
buffer_store_dword v8, off, s[4:7], s59 offset:1792 sc1
s_mov_b64 exec, -1
L_s1_done:
s_mov_b32 s20, s50
s_mov_b32 s21, s51
s_mov_b32 s22, 0x400000
s_mov_b32 s23, 0x20000
s_mov_b32 s24, s54
s_mov_b32 s25, s55
s_mov_b32 s26, 0x1c0000
s_mov_b32 s27, 0x20000
s_cmp_lt_u32 s42, 32
s_cbranch_scc1 L_nos2
s_lshr_b32 s60, s42, 4
s_sub_u32 s60, s60, 2
s_and_b32 s63, s42, 15
s_lshl_b32 s56, s63, 6
v_lshlrev_b32 v4, 13, v2
v_lshlrev_b32 v5, 2, v1
v_add3_u32 v4, v4, v5, s56
s_lshl_b32 s58, s38, 20
v_add_u32 v5, s58, v4
s_mul_i32 s58, s38, 458752
v_add_u32 v4, s58, v4
s_mov_b32 s56, 0x0
buffer_load_dword v32, v5, s[20:23], s56 offen offset:0
s_mov_b32 s56, 0x800
buffer_load_dword v33, v5, s[20:23], s56 offen offset:0
s_mov_b32 s56, 0x1000
buffer_load_dword v34, v5, s[20:23], s56 offen offset:0
s_mov_b32 s56, 0x1800
buffer_load_dword v35, v5, s[20:23], s56 offen offset:0
s_mov_b32 s56, 0x400
buffer_load_dword v36, v5, s[20:23], s56 offen offset:0
s_mov_b32 s56, 0xc00
buffer_load_dword v37, v5, s[20:23], s56 offen offset:0
s_mov_b32 s56, 0x1400
buffer_load_dword v38, v5, s[20:23], s56 offen offset:0
s_mov_b32 s56, 0x1c00
buffer_load_dword v39, v5, s[20:23], s56 offen offset:0
s_mov_b32 s56, 0x8000
buffer_load_dword v40, v5, s[20:23], s56 offen offset:0
s_mov_b32 s56, 0x8800
buffer_load_dword v41, v5, s[20:23], s56 offen offset:0
s_mov_b32 s56, 0x9000
buffer_load_dword v42, v5, s[20:23], s56 offen offset:0
s_mov_b32 s56, 0x9800
buffer_load_dword v43, v5, s[20:23], s56 offen offset:0
s_mov_b32 s56, 0x8400
buffer_load_dword v44, v5, s[20:23], s56 offen offset:0
s_mov_b32 s56, 0x8c00
buffer_load_dword v45, v5, s[20:23], s56 offen offset:0
s_mov_b32 s56, 0x9400
buffer_load_dword v46, v5, s[20:23], s56 offen offset:0
s_mov_b32 s56, 0x9c00
buffer_load_dword v47, v5, s[20:23], s56 offen offset:0
s_mov_b32 s56, 0x10000
buffer_load_dword v48, v5, s[20:23], s56 offen offset:0
s_mov_b32 s56, 0x10800
buffer_load_dword v49, v5, s[20:23], s56 offen offset:0
s_mov_b32 s56, 0x11000
buffer_load_dword v50, v5, s[20:23], s56 offen offset:0
s_mov_b32 s56, 0x11800
buffer_load_dword v51, v5, s[20:23], s56 offen offset:0
s_mov_b32 s56, 0x10400
buffer_load_dword v52, v5, s[20:23], s56 offen offset:0
s_mov_b32 s56, 0x10c00
buffer_load_dword v53, v5, s[20:23], s56 offen offset:0
s_mov_b32 s56, 0x11400
buffer_load_dword v54, v5, s[20:23], s56 offen offset:0
s_mov_b32 s56, 0x11c00
buffer_load_dword v55, v5, s[20:23], s56 offen offset:0
s_mov_b32 s56, 0x18000
buffer_load_dword v56, v5, s[20:23], s56 offen offset:0
s_mov_b32 s56, 0x18800
buffer_load_dword v57, v5, s[20:23], s56 offen offset:0
s_mov_b32 s56, 0x19000
buffer_load_dword v58, v5, s[20:23], s56 offen offset:0
s_mov_b32 s56, 0x19800
buffer_load_dword v59, v5, s[20:23], s56 offen offset:0
s_mov_b32 s56, 0x18400
buffer_load_dword v60, v5, s[20:23], s56 offen offset:0
s_mov_b32 s56, 0x18c00
buffer_load_dword v61, v5, s[20:23], s56 offen offset:0
s_mov_b32 s56, 0x19400
buffer_load_dword v62, v5, s[20:23], s56 offen offset:0
s_mov_b32 s56, 0x19c00
buffer_load_dword v63, v5, s[20:23], s56 offen offset:0
s_mov_b32 s56, 0x20000
buffer_load_dword v64, v5, s[20:23], s56 offen offset:0
s_mov_b32 s56, 0x20800
buffer_load_dword v65, v5, s[20:23], s56 offen offset:0
s_mov_b32 s56, 0x21000
buffer_load_dword v66, v5, s[20:23], s56 offen offset:0
s_mov_b32 s56, 0x21800
buffer_load_dword v67, v5, s[20:23], s56 offen offset:0
s_mov_b32 s56, 0x20400
buffer_load_dword v68, v5, s[20:23], s56 offen offset:0
s_mov_b32 s56, 0x20c00
buffer_load_dword v69, v5, s[20:23], s56 offen offset:0
s_mov_b32 s56, 0x21400
buffer_load_dword v70, v5, s[20:23], s56 offen offset:0
s_mov_b32 s56, 0x21c00
buffer_load_dword v71, v5, s[20:23], s56 offen offset:0
s_mov_b32 s56, 0x28000
buffer_load_dword v72, v5, s[20:23], s56 offen offset:0
s_mov_b32 s56, 0x28800
buffer_load_dword v73, v5, s[20:23], s56 offen offset:0
s_mov_b32 s56, 0x29000
buffer_load_dword v74, v5, s[20:23], s56 offen offset:0
s_mov_b32 s56, 0x29800
buffer_load_dword v75, v5, s[20:23], s56 offen offset:0
s_mov_b32 s56, 0x28400
buffer_load_dword v76, v5, s[20:23], s56 offen offset:0
s_mov_b32 s56, 0x28c00
buffer_load_dword v77, v5, s[20:23], s56 offen offset:0
s_mov_b32 s56, 0x29400
buffer_load_dword v78, v5, s[20:23], s56 offen offset:0
s_mov_b32 s56, 0x29c00
buffer_load_dword v79, v5, s[20:23], s56 offen offset:0
s_waitcnt vmcnt(32)
v_perm_b32 v8, v33, v32, s70
v_accvgpr_write_b32 a0, v8
v_perm_b32 v8, v33, v32, s71
v_accvgpr_write_b32 a4, v8
v_perm_b32 v8, v35, v34, s70
v_accvgpr_write_b32 a1, v8
v_perm_b32 v8, v35, v34, s71
v_accvgpr_write_b32 a5, v8
v_perm_b32 v8, v37, v36, s70
v_accvgpr_write_b32 a2, v8
v_perm_b32 v8, v37, v36, s71
v_accvgpr_write_b32 a6, v8
v_perm_b32 v8, v39, v38, s70
v_accvgpr_write_b32 a3, v8
v_perm_b32 v8, v39, v38, s71
v_accvgpr_write_b32 a7, v8
v_perm_b32 v8, v41, v40, s70
v_accvgpr_write_b32 a8, v8
v_perm_b32 v8, v41, v40, s71
v_accvgpr_write_b32 a12, v8
v_perm_b32 v8, v43, v42, s70
v_accvgpr_write_b32 a9, v8
v_perm_b32 v8, v43, v42, s71
v_accvgpr_write_b32 a13, v8
v_perm_b32 v8, v45, v44, s70
v_accvgpr_write_b32 a10, v8
v_perm_b32 v8, v45, v44, s71
v_accvgpr_write_b32 a14, v8
v_perm_b32 v8, v47, v46, s70
v_accvgpr_write_b32 a11, v8
v_perm_b32 v8, v47, v46, s71
v_accvgpr_write_b32 a15, v8
s_mov_b32 s56, 0x30000
buffer_load_dword v32, v5, s[20:23], s56 offen offset:0
s_mov_b32 s56, 0x30800
buffer_load_dword v33, v5, s[20:23], s56 offen offset:0
s_mov_b32 s56, 0x31000
buffer_load_dword v34, v5, s[20:23], s56 offen offset:0
s_mov_b32 s56, 0x31800
buffer_load_dword v35, v5, s[20:23], s56 offen offset:0
s_mov_b32 s56, 0x30400
buffer_load_dword v36, v5, s[20:23], s56 offen offset:0
s_mov_b32 s56, 0x30c00
buffer_load_dword v37, v5, s[20:23], s56 offen offset:0
s_mov_b32 s56, 0x31400
buffer_load_dword v38, v5, s[20:23], s56 offen offset:0
s_mov_b32 s56, 0x31c00
buffer_load_dword v39, v5, s[20:23], s56 offen offset:0
s_mov_b32 s56, 0x38000
buffer_load_dword v40, v5, s[20:23], s56 offen offset:0
s_mov_b32 s56, 0x38800
buffer_load_dword v41, v5, s[20:23], s56 offen offset:0
s_mov_b32 s56, 0x39000
buffer_load_dword v42, v5, s[20:23], s56 offen offset:0
s_mov_b32 s56, 0x39800
buffer_load_dword v43, v5, s[20:23], s56 offen offset:0
s_mov_b32 s56, 0x38400
buffer_load_dword v44, v5, s[20:23], s56 offen offset:0
s_mov_b32 s56, 0x38c00
buffer_load_dword v45, v5, s[20:23], s56 offen offset:0
s_mov_b32 s56, 0x39400
buffer_load_dword v46, v5, s[20:23], s56 offen offset:0
s_mov_b32 s56, 0x39c00
buffer_load_dword v47, v5, s[20:23], s56 offen offset:0
s_waitcnt vmcnt(32)
v_perm_b32 v8, v49, v48, s70
v_accvgpr_write_b32 a16, v8
v_perm_b32 v8, v49, v48, s71
v_accvgpr_write_b32 a20, v8
v_perm_b32 v8, v51, v50, s70
v_accvgpr_write_b32 a17, v8
v_perm_b32 v8, v51, v50, s71
v_accvgpr_write_b32 a21, v8
v_perm_b32 v8, v53, v52, s70
v_accvgpr_write_b32 a18, v8
v_perm_b32 v8, v53, v52, s71
v_accvgpr_write_b32 a22, v8
v_perm_b32 v8, v55, v54, s70
v_accvgpr_write_b32 a19, v8
v_perm_b32 v8, v55, v54, s71
v_accvgpr_write_b32 a23, v8
v_perm_b32 v8, v57, v56, s70
v_accvgpr_write_b32 a24, v8
v_perm_b32 v8, v57, v56, s71
v_accvgpr_write_b32 a28, v8
v_perm_b32 v8, v59, v58, s70
v_accvgpr_write_b32 a25, v8
v_perm_b32 v8, v59, v58, s71
v_accvgpr_write_b32 a29, v8
v_perm_b32 v8, v61, v60, s70
v_accvgpr_write_b32 a26, v8
v_perm_b32 v8, v61, v60, s71
v_accvgpr_write_b32 a30, v8
v_perm_b32 v8, v63, v62, s70
v_accvgpr_write_b32 a27, v8
v_perm_b32 v8, v63, v62, s71
v_accvgpr_write_b32 a31, v8
s_mov_b32 s56, 0x40000
buffer_load_dword v48, v5, s[20:23], s56 offen offset:0
s_mov_b32 s56, 0x40800
buffer_load_dword v49, v5, s[20:23], s56 offen offset:0
s_mov_b32 s56, 0x41000
buffer_load_dword v50, v5, s[20:23], s56 offen offset:0
s_mov_b32 s56, 0x41800
buffer_load_dword v51, v5, s[20:23], s56 offen offset:0
s_mov_b32 s56, 0x40400
buffer_load_dword v52, v5, s[20:23], s56 offen offset:0
s_mov_b32 s56, 0x40c00
buffer_load_dword v53, v5, s[20:23], s56 offen offset:0
s_mov_b32 s56, 0x41400
buffer_load_dword v54, v5, s[20:23], s56 offen offset:0
s_mov_b32 s56, 0x41c00
buffer_load_dword v55, v5, s[20:23], s56 offen offset:0
s_mov_b32 s56, 0x48000
buffer_load_dword v56, v5, s[20:23], s56 offen offset:0
s_mov_b32 s56, 0x48800
buffer_load_dword v57, v5, s[20:23], s56 offen offset:0
s_mov_b32 s56, 0x49000
buffer_load_dword v58, v5, s[20:23], s56 offen offset:0
s_mov_b32 s56, 0x49800
buffer_load_dword v59, v5, s[20:23], s56 offen offset:0
s_mov_b32 s56, 0x48400
buffer_load_dword v60, v5, s[20:23], s56 offen offset:0
s_mov_b32 s56, 0x48c00
buffer_load_dword v61, v5, s[20:23], s56 offen offset:0
s_mov_b32 s56, 0x49400
buffer_load_dword v62, v5, s[20:23], s56 offen offset:0
s_mov_b32 s56, 0x49c00
buffer_load_dword v63, v5, s[20:23], s56 offen offset:0
s_waitcnt vmcnt(32)
v_perm_b32 v8, v65, v64, s70
v_accvgpr_write_b32 a32, v8
v_perm_b32 v8, v65, v64, s71
v_accvgpr_write_b32 a36, v8
v_perm_b32 v8, v67, v66, s70
v_accvgpr_write_b32 a33, v8
v_perm_b32 v8, v67, v66, s71
v_accvgpr_write_b32 a37, v8
v_perm_b32 v8, v69, v68, s70
v_accvgpr_write_b32 a34, v8
v_perm_b32 v8, v69, v68, s71
v_accvgpr_write_b32 a38, v8
v_perm_b32 v8, v71, v70, s70
v_accvgpr_write_b32 a35, v8
v_perm_b32 v8, v71, v70, s71
v_accvgpr_write_b32 a39, v8
v_perm_b32 v8, v73, v72, s70
v_accvgpr_write_b32 a40, v8
v_perm_b32 v8, v73, v72, s71
v_accvgpr_write_b32 a44, v8
v_perm_b32 v8, v75, v74, s70
v_accvgpr_write_b32 a41, v8
v_perm_b32 v8, v75, v74, s71
v_accvgpr_write_b32 a45, v8
v_perm_b32 v8, v77, v76, s70
v_accvgpr_write_b32 a42, v8
v_perm_b32 v8, v77, v76, s71
v_accvgpr_write_b32 a46, v8
v_perm_b32 v8, v79, v78, s70
v_accvgpr_write_b32 a43, v8
v_perm_b32 v8, v79, v78, s71
v_accvgpr_write_b32 a47, v8
s_mov_b32 s56, 0x50000
buffer_load_dword v64, v5, s[20:23], s56 offen offset:0
s_mov_b32 s56, 0x50800
buffer_load_dword v65, v5, s[20:23], s56 offen offset:0
s_mov_b32 s56, 0x51000
buffer_load_dword v66, v5, s[20:23], s56 offen offset:0
s_mov_b32 s56, 0x51800
buffer_load_dword v67, v5, s[20:23], s56 offen offset:0
s_mov_b32 s56, 0x50400
buffer_load_dword v68, v5, s[20:23], s56 offen offset:0
s_mov_b32 s56, 0x50c00
buffer_load_dword v69, v5, s[20:23], s56 offen offset:0
s_mov_b32 s56, 0x51400
buffer_load_dword v70, v5, s[20:23], s56 offen offset:0
s_mov_b32 s56, 0x51c00
buffer_load_dword v71, v5, s[20:23], s56 offen offset:0
s_mov_b32 s56, 0x58000
buffer_load_dword v72, v5, s[20:23], s56 offen offset:0
s_mov_b32 s56, 0x58800
buffer_load_dword v73, v5, s[20:23], s56 offen offset:0
s_mov_b32 s56, 0x59000
buffer_load_dword v74, v5, s[20:23], s56 offen offset:0
s_mov_b32 s56, 0x59800
buffer_load_dword v75, v5, s[20:23], s56 offen offset:0
s_mov_b32 s56, 0x58400
buffer_load_dword v76, v5, s[20:23], s56 offen offset:0
s_mov_b32 s56, 0x58c00
buffer_load_dword v77, v5, s[20:23], s56 offen offset:0
s_mov_b32 s56, 0x59400
buffer_load_dword v78, v5, s[20:23], s56 offen offset:0
s_mov_b32 s56, 0x59c00
buffer_load_dword v79, v5, s[20:23], s56 offen offset:0
s_waitcnt vmcnt(32)
v_perm_b32 v8, v33, v32, s70
v_accvgpr_write_b32 a48, v8
v_perm_b32 v8, v33, v32, s71
v_accvgpr_write_b32 a52, v8
v_perm_b32 v8, v35, v34, s70
v_accvgpr_write_b32 a49, v8
v_perm_b32 v8, v35, v34, s71
v_accvgpr_write_b32 a53, v8
v_perm_b32 v8, v37, v36, s70
v_accvgpr_write_b32 a50, v8
v_perm_b32 v8, v37, v36, s71
v_accvgpr_write_b32 a54, v8
v_perm_b32 v8, v39, v38, s70
v_accvgpr_write_b32 a51, v8
v_perm_b32 v8, v39, v38, s71
v_accvgpr_write_b32 a55, v8
v_perm_b32 v8, v41, v40, s70
v_accvgpr_write_b32 a56, v8
v_perm_b32 v8, v41, v40, s71
v_accvgpr_write_b32 a60, v8
v_perm_b32 v8, v43, v42, s70
v_accvgpr_write_b32 a57, v8
v_perm_b32 v8, v43, v42, s71
v_accvgpr_write_b32 a61, v8
v_perm_b32 v8, v45, v44, s70
v_accvgpr_write_b32 a58, v8
v_perm_b32 v8, v45, v44, s71
v_accvgpr_write_b32 a62, v8
v_perm_b32 v8, v47, v46, s70
v_accvgpr_write_b32 a59, v8
v_perm_b32 v8, v47, v46, s71
v_accvgpr_write_b32 a63, v8
s_mov_b32 s56, 0x60000
buffer_load_dword v32, v5, s[20:23], s56 offen offset:0
s_mov_b32 s56, 0x60800
buffer_load_dword v33, v5, s[20:23], s56 offen offset:0
s_mov_b32 s56, 0x61000
buffer_load_dword v34, v5, s[20:23], s56 offen offset:0
s_mov_b32 s56, 0x61800
buffer_load_dword v35, v5, s[20:23], s56 offen offset:0
s_mov_b32 s56, 0x60400
buffer_load_dword v36, v5, s[20:23], s56 offen offset:0
s_mov_b32 s56, 0x60c00
buffer_load_dword v37, v5, s[20:23], s56 offen offset:0
s_mov_b32 s56, 0x61400
buffer_load_dword v38, v5, s[20:23], s56 offen offset:0
s_mov_b32 s56, 0x61c00
buffer_load_dword v39, v5, s[20:23], s56 offen offset:0
s_mov_b32 s56, 0x68000
buffer_load_dword v40, v5, s[20:23], s56 offen offset:0
s_mov_b32 s56, 0x68800
buffer_load_dword v41, v5, s[20:23], s56 offen offset:0
s_mov_b32 s56, 0x69000
buffer_load_dword v42, v5, s[20:23], s56 offen offset:0
s_mov_b32 s56, 0x69800
buffer_load_dword v43, v5, s[20:23], s56 offen offset:0
s_mov_b32 s56, 0x68400
buffer_load_dword v44, v5, s[20:23], s56 offen offset:0
s_mov_b32 s56, 0x68c00
buffer_load_dword v45, v5, s[20:23], s56 offen offset:0
s_mov_b32 s56, 0x69400
buffer_load_dword v46, v5, s[20:23], s56 offen offset:0
s_mov_b32 s56, 0x69c00
buffer_load_dword v47, v5, s[20:23], s56 offen offset:0
s_waitcnt vmcnt(32)
v_perm_b32 v8, v49, v48, s70
v_accvgpr_write_b32 a64, v8
v_perm_b32 v8, v49, v48, s71
v_accvgpr_write_b32 a68, v8
v_perm_b32 v8, v51, v50, s70
v_accvgpr_write_b32 a65, v8
v_perm_b32 v8, v51, v50, s71
v_accvgpr_write_b32 a69, v8
v_perm_b32 v8, v53, v52, s70
v_accvgpr_write_b32 a66, v8
v_perm_b32 v8, v53, v52, s71
v_accvgpr_write_b32 a70, v8
v_perm_b32 v8, v55, v54, s70
v_accvgpr_write_b32 a67, v8
v_perm_b32 v8, v55, v54, s71
v_accvgpr_write_b32 a71, v8
v_perm_b32 v8, v57, v56, s70
v_accvgpr_write_b32 a72, v8
v_perm_b32 v8, v57, v56, s71
v_accvgpr_write_b32 a76, v8
v_perm_b32 v8, v59, v58, s70
v_accvgpr_write_b32 a73, v8
v_perm_b32 v8, v59, v58, s71
v_accvgpr_write_b32 a77, v8
v_perm_b32 v8, v61, v60, s70
v_accvgpr_write_b32 a74, v8
v_perm_b32 v8, v61, v60, s71
v_accvgpr_write_b32 a78, v8
v_perm_b32 v8, v63, v62, s70
v_accvgpr_write_b32 a75, v8
v_perm_b32 v8, v63, v62, s71
v_accvgpr_write_b32 a79, v8
s_mov_b32 s56, 0x70000
buffer_load_dword v48, v5, s[20:23], s56 offen offset:0
s_mov_b32 s56, 0x70800
buffer_load_dword v49, v5, s[20:23], s56 offen offset:0
s_mov_b32 s56, 0x71000
buffer_load_dword v50, v5, s[20:23], s56 offen offset:0
s_mov_b32 s56, 0x71800
buffer_load_dword v51, v5, s[20:23], s56 offen offset:0
s_mov_b32 s56, 0x70400
buffer_load_dword v52, v5, s[20:23], s56 offen offset:0
s_mov_b32 s56, 0x70c00
buffer_load_dword v53, v5, s[20:23], s56 offen offset:0
s_mov_b32 s56, 0x71400
buffer_load_dword v54, v5, s[20:23], s56 offen offset:0
s_mov_b32 s56, 0x71c00
buffer_load_dword v55, v5, s[20:23], s56 offen offset:0
s_mov_b32 s56, 0x78000
buffer_load_dword v56, v5, s[20:23], s56 offen offset:0
s_mov_b32 s56, 0x78800
buffer_load_dword v57, v5, s[20:23], s56 offen offset:0
s_mov_b32 s56, 0x79000
buffer_load_dword v58, v5, s[20:23], s56 offen offset:0
s_mov_b32 s56, 0x79800
buffer_load_dword v59, v5, s[20:23], s56 offen offset:0
s_mov_b32 s56, 0x78400
buffer_load_dword v60, v5, s[20:23], s56 offen offset:0
s_mov_b32 s56, 0x78c00
buffer_load_dword v61, v5, s[20:23], s56 offen offset:0
s_mov_b32 s56, 0x79400
buffer_load_dword v62, v5, s[20:23], s56 offen offset:0
s_mov_b32 s56, 0x79c00
buffer_load_dword v63, v5, s[20:23], s56 offen offset:0
s_waitcnt vmcnt(32)
v_perm_b32 v8, v65, v64, s70
v_accvgpr_write_b32 a80, v8
v_perm_b32 v8, v65, v64, s71
v_accvgpr_write_b32 a84, v8
v_perm_b32 v8, v67, v66, s70
v_accvgpr_write_b32 a81, v8
v_perm_b32 v8, v67, v66, s71
v_accvgpr_write_b32 a85, v8
v_perm_b32 v8, v69, v68, s70
v_accvgpr_write_b32 a82, v8
v_perm_b32 v8, v69, v68, s71
v_accvgpr_write_b32 a86, v8
v_perm_b32 v8, v71, v70, s70
v_accvgpr_write_b32 a83, v8
v_perm_b32 v8, v71, v70, s71
v_accvgpr_write_b32 a87, v8
v_perm_b32 v8, v73, v72, s70
v_accvgpr_write_b32 a88, v8
v_perm_b32 v8, v73, v72, s71
v_accvgpr_write_b32 a92, v8
v_perm_b32 v8, v75, v74, s70
v_accvgpr_write_b32 a89, v8
v_perm_b32 v8, v75, v74, s71
v_accvgpr_write_b32 a93, v8
v_perm_b32 v8, v77, v76, s70
v_accvgpr_write_b32 a90, v8
v_perm_b32 v8, v77, v76, s71
v_accvgpr_write_b32 a94, v8
v_perm_b32 v8, v79, v78, s70
v_accvgpr_write_b32 a91, v8
v_perm_b32 v8, v79, v78, s71
v_accvgpr_write_b32 a95, v8
s_mov_b32 s56, 0x80000
buffer_load_dword v64, v5, s[20:23], s56 offen offset:0
s_mov_b32 s56, 0x80800
buffer_load_dword v65, v5, s[20:23], s56 offen offset:0
s_mov_b32 s56, 0x81000
buffer_load_dword v66, v5, s[20:23], s56 offen offset:0
s_mov_b32 s56, 0x81800
buffer_load_dword v67, v5, s[20:23], s56 offen offset:0
s_mov_b32 s56, 0x80400
buffer_load_dword v68, v5, s[20:23], s56 offen offset:0
s_mov_b32 s56, 0x80c00
buffer_load_dword v69, v5, s[20:23], s56 offen offset:0
s_mov_b32 s56, 0x81400
buffer_load_dword v70, v5, s[20:23], s56 offen offset:0
s_mov_b32 s56, 0x81c00
buffer_load_dword v71, v5, s[20:23], s56 offen offset:0
s_mov_b32 s56, 0x88000
buffer_load_dword v72, v5, s[20:23], s56 offen offset:0
s_mov_b32 s56, 0x88800
buffer_load_dword v73, v5, s[20:23], s56 offen offset:0
s_mov_b32 s56, 0x89000
buffer_load_dword v74, v5, s[20:23], s56 offen offset:0
s_mov_b32 s56, 0x89800
buffer_load_dword v75, v5, s[20:23], s56 offen offset:0
s_mov_b32 s56, 0x88400
buffer_load_dword v76, v5, s[20:23], s56 offen offset:0
s_mov_b32 s56, 0x88c00
buffer_load_dword v77, v5, s[20:23], s56 offen offset:0
s_mov_b32 s56, 0x89400
buffer_load_dword v78, v5, s[20:23], s56 offen offset:0
s_mov_b32 s56, 0x89c00
buffer_load_dword v79, v5, s[20:23], s56 offen offset:0
s_waitcnt vmcnt(32)
v_perm_b32 v8, v33, v32, s70
v_accvgpr_write_b32 a96, v8
v_perm_b32 v8, v33, v32, s71
v_accvgpr_write_b32 a100, v8
v_perm_b32 v8, v35, v34, s70
v_accvgpr_write_b32 a97, v8
v_perm_b32 v8, v35, v34, s71
v_accvgpr_write_b32 a101, v8
v_perm_b32 v8, v37, v36, s70
v_accvgpr_write_b32 a98, v8
v_perm_b32 v8, v37, v36, s71
v_accvgpr_write_b32 a102, v8
v_perm_b32 v8, v39, v38, s70
v_accvgpr_write_b32 a99, v8
v_perm_b32 v8, v39, v38, s71
v_accvgpr_write_b32 a103, v8
v_perm_b32 v8, v41, v40, s70
v_accvgpr_write_b32 a104, v8
v_perm_b32 v8, v41, v40, s71
v_accvgpr_write_b32 a108, v8
v_perm_b32 v8, v43, v42, s70
v_accvgpr_write_b32 a105, v8
v_perm_b32 v8, v43, v42, s71
v_accvgpr_write_b32 a109, v8
v_perm_b32 v8, v45, v44, s70
v_accvgpr_write_b32 a106, v8
v_perm_b32 v8, v45, v44, s71
v_accvgpr_write_b32 a110, v8
v_perm_b32 v8, v47, v46, s70
v_accvgpr_write_b32 a107, v8
v_perm_b32 v8, v47, v46, s71
v_accvgpr_write_b32 a111, v8
s_mov_b32 s56, 0x90000
buffer_load_dword v32, v5, s[20:23], s56 offen offset:0
s_mov_b32 s56, 0x90800
buffer_load_dword v33, v5, s[20:23], s56 offen offset:0
s_mov_b32 s56, 0x91000
buffer_load_dword v34, v5, s[20:23], s56 offen offset:0
s_mov_b32 s56, 0x91800
buffer_load_dword v35, v5, s[20:23], s56 offen offset:0
s_mov_b32 s56, 0x90400
buffer_load_dword v36, v5, s[20:23], s56 offen offset:0
s_mov_b32 s56, 0x90c00
buffer_load_dword v37, v5, s[20:23], s56 offen offset:0
s_mov_b32 s56, 0x91400
buffer_load_dword v38, v5, s[20:23], s56 offen offset:0
s_mov_b32 s56, 0x91c00
buffer_load_dword v39, v5, s[20:23], s56 offen offset:0
s_mov_b32 s56, 0x98000
buffer_load_dword v40, v5, s[20:23], s56 offen offset:0
s_mov_b32 s56, 0x98800
buffer_load_dword v41, v5, s[20:23], s56 offen offset:0
s_mov_b32 s56, 0x99000
buffer_load_dword v42, v5, s[20:23], s56 offen offset:0
s_mov_b32 s56, 0x99800
buffer_load_dword v43, v5, s[20:23], s56 offen offset:0
s_mov_b32 s56, 0x98400
buffer_load_dword v44, v5, s[20:23], s56 offen offset:0
s_mov_b32 s56, 0x98c00
buffer_load_dword v45, v5, s[20:23], s56 offen offset:0
s_mov_b32 s56, 0x99400
buffer_load_dword v46, v5, s[20:23], s56 offen offset:0
s_mov_b32 s56, 0x99c00
buffer_load_dword v47, v5, s[20:23], s56 offen offset:0
s_waitcnt vmcnt(32)
v_perm_b32 v8, v49, v48, s70
v_accvgpr_write_b32 a112, v8
v_perm_b32 v8, v49, v48, s71
v_accvgpr_write_b32 a116, v8
v_perm_b32 v8, v51, v50, s70
v_accvgpr_write_b32 a113, v8
v_perm_b32 v8, v51, v50, s71
v_accvgpr_write_b32 a117, v8
v_perm_b32 v8, v53, v52, s70
v_accvgpr_write_b32 a114, v8
v_perm_b32 v8, v53, v52, s71
v_accvgpr_write_b32 a118, v8
v_perm_b32 v8, v55, v54, s70
v_accvgpr_write_b32 a115, v8
v_perm_b32 v8, v55, v54, s71
v_accvgpr_write_b32 a119, v8
v_perm_b32 v8, v57, v56, s70
v_accvgpr_write_b32 a120, v8
v_perm_b32 v8, v57, v56, s71
v_accvgpr_write_b32 a124, v8
v_perm_b32 v8, v59, v58, s70
v_accvgpr_write_b32 a121, v8
v_perm_b32 v8, v59, v58, s71
v_accvgpr_write_b32 a125, v8
v_perm_b32 v8, v61, v60, s70
v_accvgpr_write_b32 a122, v8
v_perm_b32 v8, v61, v60, s71
v_accvgpr_write_b32 a126, v8
v_perm_b32 v8, v63, v62, s70
v_accvgpr_write_b32 a123, v8
v_perm_b32 v8, v63, v62, s71
v_accvgpr_write_b32 a127, v8
s_mov_b32 s56, 0xa0000
buffer_load_dword v48, v5, s[20:23], s56 offen offset:0
s_mov_b32 s56, 0xa0800
buffer_load_dword v49, v5, s[20:23], s56 offen offset:0
s_mov_b32 s56, 0xa1000
buffer_load_dword v50, v5, s[20:23], s56 offen offset:0
s_mov_b32 s56, 0xa1800
buffer_load_dword v51, v5, s[20:23], s56 offen offset:0
s_mov_b32 s56, 0xa0400
buffer_load_dword v52, v5, s[20:23], s56 offen offset:0
s_mov_b32 s56, 0xa0c00
buffer_load_dword v53, v5, s[20:23], s56 offen offset:0
s_mov_b32 s56, 0xa1400
buffer_load_dword v54, v5, s[20:23], s56 offen offset:0
s_mov_b32 s56, 0xa1c00
buffer_load_dword v55, v5, s[20:23], s56 offen offset:0
s_mov_b32 s56, 0xa8000
buffer_load_dword v56, v5, s[20:23], s56 offen offset:0
s_mov_b32 s56, 0xa8800
buffer_load_dword v57, v5, s[20:23], s56 offen offset:0
s_mov_b32 s56, 0xa9000
buffer_load_dword v58, v5, s[20:23], s56 offen offset:0
s_mov_b32 s56, 0xa9800
buffer_load_dword v59, v5, s[20:23], s56 offen offset:0
s_mov_b32 s56, 0xa8400
buffer_load_dword v60, v5, s[20:23], s56 offen offset:0
s_mov_b32 s56, 0xa8c00
buffer_load_dword v61, v5, s[20:23], s56 offen offset:0
s_mov_b32 s56, 0xa9400
buffer_load_dword v62, v5, s[20:23], s56 offen offset:0
s_mov_b32 s56, 0xa9c00
buffer_load_dword v63, v5, s[20:23], s56 offen offset:0
s_waitcnt vmcnt(32)
v_perm_b32 v8, v65, v64, s70
v_accvgpr_write_b32 a128, v8
v_perm_b32 v8, v65, v64, s71
v_accvgpr_write_b32 a132, v8
v_perm_b32 v8, v67, v66, s70
v_accvgpr_write_b32 a129, v8
v_perm_b32 v8, v67, v66, s71
v_accvgpr_write_b32 a133, v8
v_perm_b32 v8, v69, v68, s70
v_accvgpr_write_b32 a130, v8
v_perm_b32 v8, v69, v68, s71
v_accvgpr_write_b32 a134, v8
v_perm_b32 v8, v71, v70, s70
v_accvgpr_write_b32 a131, v8
v_perm_b32 v8, v71, v70, s71
v_accvgpr_write_b32 a135, v8
v_perm_b32 v8, v73, v72, s70
v_accvgpr_write_b32 a136, v8
v_perm_b32 v8, v73, v72, s71
v_accvgpr_write_b32 a140, v8
v_perm_b32 v8, v75, v74, s70
v_accvgpr_write_b32 a137, v8
v_perm_b32 v8, v75, v74, s71
v_accvgpr_write_b32 a141, v8
v_perm_b32 v8, v77, v76, s70
v_accvgpr_write_b32 a138, v8
v_perm_b32 v8, v77, v76, s71
v_accvgpr_write_b32 a142, v8
v_perm_b32 v8, v79, v78, s70
v_accvgpr_write_b32 a139, v8
v_perm_b32 v8, v79, v78, s71
v_accvgpr_write_b32 a143, v8
s_mov_b32 s56, 0xb0000
buffer_load_dword v64, v5, s[20:23], s56 offen offset:0
s_mov_b32 s56, 0xb0800
buffer_load_dword v65, v5, s[20:23], s56 offen offset:0
s_mov_b32 s56, 0xb1000
buffer_load_dword v66, v5, s[20:23], s56 offen offset:0
s_mov_b32 s56, 0xb1800
buffer_load_dword v67, v5, s[20:23], s56 offen offset:0
s_mov_b32 s56, 0xb0400
buffer_load_dword v68, v5, s[20:23], s56 offen offset:0
s_mov_b32 s56, 0xb0c00
buffer_load_dword v69, v5, s[20:23], s56 offen offset:0
s_mov_b32 s56, 0xb1400
buffer_load_dword v70, v5, s[20:23], s56 offen offset:0
s_mov_b32 s56, 0xb1c00
buffer_load_dword v71, v5, s[20:23], s56 offen offset:0
s_mov_b32 s56, 0xb8000
buffer_load_dword v72, v5, s[20:23], s56 offen offset:0
s_mov_b32 s56, 0xb8800
buffer_load_dword v73, v5, s[20:23], s56 offen offset:0
s_mov_b32 s56, 0xb9000
buffer_load_dword v74, v5, s[20:23], s56 offen offset:0
s_mov_b32 s56, 0xb9800
buffer_load_dword v75, v5, s[20:23], s56 offen offset:0
s_mov_b32 s56, 0xb8400
buffer_load_dword v76, v5, s[20:23], s56 offen offset:0
s_mov_b32 s56, 0xb8c00
buffer_load_dword v77, v5, s[20:23], s56 offen offset:0
s_mov_b32 s56, 0xb9400
buffer_load_dword v78, v5, s[20:23], s56 offen offset:0
s_mov_b32 s56, 0xb9c00
buffer_load_dword v79, v5, s[20:23], s56 offen offset:0
s_waitcnt vmcnt(32)
v_perm_b32 v8, v33, v32, s70
v_accvgpr_write_b32 a144, v8
v_perm_b32 v8, v33, v32, s71
v_accvgpr_write_b32 a148, v8
v_perm_b32 v8, v35, v34, s70
v_accvgpr_write_b32 a145, v8
v_perm_b32 v8, v35, v34, s71
v_accvgpr_write_b32 a149, v8
v_perm_b32 v8, v37, v36, s70
v_accvgpr_write_b32 a146, v8
v_perm_b32 v8, v37, v36, s71
v_accvgpr_write_b32 a150, v8
v_perm_b32 v8, v39, v38, s70
v_accvgpr_write_b32 a147, v8
v_perm_b32 v8, v39, v38, s71
v_accvgpr_write_b32 a151, v8
v_perm_b32 v8, v41, v40, s70
v_accvgpr_write_b32 a152, v8
v_perm_b32 v8, v41, v40, s71
v_accvgpr_write_b32 a156, v8
v_perm_b32 v8, v43, v42, s70
v_accvgpr_write_b32 a153, v8
v_perm_b32 v8, v43, v42, s71
v_accvgpr_write_b32 a157, v8
v_perm_b32 v8, v45, v44, s70
v_accvgpr_write_b32 a154, v8
v_perm_b32 v8, v45, v44, s71
v_accvgpr_write_b32 a158, v8
v_perm_b32 v8, v47, v46, s70
v_accvgpr_write_b32 a155, v8
v_perm_b32 v8, v47, v46, s71
v_accvgpr_write_b32 a159, v8
s_mov_b32 s56, 0xc0000
buffer_load_dword v32, v5, s[20:23], s56 offen offset:0
s_mov_b32 s56, 0xc0800
buffer_load_dword v33, v5, s[20:23], s56 offen offset:0
s_mov_b32 s56, 0xc1000
buffer_load_dword v34, v5, s[20:23], s56 offen offset:0
s_mov_b32 s56, 0xc1800
buffer_load_dword v35, v5, s[20:23], s56 offen offset:0
s_mov_b32 s56, 0xc0400
buffer_load_dword v36, v5, s[20:23], s56 offen offset:0
s_mov_b32 s56, 0xc0c00
buffer_load_dword v37, v5, s[20:23], s56 offen offset:0
s_mov_b32 s56, 0xc1400
buffer_load_dword v38, v5, s[20:23], s56 offen offset:0
s_mov_b32 s56, 0xc1c00
buffer_load_dword v39, v5, s[20:23], s56 offen offset:0
s_mov_b32 s56, 0xc8000
buffer_load_dword v40, v5, s[20:23], s56 offen offset:0
s_mov_b32 s56, 0xc8800
buffer_load_dword v41, v5, s[20:23], s56 offen offset:0
s_mov_b32 s56, 0xc9000
buffer_load_dword v42, v5, s[20:23], s56 offen offset:0
s_mov_b32 s56, 0xc9800
buffer_load_dword v43, v5, s[20:23], s56 offen offset:0
s_mov_b32 s56, 0xc8400
buffer_load_dword v44, v5, s[20:23], s56 offen offset:0
s_mov_b32 s56, 0xc8c00
buffer_load_dword v45, v5, s[20:23], s56 offen offset:0
s_mov_b32 s56, 0xc9400
buffer_load_dword v46, v5, s[20:23], s56 offen offset:0
s_mov_b32 s56, 0xc9c00
buffer_load_dword v47, v5, s[20:23], s56 offen offset:0
s_waitcnt vmcnt(32)
v_perm_b32 v8, v49, v48, s70
v_accvgpr_write_b32 a160, v8
v_perm_b32 v8, v49, v48, s71
v_accvgpr_write_b32 a164, v8
v_perm_b32 v8, v51, v50, s70
v_accvgpr_write_b32 a161, v8
v_perm_b32 v8, v51, v50, s71
v_accvgpr_write_b32 a165, v8
v_perm_b32 v8, v53, v52, s70
v_accvgpr_write_b32 a162, v8
v_perm_b32 v8, v53, v52, s71
v_accvgpr_write_b32 a166, v8
v_perm_b32 v8, v55, v54, s70
v_accvgpr_write_b32 a163, v8
v_perm_b32 v8, v55, v54, s71
v_accvgpr_write_b32 a167, v8
v_perm_b32 v8, v57, v56, s70
v_accvgpr_write_b32 a168, v8
v_perm_b32 v8, v57, v56, s71
v_accvgpr_write_b32 a172, v8
v_perm_b32 v8, v59, v58, s70
v_accvgpr_write_b32 a169, v8
v_perm_b32 v8, v59, v58, s71
v_accvgpr_write_b32 a173, v8
v_perm_b32 v8, v61, v60, s70
v_accvgpr_write_b32 a170, v8
v_perm_b32 v8, v61, v60, s71
v_accvgpr_write_b32 a174, v8
v_perm_b32 v8, v63, v62, s70
v_accvgpr_write_b32 a171, v8
v_perm_b32 v8, v63, v62, s71
v_accvgpr_write_b32 a175, v8
s_mov_b32 s56, 0xd0000
buffer_load_dword v48, v5, s[20:23], s56 offen offset:0
s_mov_b32 s56, 0xd0800
buffer_load_dword v49, v5, s[20:23], s56 offen offset:0
s_mov_b32 s56, 0xd1000
buffer_load_dword v50, v5, s[20:23], s56 offen offset:0
s_mov_b32 s56, 0xd1800
buffer_load_dword v51, v5, s[20:23], s56 offen offset:0
s_mov_b32 s56, 0xd0400
buffer_load_dword v52, v5, s[20:23], s56 offen offset:0
s_mov_b32 s56, 0xd0c00
buffer_load_dword v53, v5, s[20:23], s56 offen offset:0
s_mov_b32 s56, 0xd1400
buffer_load_dword v54, v5, s[20:23], s56 offen offset:0
s_mov_b32 s56, 0xd1c00
buffer_load_dword v55, v5, s[20:23], s56 offen offset:0
s_mov_b32 s56, 0xd8000
buffer_load_dword v56, v5, s[20:23], s56 offen offset:0
s_mov_b32 s56, 0xd8800
buffer_load_dword v57, v5, s[20:23], s56 offen offset:0
s_mov_b32 s56, 0xd9000
buffer_load_dword v58, v5, s[20:23], s56 offen offset:0
s_mov_b32 s56, 0xd9800
buffer_load_dword v59, v5, s[20:23], s56 offen offset:0
s_mov_b32 s56, 0xd8400
buffer_load_dword v60, v5, s[20:23], s56 offen offset:0
s_mov_b32 s56, 0xd8c00
buffer_load_dword v61, v5, s[20:23], s56 offen offset:0
s_mov_b32 s56, 0xd9400
buffer_load_dword v62, v5, s[20:23], s56 offen offset:0
s_mov_b32 s56, 0xd9c00
buffer_load_dword v63, v5, s[20:23], s56 offen offset:0
s_waitcnt vmcnt(32)
v_perm_b32 v8, v65, v64, s70
v_accvgpr_write_b32 a176, v8
v_perm_b32 v8, v65, v64, s71
v_accvgpr_write_b32 a180, v8
v_perm_b32 v8, v67, v66, s70
v_accvgpr_write_b32 a177, v8
v_perm_b32 v8, v67, v66, s71
v_accvgpr_write_b32 a181, v8
v_perm_b32 v8, v69, v68, s70
v_accvgpr_write_b32 a178, v8
v_perm_b32 v8, v69, v68, s71
v_accvgpr_write_b32 a182, v8
v_perm_b32 v8, v71, v70, s70
v_accvgpr_write_b32 a179, v8
v_perm_b32 v8, v71, v70, s71
v_accvgpr_write_b32 a183, v8
v_perm_b32 v8, v73, v72, s70
v_accvgpr_write_b32 a184, v8
v_perm_b32 v8, v73, v72, s71
v_accvgpr_write_b32 a188, v8
v_perm_b32 v8, v75, v74, s70
v_accvgpr_write_b32 a185, v8
v_perm_b32 v8, v75, v74, s71
v_accvgpr_write_b32 a189, v8
v_perm_b32 v8, v77, v76, s70
v_accvgpr_write_b32 a186, v8
v_perm_b32 v8, v77, v76, s71
v_accvgpr_write_b32 a190, v8
v_perm_b32 v8, v79, v78, s70
v_accvgpr_write_b32 a187, v8
v_perm_b32 v8, v79, v78, s71
v_accvgpr_write_b32 a191, v8
s_mov_b32 s56, 0xe0000
buffer_load_dword v64, v5, s[20:23], s56 offen offset:0
s_mov_b32 s56, 0xe0800
buffer_load_dword v65, v5, s[20:23], s56 offen offset:0
s_mov_b32 s56, 0xe1000
buffer_load_dword v66, v5, s[20:23], s56 offen offset:0
s_mov_b32 s56, 0xe1800
buffer_load_dword v67, v5, s[20:23], s56 offen offset:0
s_mov_b32 s56, 0xe0400
buffer_load_dword v68, v5, s[20:23], s56 offen offset:0
s_mov_b32 s56, 0xe0c00
buffer_load_dword v69, v5, s[20:23], s56 offen offset:0
s_mov_b32 s56, 0xe1400
buffer_load_dword v70, v5, s[20:23], s56 offen offset:0
s_mov_b32 s56, 0xe1c00
buffer_load_dword v71, v5, s[20:23], s56 offen offset:0
s_mov_b32 s56, 0xe8000
buffer_load_dword v72, v5, s[20:23], s56 offen offset:0
s_mov_b32 s56, 0xe8800
buffer_load_dword v73, v5, s[20:23], s56 offen offset:0
s_mov_b32 s56, 0xe9000
buffer_load_dword v74, v5, s[20:23], s56 offen offset:0
s_mov_b32 s56, 0xe9800
buffer_load_dword v75, v5, s[20:23], s56 offen offset:0
s_mov_b32 s56, 0xe8400
buffer_load_dword v76, v5, s[20:23], s56 offen offset:0
s_mov_b32 s56, 0xe8c00
buffer_load_dword v77, v5, s[20:23], s56 offen offset:0
s_mov_b32 s56, 0xe9400
buffer_load_dword v78, v5, s[20:23], s56 offen offset:0
s_mov_b32 s56, 0xe9c00
buffer_load_dword v79, v5, s[20:23], s56 offen offset:0
s_waitcnt vmcnt(32)
v_perm_b32 v8, v33, v32, s70
v_accvgpr_write_b32 a192, v8
v_perm_b32 v8, v33, v32, s71
v_accvgpr_write_b32 a196, v8
v_perm_b32 v8, v35, v34, s70
v_accvgpr_write_b32 a193, v8
v_perm_b32 v8, v35, v34, s71
v_accvgpr_write_b32 a197, v8
v_perm_b32 v8, v37, v36, s70
v_accvgpr_write_b32 a194, v8
v_perm_b32 v8, v37, v36, s71
v_accvgpr_write_b32 a198, v8
v_perm_b32 v8, v39, v38, s70
v_accvgpr_write_b32 a195, v8
v_perm_b32 v8, v39, v38, s71
v_accvgpr_write_b32 a199, v8
v_perm_b32 v8, v41, v40, s70
v_accvgpr_write_b32 a200, v8
v_perm_b32 v8, v41, v40, s71
v_accvgpr_write_b32 a204, v8
v_perm_b32 v8, v43, v42, s70
v_accvgpr_write_b32 a201, v8
v_perm_b32 v8, v43, v42, s71
v_accvgpr_write_b32 a205, v8
v_perm_b32 v8, v45, v44, s70
v_accvgpr_write_b32 a202, v8
v_perm_b32 v8, v45, v44, s71
v_accvgpr_write_b32 a206, v8
v_perm_b32 v8, v47, v46, s70
v_accvgpr_write_b32 a203, v8
v_perm_b32 v8, v47, v46, s71
v_accvgpr_write_b32 a207, v8
s_mov_b32 s56, 0xf0000
buffer_load_dword v32, v5, s[20:23], s56 offen offset:0
s_mov_b32 s56, 0xf0800
buffer_load_dword v33, v5, s[20:23], s56 offen offset:0
s_mov_b32 s56, 0xf1000
buffer_load_dword v34, v5, s[20:23], s56 offen offset:0
s_mov_b32 s56, 0xf1800
buffer_load_dword v35, v5, s[20:23], s56 offen offset:0
s_mov_b32 s56, 0xf0400
buffer_load_dword v36, v5, s[20:23], s56 offen offset:0
s_mov_b32 s56, 0xf0c00
buffer_load_dword v37, v5, s[20:23], s56 offen offset:0
s_mov_b32 s56, 0xf1400
buffer_load_dword v38, v5, s[20:23], s56 offen offset:0
s_mov_b32 s56, 0xf1c00
buffer_load_dword v39, v5, s[20:23], s56 offen offset:0
s_mov_b32 s56, 0xf8000
buffer_load_dword v40, v5, s[20:23], s56 offen offset:0
s_mov_b32 s56, 0xf8800
buffer_load_dword v41, v5, s[20:23], s56 offen offset:0
s_mov_b32 s56, 0xf9000
buffer_load_dword v42, v5, s[20:23], s56 offen offset:0
s_mov_b32 s56, 0xf9800
buffer_load_dword v43, v5, s[20:23], s56 offen offset:0
s_mov_b32 s56, 0xf8400
buffer_load_dword v44, v5, s[20:23], s56 offen offset:0
s_mov_b32 s56, 0xf8c00
buffer_load_dword v45, v5, s[20:23], s56 offen offset:0
s_mov_b32 s56, 0xf9400
buffer_load_dword v46, v5, s[20:23], s56 offen offset:0
s_mov_b32 s56, 0xf9c00
buffer_load_dword v47, v5, s[20:23], s56 offen offset:0
s_waitcnt vmcnt(32)
v_perm_b32 v8, v49, v48, s70
v_accvgpr_write_b32 a208, v8
v_perm_b32 v8, v49, v48, s71
v_accvgpr_write_b32 a212, v8
v_perm_b32 v8, v51, v50, s70
v_accvgpr_write_b32 a209, v8
v_perm_b32 v8, v51, v50, s71
v_accvgpr_write_b32 a213, v8
v_perm_b32 v8, v53, v52, s70
v_accvgpr_write_b32 a210, v8
v_perm_b32 v8, v53, v52, s71
v_accvgpr_write_b32 a214, v8
v_perm_b32 v8, v55, v54, s70
v_accvgpr_write_b32 a211, v8
v_perm_b32 v8, v55, v54, s71
v_accvgpr_write_b32 a215, v8
v_perm_b32 v8, v57, v56, s70
v_accvgpr_write_b32 a216, v8
v_perm_b32 v8, v57, v56, s71
v_accvgpr_write_b32 a220, v8
v_perm_b32 v8, v59, v58, s70
v_accvgpr_write_b32 a217, v8
v_perm_b32 v8, v59, v58, s71
v_accvgpr_write_b32 a221, v8
v_perm_b32 v8, v61, v60, s70
v_accvgpr_write_b32 a218, v8
v_perm_b32 v8, v61, v60, s71
v_accvgpr_write_b32 a222, v8
v_perm_b32 v8, v63, v62, s70
v_accvgpr_write_b32 a219, v8
v_perm_b32 v8, v63, v62, s71
v_accvgpr_write_b32 a223, v8
s_waitcnt vmcnt(16)
v_perm_b32 v8, v65, v64, s70
v_accvgpr_write_b32 a224, v8
v_perm_b32 v8, v65, v64, s71
v_accvgpr_write_b32 a228, v8
v_perm_b32 v8, v67, v66, s70
v_accvgpr_write_b32 a225, v8
v_perm_b32 v8, v67, v66, s71
v_accvgpr_write_b32 a229, v8
v_perm_b32 v8, v69, v68, s70
v_accvgpr_write_b32 a226, v8
v_perm_b32 v8, v69, v68, s71
v_accvgpr_write_b32 a230, v8
v_perm_b32 v8, v71, v70, s70
v_accvgpr_write_b32 a227, v8
v_perm_b32 v8, v71, v70, s71
v_accvgpr_write_b32 a231, v8
v_perm_b32 v8, v73, v72, s70
v_accvgpr_write_b32 a232, v8
v_perm_b32 v8, v73, v72, s71
v_accvgpr_write_b32 a236, v8
v_perm_b32 v8, v75, v74, s70
v_accvgpr_write_b32 a233, v8
v_perm_b32 v8, v75, v74, s71
v_accvgpr_write_b32 a237, v8
v_perm_b32 v8, v77, v76, s70
v_accvgpr_write_b32 a234, v8
v_perm_b32 v8, v77, v76, s71
v_accvgpr_write_b32 a238, v8
v_perm_b32 v8, v79, v78, s70
v_accvgpr_write_b32 a235, v8
v_perm_b32 v8, v79, v78, s71
v_accvgpr_write_b32 a239, v8
s_waitcnt vmcnt(0)
v_perm_b32 v8, v33, v32, s70
v_accvgpr_write_b32 a240, v8
v_perm_b32 v8, v33, v32, s71
v_accvgpr_write_b32 a244, v8
v_perm_b32 v8, v35, v34, s70
v_accvgpr_write_b32 a241, v8
v_perm_b32 v8, v35, v34, s71
v_accvgpr_write_b32 a245, v8
v_perm_b32 v8, v37, v36, s70
v_accvgpr_write_b32 a242, v8
v_perm_b32 v8, v37, v36, s71
v_accvgpr_write_b32 a246, v8
v_perm_b32 v8, v39, v38, s70
v_accvgpr_write_b32 a243, v8
v_perm_b32 v8, v39, v38, s71
v_accvgpr_write_b32 a247, v8
v_perm_b32 v8, v41, v40, s70
v_accvgpr_write_b32 a248, v8
v_perm_b32 v8, v41, v40, s71
v_accvgpr_write_b32 a252, v8
v_perm_b32 v8, v43, v42, s70
v_accvgpr_write_b32 a249, v8
v_perm_b32 v8, v43, v42, s71
v_accvgpr_write_b32 a253, v8
v_perm_b32 v8, v45, v44, s70
v_accvgpr_write_b32 a250, v8
v_perm_b32 v8, v45, v44, s71
v_accvgpr_write_b32 a254, v8
v_perm_b32 v8, v47, v46, s70
v_accvgpr_write_b32 a251, v8
v_perm_b32 v8, v47, v46, s71
v_accvgpr_write_b32 a255, v8
s_mov_b32 s56, 0x0
buffer_load_dword v32, v4, s[24:27], s56 offen offset:0
s_mov_b32 s56, 0x800
buffer_load_dword v33, v4, s[24:27], s56 offen offset:0
s_mov_b32 s56, 0x1000
buffer_load_dword v34, v4, s[24:27], s56 offen offset:0
s_mov_b32 s56, 0x1800
buffer_load_dword v35, v4, s[24:27], s56 offen offset:0
s_mov_b32 s56, 0x400
buffer_load_dword v36, v4, s[24:27], s56 offen offset:0
s_mov_b32 s56, 0xc00
buffer_load_dword v37, v4, s[24:27], s56 offen offset:0
s_mov_b32 s56, 0x1400
buffer_load_dword v38, v4, s[24:27], s56 offen offset:0
s_mov_b32 s56, 0x1c00
buffer_load_dword v39, v4, s[24:27], s56 offen offset:0
s_mov_b32 s56, 0x8000
buffer_load_dword v40, v4, s[24:27], s56 offen offset:0
s_mov_b32 s56, 0x8800
buffer_load_dword v41, v4, s[24:27], s56 offen offset:0
s_mov_b32 s56, 0x9000
buffer_load_dword v42, v4, s[24:27], s56 offen offset:0
s_mov_b32 s56, 0x9800
buffer_load_dword v43, v4, s[24:27], s56 offen offset:0
s_mov_b32 s56, 0x8400
buffer_load_dword v44, v4, s[24:27], s56 offen offset:0
s_mov_b32 s56, 0x8c00
buffer_load_dword v45, v4, s[24:27], s56 offen offset:0
s_mov_b32 s56, 0x9400
buffer_load_dword v46, v4, s[24:27], s56 offen offset:0
s_mov_b32 s56, 0x9c00
buffer_load_dword v47, v4, s[24:27], s56 offen offset:0
s_mov_b32 s56, 0x10000
buffer_load_dword v48, v4, s[24:27], s56 offen offset:0
s_mov_b32 s56, 0x10800
buffer_load_dword v49, v4, s[24:27], s56 offen offset:0
s_mov_b32 s56, 0x11000
buffer_load_dword v50, v4, s[24:27], s56 offen offset:0
s_mov_b32 s56, 0x11800
buffer_load_dword v51, v4, s[24:27], s56 offen offset:0
s_mov_b32 s56, 0x10400
buffer_load_dword v52, v4, s[24:27], s56 offen offset:0
s_mov_b32 s56, 0x10c00
buffer_load_dword v53, v4, s[24:27], s56 offen offset:0
s_mov_b32 s56, 0x11400
buffer_load_dword v54, v4, s[24:27], s56 offen offset:0
s_mov_b32 s56, 0x11c00
buffer_load_dword v55, v4, s[24:27], s56 offen offset:0
s_mov_b32 s56, 0x18000
buffer_load_dword v56, v4, s[24:27], s56 offen offset:0
s_mov_b32 s56, 0x18800
buffer_load_dword v57, v4, s[24:27], s56 offen offset:0
s_mov_b32 s56, 0x19000
buffer_load_dword v58, v4, s[24:27], s56 offen offset:0
s_mov_b32 s56, 0x19800
buffer_load_dword v59, v4, s[24:27], s56 offen offset:0
s_mov_b32 s56, 0x18400
buffer_load_dword v60, v4, s[24:27], s56 offen offset:0
s_mov_b32 s56, 0x18c00
buffer_load_dword v61, v4, s[24:27], s56 offen offset:0
s_mov_b32 s56, 0x19400
buffer_load_dword v62, v4, s[24:27], s56 offen offset:0
s_mov_b32 s56, 0x19c00
buffer_load_dword v63, v4, s[24:27], s56 offen offset:0
s_mov_b32 s56, 0x20000
buffer_load_dword v64, v4, s[24:27], s56 offen offset:0
s_mov_b32 s56, 0x20800
buffer_load_dword v65, v4, s[24:27], s56 offen offset:0
s_mov_b32 s56, 0x21000
buffer_load_dword v66, v4, s[24:27], s56 offen offset:0
s_mov_b32 s56, 0x21800
buffer_load_dword v67, v4, s[24:27], s56 offen offset:0
s_mov_b32 s56, 0x20400
buffer_load_dword v68, v4, s[24:27], s56 offen offset:0
s_mov_b32 s56, 0x20c00
buffer_load_dword v69, v4, s[24:27], s56 offen offset:0
s_mov_b32 s56, 0x21400
buffer_load_dword v70, v4, s[24:27], s56 offen offset:0
s_mov_b32 s56, 0x21c00
buffer_load_dword v71, v4, s[24:27], s56 offen offset:0
s_mov_b32 s56, 0x28000
buffer_load_dword v72, v4, s[24:27], s56 offen offset:0
s_mov_b32 s56, 0x28800
buffer_load_dword v73, v4, s[24:27], s56 offen offset:0
s_mov_b32 s56, 0x29000
buffer_load_dword v74, v4, s[24:27], s56 offen offset:0
s_mov_b32 s56, 0x29800
buffer_load_dword v75, v4, s[24:27], s56 offen offset:0
s_mov_b32 s56, 0x28400
buffer_load_dword v76, v4, s[24:27], s56 offen offset:0
s_mov_b32 s56, 0x28c00
buffer_load_dword v77, v4, s[24:27], s56 offen offset:0
s_mov_b32 s56, 0x29400
buffer_load_dword v78, v4, s[24:27], s56 offen offset:0
s_mov_b32 s56, 0x29c00
buffer_load_dword v79, v4, s[24:27], s56 offen offset:0
s_waitcnt vmcnt(32)
v_perm_b32 v144, v33, v32, s70
v_perm_b32 v148, v33, v32, s71
v_perm_b32 v145, v35, v34, s70
v_perm_b32 v149, v35, v34, s71
v_perm_b32 v146, v37, v36, s70
v_perm_b32 v150, v37, v36, s71
v_perm_b32 v147, v39, v38, s70
v_perm_b32 v151, v39, v38, s71
v_perm_b32 v152, v41, v40, s70
v_perm_b32 v156, v41, v40, s71
v_perm_b32 v153, v43, v42, s70
v_perm_b32 v157, v43, v42, s71
v_perm_b32 v154, v45, v44, s70
v_perm_b32 v158, v45, v44, s71
v_perm_b32 v155, v47, v46, s70
v_perm_b32 v159, v47, v46, s71
s_mov_b32 s56, 0x30000
buffer_load_dword v32, v4, s[24:27], s56 offen offset:0
s_mov_b32 s56, 0x30800
buffer_load_dword v33, v4, s[24:27], s56 offen offset:0
s_mov_b32 s56, 0x31000
buffer_load_dword v34, v4, s[24:27], s56 offen offset:0
s_mov_b32 s56, 0x31800
buffer_load_dword v35, v4, s[24:27], s56 offen offset:0
s_mov_b32 s56, 0x30400
buffer_load_dword v36, v4, s[24:27], s56 offen offset:0
s_mov_b32 s56, 0x30c00
buffer_load_dword v37, v4, s[24:27], s56 offen offset:0
s_mov_b32 s56, 0x31400
buffer_load_dword v38, v4, s[24:27], s56 offen offset:0
s_mov_b32 s56, 0x31c00
buffer_load_dword v39, v4, s[24:27], s56 offen offset:0
s_mov_b32 s56, 0x38000
buffer_load_dword v40, v4, s[24:27], s56 offen offset:0
s_mov_b32 s56, 0x38800
buffer_load_dword v41, v4, s[24:27], s56 offen offset:0
s_mov_b32 s56, 0x39000
buffer_load_dword v42, v4, s[24:27], s56 offen offset:0
s_mov_b32 s56, 0x39800
buffer_load_dword v43, v4, s[24:27], s56 offen offset:0
s_mov_b32 s56, 0x38400
buffer_load_dword v44, v4, s[24:27], s56 offen offset:0
s_mov_b32 s56, 0x38c00
buffer_load_dword v45, v4, s[24:27], s56 offen offset:0
s_mov_b32 s56, 0x39400
buffer_load_dword v46, v4, s[24:27], s56 offen offset:0
s_mov_b32 s56, 0x39c00
buffer_load_dword v47, v4, s[24:27], s56 offen offset:0
s_waitcnt vmcnt(32)
v_perm_b32 v160, v49, v48, s70
v_perm_b32 v164, v49, v48, s71
v_perm_b32 v161, v51, v50, s70
v_perm_b32 v165, v51, v50, s71
v_perm_b32 v162, v53, v52, s70
v_perm_b32 v166, v53, v52, s71
v_perm_b32 v163, v55, v54, s70
v_perm_b32 v167, v55, v54, s71
v_perm_b32 v168, v57, v56, s70
v_perm_b32 v172, v57, v56, s71
v_perm_b32 v169, v59, v58, s70
v_perm_b32 v173, v59, v58, s71
v_perm_b32 v170, v61, v60, s70
v_perm_b32 v174, v61, v60, s71
v_perm_b32 v171, v63, v62, s70
v_perm_b32 v175, v63, v62, s71
s_mov_b32 s56, 0x40000
buffer_load_dword v48, v4, s[24:27], s56 offen offset:0
s_mov_b32 s56, 0x40800
buffer_load_dword v49, v4, s[24:27], s56 offen offset:0
s_mov_b32 s56, 0x41000
buffer_load_dword v50, v4, s[24:27], s56 offen offset:0
s_mov_b32 s56, 0x41800
buffer_load_dword v51, v4, s[24:27], s56 offen offset:0
s_mov_b32 s56, 0x40400
buffer_load_dword v52, v4, s[24:27], s56 offen offset:0
s_mov_b32 s56, 0x40c00
buffer_load_dword v53, v4, s[24:27], s56 offen offset:0
s_mov_b32 s56, 0x41400
buffer_load_dword v54, v4, s[24:27], s56 offen offset:0
s_mov_b32 s56, 0x41c00
buffer_load_dword v55, v4, s[24:27], s56 offen offset:0
s_mov_b32 s56, 0x48000
buffer_load_dword v56, v4, s[24:27], s56 offen offset:0
s_mov_b32 s56, 0x48800
buffer_load_dword v57, v4, s[24:27], s56 offen offset:0
s_mov_b32 s56, 0x49000
buffer_load_dword v58, v4, s[24:27], s56 offen offset:0
s_mov_b32 s56, 0x49800
buffer_load_dword v59, v4, s[24:27], s56 offen offset:0
s_mov_b32 s56, 0x48400
buffer_load_dword v60, v4, s[24:27], s56 offen offset:0
s_mov_b32 s56, 0x48c00
buffer_load_dword v61, v4, s[24:27], s56 offen offset:0
s_mov_b32 s56, 0x49400
buffer_load_dword v62, v4, s[24:27], s56 offen offset:0
s_mov_b32 s56, 0x49c00
buffer_load_dword v63, v4, s[24:27], s56 offen offset:0
s_waitcnt vmcnt(32)
v_perm_b32 v176, v65, v64, s70
v_perm_b32 v180, v65, v64, s71
v_perm_b32 v177, v67, v66, s70
v_perm_b32 v181, v67, v66, s71
v_perm_b32 v178, v69, v68, s70
v_perm_b32 v182, v69, v68, s71
v_perm_b32 v179, v71, v70, s70
v_perm_b32 v183, v71, v70, s71
v_perm_b32 v184, v73, v72, s70
v_perm_b32 v188, v73, v72, s71
v_perm_b32 v185, v75, v74, s70
v_perm_b32 v189, v75, v74, s71
v_perm_b32 v186, v77, v76, s70
v_perm_b32 v190, v77, v76, s71
v_perm_b32 v187, v79, v78, s70
v_perm_b32 v191, v79, v78, s71
s_mov_b32 s56, 0x50000
buffer_load_dword v64, v4, s[24:27], s56 offen offset:0
s_mov_b32 s56, 0x50800
buffer_load_dword v65, v4, s[24:27], s56 offen offset:0
s_mov_b32 s56, 0x51000
buffer_load_dword v66, v4, s[24:27], s56 offen offset:0
s_mov_b32 s56, 0x51800
buffer_load_dword v67, v4, s[24:27], s56 offen offset:0
s_mov_b32 s56, 0x50400
buffer_load_dword v68, v4, s[24:27], s56 offen offset:0
s_mov_b32 s56, 0x50c00
buffer_load_dword v69, v4, s[24:27], s56 offen offset:0
s_mov_b32 s56, 0x51400
buffer_load_dword v70, v4, s[24:27], s56 offen offset:0
s_mov_b32 s56, 0x51c00
buffer_load_dword v71, v4, s[24:27], s56 offen offset:0
s_mov_b32 s56, 0x58000
buffer_load_dword v72, v4, s[24:27], s56 offen offset:0
s_mov_b32 s56, 0x58800
buffer_load_dword v73, v4, s[24:27], s56 offen offset:0
s_mov_b32 s56, 0x59000
buffer_load_dword v74, v4, s[24:27], s56 offen offset:0
s_mov_b32 s56, 0x59800
buffer_load_dword v75, v4, s[24:27], s56 offen offset:0
s_mov_b32 s56, 0x58400
buffer_load_dword v76, v4, s[24:27], s56 offen offset:0
s_mov_b32 s56, 0x58c00
buffer_load_dword v77, v4, s[24:27], s56 offen offset:0
s_mov_b32 s56, 0x59400
buffer_load_dword v78, v4, s[24:27], s56 offen offset:0
s_mov_b32 s56, 0x59c00
buffer_load_dword v79, v4, s[24:27], s56 offen offset:0
s_waitcnt vmcnt(32)
v_perm_b32 v192, v33, v32, s70
v_perm_b32 v196, v33, v32, s71
v_perm_b32 v193, v35, v34, s70
v_perm_b32 v197, v35, v34, s71
v_perm_b32 v194, v37, v36, s70
v_perm_b32 v198, v37, v36, s71
v_perm_b32 v195, v39, v38, s70
v_perm_b32 v199, v39, v38, s71
v_perm_b32 v200, v41, v40, s70
v_perm_b32 v204, v41, v40, s71
v_perm_b32 v201, v43, v42, s70
v_perm_b32 v205, v43, v42, s71
v_perm_b32 v202, v45, v44, s70
v_perm_b32 v206, v45, v44, s71
v_perm_b32 v203, v47, v46, s70
v_perm_b32 v207, v47, v46, s71
s_mov_b32 s56, 0x60000
buffer_load_dword v32, v4, s[24:27], s56 offen offset:0
s_mov_b32 s56, 0x60800
buffer_load_dword v33, v4, s[24:27], s56 offen offset:0
s_mov_b32 s56, 0x61000
buffer_load_dword v34, v4, s[24:27], s56 offen offset:0
s_mov_b32 s56, 0x61800
buffer_load_dword v35, v4, s[24:27], s56 offen offset:0
s_mov_b32 s56, 0x60400
buffer_load_dword v36, v4, s[24:27], s56 offen offset:0
s_mov_b32 s56, 0x60c00
buffer_load_dword v37, v4, s[24:27], s56 offen offset:0
s_mov_b32 s56, 0x61400
buffer_load_dword v38, v4, s[24:27], s56 offen offset:0
s_mov_b32 s56, 0x61c00
buffer_load_dword v39, v4, s[24:27], s56 offen offset:0
s_mov_b32 s56, 0x68000
buffer_load_dword v40, v4, s[24:27], s56 offen offset:0
s_mov_b32 s56, 0x68800
buffer_load_dword v41, v4, s[24:27], s56 offen offset:0
s_mov_b32 s56, 0x69000
buffer_load_dword v42, v4, s[24:27], s56 offen offset:0
s_mov_b32 s56, 0x69800
buffer_load_dword v43, v4, s[24:27], s56 offen offset:0
s_mov_b32 s56, 0x68400
buffer_load_dword v44, v4, s[24:27], s56 offen offset:0
s_mov_b32 s56, 0x68c00
buffer_load_dword v45, v4, s[24:27], s56 offen offset:0
s_mov_b32 s56, 0x69400
buffer_load_dword v46, v4, s[24:27], s56 offen offset:0
s_mov_b32 s56, 0x69c00
buffer_load_dword v47, v4, s[24:27], s56 offen offset:0
s_waitcnt vmcnt(32)
v_perm_b32 v208, v49, v48, s70
v_perm_b32 v212, v49, v48, s71
v_perm_b32 v209, v51, v50, s70
v_perm_b32 v213, v51, v50, s71
v_perm_b32 v210, v53, v52, s70
v_perm_b32 v214, v53, v52, s71
v_perm_b32 v211, v55, v54, s70
v_perm_b32 v215, v55, v54, s71
v_perm_b32 v216, v57, v56, s70
v_perm_b32 v220, v57, v56, s71
v_perm_b32 v217, v59, v58, s70
v_perm_b32 v221, v59, v58, s71
v_perm_b32 v218, v61, v60, s70
v_perm_b32 v222, v61, v60, s71
v_perm_b32 v219, v63, v62, s70
v_perm_b32 v223, v63, v62, s71
s_waitcnt vmcnt(16)
v_perm_b32 v224, v65, v64, s70
v_perm_b32 v228, v65, v64, s71
v_perm_b32 v225, v67, v66, s70
v_perm_b32 v229, v67, v66, s71
v_perm_b32 v226, v69, v68, s70
v_perm_b32 v230, v69, v68, s71
v_perm_b32 v227, v71, v70, s70
v_perm_b32 v231, v71, v70, s71
v_perm_b32 v232, v73, v72, s70
v_perm_b32 v236, v73, v72, s71
v_perm_b32 v233, v75, v74, s70
v_perm_b32 v237, v75, v74, s71
v_perm_b32 v234, v77, v76, s70
v_perm_b32 v238, v77, v76, s71
v_perm_b32 v235, v79, v78, s70
v_perm_b32 v239, v79, v78, s71
s_waitcnt vmcnt(0)
v_perm_b32 v240, v33, v32, s70
v_perm_b32 v244, v33, v32, s71
v_perm_b32 v241, v35, v34, s70
v_perm_b32 v245, v35, v34, s71
v_perm_b32 v242, v37, v36, s70
v_perm_b32 v246, v37, v36, s71
v_perm_b32 v243, v39, v38, s70
v_perm_b32 v247, v39, v38, s71
v_perm_b32 v248, v41, v40, s70
v_perm_b32 v252, v41, v40, s71
v_perm_b32 v249, v43, v42, s70
v_perm_b32 v253, v43, v42, s71
v_perm_b32 v250, v45, v44, s70
v_perm_b32 v254, v45, v44, s71
v_perm_b32 v251, v47, v46, s70
v_perm_b32 v255, v47, v46, s71
s_lshr_b32 s58, s39, 5
s_mov_b64 exec, 0x1ff
v_lshlrev_b32 v4, 2, v0
v_cmp_eq_u32 vcc, 0, v0
v_mov_b32 v5, 128
s_nop 0
v_cndmask_b32 v4, v4, v5, vcc
s_mov_b32 s57, 0
L_loc:
global_load_dword v5, v4, s[36:37] sc1
s_add_u32 s57, s57, 1
s_cmp_ge_u32 s57, 524288
s_cbranch_scc1 L_end
s_waitcnt vmcnt(0)
v_readlane_b32 s56, v5, s58
s_mov_b32 s43, 1
s_cmp_ge_u32 s56, 32
s_cbranch_scc1 L_loc_ok
s_mov_b32 s43, 0
s_mov_b32 s61, 0
v_readlane_b32 s56, v5, 0
s_add_u32 s61, s61, s56
v_readlane_b32 s56, v5, 1
s_add_u32 s61, s61, s56
v_readlane_b32 s56, v5, 2
s_add_u32 s61, s61, s56
v_readlane_b32 s56, v5, 3
s_add_u32 s61, s61, s56
v_readlane_b32 s56, v5, 4
s_add_u32 s61, s61, s56
v_readlane_b32 s56, v5, 5
s_add_u32 s61, s61, s56
v_readlane_b32 s56, v5, 6
s_add_u32 s61, s61, s56
v_readlane_b32 s56, v5, 7
s_add_u32 s61, s61, s56
v_readlane_b32 s56, v5, 8
s_add_u32 s61, s61, s56
s_cmp_lt_u32 s61, 256
s_cbranch_scc1 L_loc
L_loc_ok:
s_mov_b64 exec, -1
v_min_u32 v4, 54, v0
v_lshlrev_b32 v4, 2, v4
v_lshlrev_b32 v5, 10, v1
v_lshlrev_b32 v6, 4, v2
s_lshl_b32 s56, s63, 6
v_add3_u32 v5, v5, v6, s56
v_and_b32 v6, 7, v1
v_lshlrev_b32 v6, 4, v6
v_lshlrev_b32 v7, 8, v2
v_add3_u32 v6, v6, v7, 64
v_add_u32 v6, 64, v6
v_and_b32 v7, 7, v0
v_lshlrev_b32 v7, 2, v7
s_lshl_b32 s64, s63, 1
s_add_u32 s64, s64, s38
s_lshl_b32 s56, s38, 11
v_add_u32 v142, s56, v3
s_lshl_b32 s63, s60, 18
s_add_u32 s63, s63, 67108864
s_mov_b32 s59, 0
s_mov_b32 s76, 0
L_s2_item:
s_cmp_ge_u32 s60, 124
s_cselect_b32 s44, 0x00ff00ff, -1
s_cmp_ge_u32 s60, 130
s_cselect_b32 s41, 6, 2
s_sub_u32 s41, s60, s41
s_cmp_ge_u32 s60, 128
s_cselect_b32 s44, 0xff00ff00, s44
s_cselect_b32 s41, s41, s60
s_mov_b32 s45, s44
s_lshr_b32 s61, s41, 1
s_and_b32 s62, s41, 1
s_mul_i32 s56, s61, 0x5556
s_lshr_b32 s56, s56, 16
s_mul_i32 s56, s56, 3
s_sub_u32 s56, s61, s56
s_bitcmp1_b32 s59, s56
s_cbranch_scc1 L_s2_s1ok
s_lshl_b32 s56, s56, 8
s_add_u32 s58, s56, 1024
s_mov_b32 s57, 0
L_wf_52:
buffer_load_dword v140, v4, s[4:7], s58 offen offset:0 sc1
s_add_u32 s57, s57, 1
s_cmp_ge_u32 s57, 524288
s_cbranch_scc1 L_end
s_waitcnt vmcnt(0)
v_cmp_ge_u32 vcc, s61, v140
s_cbranch_vccnz L_wf_52
v_cmp_gt_u32 vcc, 64, v140
s_cbranch_vccnz L_s2_s1ok
s_mul_i32 s56, s61, 0x5556
s_lshr_b32 s56, s56, 16
s_mul_i32 s56, s56, 3
s_sub_u32 s56, s61, s56
s_bitset1_b32 s59, s56
L_s2_s1ok:
s_cmp_ge_u32 s38, 2
s_cbranch_scc1 L_s2_noatt
s_add_u32 s56, s61, 1
s_cmp_lt_u32 s61, 62
s_cselect_b32 s56, s56, -1
s_cmp_gt_u32 s76, s56
s_cbranch_scc1 L_s2_ready
s_lshl_b32 s56, s61, 5
s_add_u32 s56, s56, s64
s_lshl_b32 s65, s56, 13
s_lshl_b32 s58, s62, 10
s_add_u32 s66, s65, s58
s_add_u32 s66, s66, 16777216
s_add_u32 s67, s66, 0x1000
s_add_u32 s68, s65, 33554432
s_add_u32 s69, s68, 0x1000
s_add_u32 s72, s65, 50331648
s_add_u32 s73, s72, 0x1000
buffer_load_dwordx4 v[16:19], v3, s[4:7], s66 offen offset:0 sc1
buffer_load_dwordx4 v[20:23], v3, s[4:7], s66 offen offset:2048 sc1
buffer_load_dwordx4 v[24:27], v3, s[4:7], s67 offen offset:0 sc1
buffer_load_dwordx4 v[28:31], v3, s[4:7], s67 offen offset:2048 sc1
buffer_load_dwordx4 v[32:35], v3, s[4:7], s68 offen offset:0 sc1
buffer_load_dwordx4 v[36:39], v3, s[4:7], s68 offen offset:1024 sc1
buffer_load_dwordx4 v[40:43], v3, s[4:7], s68 offen offset:2048 sc1
buffer_load_dwordx4 v[44:47], v3, s[4:7], s68 offen offset:3072 sc1
buffer_load_dwordx4 v[48:51], v3, s[4:7], s69 offen offset:0 sc1
buffer_load_dwordx4 v[52:55], v3, s[4:7], s69 offen offset:1024 sc1
buffer_load_dwordx4 v[56:59], v3, s[4:7], s69 offen offset:2048 sc1
buffer_load_dwordx4 v[60:63], v3, s[4:7], s69 offen offset:3072 sc1
buffer_load_dwordx4 v[96:99], v3, s[4:7], s72 offen offset:0 sc1
buffer_load_dwordx4 v[100:103], v3, s[4:7], s72 offen offset:1024 sc1
buffer_load_dwordx4 v[104:107], v3, s[4:7], s72 offen offset:2048 sc1
buffer_load_dwordx4 v[108:111], v3, s[4:7], s72 offen offset:3072 sc1
buffer_load_dwordx4 v[112:115], v3, s[4:7], s73 offen offset:0 sc1
buffer_load_dwordx4 v[116:119], v3, s[4:7], s73 offen offset:1024 sc1
buffer_load_dwordx4 v[120:123], v3, s[4:7], s73 offen offset:2048 sc1
buffer_load_dwordx4 v[124:127], v3, s[4:7], s73 offen offset:3072 sc1
s_lshr_b32 s58, s42, 4
s_lshl_b32 s58, s58, 7
s_add_u32 s74, s58, 2048
s_add_u32 s75, s61, 1
s_cmp_ge_u32 s61, 58
s_cselect_b32 s75, s61, s75
s_min_u32 s75, s75, 61
v_mov_b32 v143, 0
s_lshl_b32 s56, s62, 4
v_lshlrev_b32 v140, 2, v2
v_sub_u32 v140, v1, v140
v_add_u32 v140, s56, v140
v_mov_b32 v141, 0xf149f2ca
s_waitcnt vmcnt(8)
v_mfma_f32_16x16x32_bf16 v[128:131], v[32:35], v[16:19], 0
v_mfma_f32_16x16x32_bf16 v[132:135], v[36:39], v[16:19], 0
v_mfma_f32_16x16x32_bf16 v[128:131], v[40:43], v[20:23], v[128:131]
v_mfma_f32_16x16x32_bf16 v[132:135], v[44:47], v[20:23], v[132:135]
v_mfma_f32_16x16x32_bf16 v[128:131], v[48:51], v[24:27], v[128:131]
v_mfma_f32_16x16x32_bf16 v[132:135], v[52:55], v[24:27], v[132:135]
v_mfma_f32_16x16x32_bf16 v[128:131], v[56:59], v[28:31], v[128:131]
v_mfma_f32_16x16x32_bf16 v[132:135], v[60:63], v[28:31], v[132:135]
v_cmp_le_i32 vcc, 0, v140
s_nop 2
v_cndmask_b32 v128, v141, v128, vcc
v_cmp_le_i32 vcc, 1, v140
s_nop 1
v_cndmask_b32 v129, v141, v129, vcc
v_cmp_le_i32 vcc, 2, v140
s_nop 1
v_cndmask_b32 v130, v141, v130, vcc
v_cmp_le_i32 vcc, 3, v140
s_nop 1
v_cndmask_b32 v131, v141, v131, vcc
v_cmp_le_i32 vcc, 16, v140
s_nop 1
v_cndmask_b32 v132, v141, v132, vcc
v_cmp_le_i32 vcc, 17, v140
s_nop 1
v_cndmask_b32 v133, v141, v133, vcc
v_cmp_le_i32 vcc, 18, v140
s_nop 1
v_cndmask_b32 v134, v141, v134, vcc
v_cmp_le_i32 vcc, 19, v140
s_nop 1
v_cndmask_b32 v135, v141, v135, vcc
s_lshl_b32 s56, s41, 14
s_cmp_ge_u32 s60, 124
s_cselect_b32 s56, s56, 0x7ff00000
s_cmp_eq_u32 s38, 0
s_cselect_b32 s56, s56, 0x7ff00000
buffer_load_dwordx4 v[88:91], v5, s[8:11], s56 offen
s_mul_i32 s77, s41, 56
s_mul_i32 s56, s38, 14
s_add_u32 s77, s77, s56
s_lshl_b32 s77, s77, 10
s_add_u32 s77, s77, 83886080
buffer_load_dwordx4 v[32:35], v3, s[4:7], s77 offen offset:0 sc1
buffer_load_dwordx4 v[36:39], v3, s[4:7], s77 offen offset:1024 sc1
buffer_load_dwordx4 v[40:43], v3, s[4:7], s77 offen offset:2048 sc1
buffer_load_dwordx4 v[44:47], v3, s[4:7], s77 offen offset:3072 sc1
s_add_u32 s77, s77, 0x1000
buffer_load_dwordx4 v[48:51], v3, s[4:7], s77 offen offset:0 sc1
buffer_load_dwordx4 v[52:55], v3, s[4:7], s77 offen offset:1024 sc1
buffer_load_dwordx4 v[56:59], v3, s[4:7], s77 offen offset:2048 sc1
buffer_load_dwordx4 v[60:63], v3, s[4:7], s77 offen offset:3072 sc1
s_add_u32 s77, s77, 0x1000
buffer_load_dwordx4 v[64:67], v3, s[4:7], s77 offen offset:0 sc1
buffer_load_dwordx4 v[68:71], v3, s[4:7], s77 offen offset:1024 sc1
buffer_load_dwordx4 v[72:75], v3, s[4:7], s77 offen offset:2048 sc1
buffer_load_dwordx4 v[76:79], v3, s[4:7], s77 offen offset:3072 sc1
s_add_u32 s77, s77, 0x1000
buffer_load_dwordx4 v[80:83], v3, s[4:7], s77 offen offset:0 sc1
buffer_load_dwordx4 v[84:87], v3, s[4:7], s77 offen offset:1024 sc1
s_waitcnt vmcnt(13)
v_mfma_f32_16x16x32_bf16 v[8:11], v[144:147], v[32:35], 0
v_mfma_f32_16x16x32_bf16 v[12:15], v[148:151], v[32:35], 0
s_waitcnt vmcnt(12)
v_mfma_f32_16x16x32_bf16 v[8:11], v[152:155], v[36:39], v[8:11]
v_mfma_f32_16x16x32_bf16 v[12:15], v[156:159], v[36:39], v[12:15]
s_waitcnt vmcnt(11)
v_mfma_f32_16x16x32_bf16 v[8:11], v[160:163], v[40:43], v[8:11]
v_mfma_f32_16x16x32_bf16 v[12:15], v[164:167], v[40:43], v[12:15]
s_waitcnt vmcnt(10)
v_mfma_f32_16x16x32_bf16 v[8:11], v[168:171], v[44:47], v[8:11]
v_mfma_f32_16x16x32_bf16 v[12:15], v[172:175], v[44:47], v[12:15]
s_waitcnt vmcnt(9)
v_mfma_f32_16x16x32_bf16 v[8:11], v[176:179], v[48:51], v[8:11]
v_mfma_f32_16x16x32_bf16 v[12:15], v[180:183], v[48:51], v[12:15]
s_waitcnt vmcnt(8)
v_mfma_f32_16x16x32_bf16 v[8:11], v[184:187], v[52:55], v[8:11]
v_mfma_f32_16x16x32_bf16 v[12:15], v[188:191], v[52:55], v[12:15]
s_waitcnt vmcnt(7)
v_mfma_f32_16x16x32_bf16 v[8:11], v[192:195], v[56:59], v[8:11]
v_mfma_f32_16x16x32_bf16 v[12:15], v[196:199], v[56:59], v[12:15]
s_waitcnt vmcnt(6)
v_mfma_f32_16x16x32_bf16 v[8:11], v[200:203], v[60:63], v[8:11]
v_mfma_f32_16x16x32_bf16 v[12:15], v[204:207], v[60:63], v[12:15]
s_waitcnt vmcnt(5)
v_mfma_f32_16x16x32_bf16 v[8:11], v[208:211], v[64:67], v[8:11]
v_mfma_f32_16x16x32_bf16 v[12:15], v[212:215], v[64:67], v[12:15]
s_waitcnt vmcnt(4)
v_mfma_f32_16x16x32_bf16 v[8:11], v[216:219], v[68:71], v[8:11]
v_mfma_f32_16x16x32_bf16 v[12:15], v[220:223], v[68:71], v[12:15]
s_waitcnt vmcnt(3)
v_mfma_f32_16x16x32_bf16 v[8:11], v[224:227], v[72:75], v[8:11]
v_mfma_f32_16x16x32_bf16 v[12:15], v[228:231], v[72:75], v[12:15]
s_waitcnt vmcnt(2)
v_mfma_f32_16x16x32_bf16 v[8:11], v[232:235], v[76:79], v[8:11]
v_mfma_f32_16x16x32_bf16 v[12:15], v[236:239], v[76:79], v[12:15]
s_waitcnt vmcnt(1)
v_mfma_f32_16x16x32_bf16 v[8:11], v[240:243], v[80:83], v[8:11]
v_mfma_f32_16x16x32_bf16 v[12:15], v[244:247], v[80:83], v[12:15]
s_waitcnt vmcnt(0)
v_mfma_f32_16x16x32_bf16 v[8:11], v[248:251], v[84:87], v[8:11]
v_mfma_f32_16x16x32_bf16 v[12:15], v[252:255], v[84:87], v[12:15]
v_lshlrev_b32 v92, 16, v88
v_and_b32 v88, 0xffff0000, v88
v_lshlrev_b32 v93, 16, v89
v_and_b32 v89, 0xffff0000, v89
v_lshlrev_b32 v94, 16, v90
v_and_b32 v90, 0xffff0000, v90
v_lshlrev_b32 v95, 16, v91
v_and_b32 v91, 0xffff0000, v91
v_add_f32 v8, v8, v92
v_add_f32 v12, v12, v88
v_add_f32 v9, v9, v93
v_add_f32 v13, v13, v89
v_add_f32 v10, v10, v94
v_add_f32 v14, v14, v90
v_add_f32 v11, v11, v95
v_add_f32 v15, v15, v91
s_mov_b32 s57, 0
L_wf_53:
buffer_load_dword v141, v143, s[4:7], s74 offen offset:0 sc1
s_add_u32 s57, s57, 1
s_cmp_ge_u32 s57, 524288
s_cbranch_scc1 L_end
s_waitcnt vmcnt(0)
v_cmp_ge_u32 vcc, s75, v141
s_cbranch_vccnz L_wf_53
L_tg_k0:
s_mov_b32 s57, 0
L_tg_k:
s_add_u32 s78, s65, 100925440
s_add_u32 s79, s78, 0x1000
buffer_load_dwordx4 v[64:67], v6, s[4:7], s78 offen offset:0 sc1
buffer_load_dwordx4 v[68:71], v6, s[4:7], s78 offen offset:2048 sc1
buffer_load_dwordx4 v[72:75], v6, s[4:7], s79 offen offset:0 sc1
buffer_load_dwordx4 v[76:79], v6, s[4:7], s79 offen offset:2048 sc1
buffer_load_dwordx4 v[80:83], v3, s[4:7], s78 offen offset:1024 sc1
buffer_load_dwordx4 v[84:87], v3, s[4:7], s78 offen offset:3072 sc1
buffer_load_dwordx4 v[88:91], v3, s[4:7], s79 offen offset:1024 sc1
buffer_load_dwordx4 v[92:95], v3, s[4:7], s79 offen offset:3072 sc1
s_waitcnt vmcnt(4)
v_max3_u32 v141, v64, v68, v72
s_add_u32 s57, s57, 1
v_max_u32 v141, v141, v76
s_cmp_ge_u32 s57, 524288
v_cmp_eq_u32 vcc, -1, v141
s_cbranch_scc1 L_end
s_cbranch_vccnz L_tg_k
v_mfma_f32_16x16x32_bf16 v[136:139], v[64:67], v[16:19], 0
v_mfma_f32_16x16x32_bf16 v[136:139], v[68:71], v[20:23], v[136:139]
v_mfma_f32_16x16x32_bf16 v[136:139], v[72:75], v[24:27], v[136:139]
v_mfma_f32_16x16x32_bf16 v[136:139], v[76:79], v[28:31], v[136:139]
v_max3_f32 v140, v128, v129, v130
v_max3_f32 v141, v131, v132, v133
v_max3_f32 v140, v140, v134, v135
v_max_f32 v140, v140, v141
s_nop 3
v_max3_f32 v141, v136, v137, v138
v_max3_f32 v140, v140, v141, v139
v_mov_b32 v141, v140
s_nop 1
v_permlane16_swap_b32 v140, v141
v_max_f32 v140, v140, v141
v_mov_b32 v141, v140
s_nop 1
v_permlane32_swap_b32 v140, v141
v_max_f32 v140, v140, v141
s_mov_b32 s56, 0x3e0293ee
v_mul_f32 v140, s56, v140
v_fma_f32 v128, v128, s56, -v140
v_fma_f32 v129, v129, s56, -v140
v_fma_f32 v130, v130, s56, -v140
v_fma_f32 v131, v131, s56, -v140
v_fma_f32 v132, v132, s56, -v140
v_fma_f32 v133, v133, s56, -v140
v_fma_f32 v134, v134, s56, -v140
v_fma_f32 v135, v135, s56, -v140
v_fma_f32 v136, v136, s56, -v140
v_fma_f32 v137, v137, s56, -v140
v_fma_f32 v138, v138, s56, -v140
v_fma_f32 v139, v139, s56, -v140
v_exp_f32 v128, v128
v_exp_f32 v129, v129
v_exp_f32 v130, v130
v_exp_f32 v131, v131
v_exp_f32 v132, v132
v_exp_f32 v133, v133
v_exp_f32 v134, v134
v_exp_f32 v135, v135
v_exp_f32 v136, v136
v_exp_f32 v137, v137
v_exp_f32 v138, v138
v_exp_f32 v139, v139
v_mov_b32 v24, 0x3f803f80
v_mov_b32 v25, 0x3f803f80
v_mov_b32 v26, 0x3f803f80
v_mov_b32 v27, 0x3f803f80
v_cvt_pk_bf16_f32 v16, v128, v129
v_cvt_pk_bf16_f32 v17, v130, v131
v_cvt_pk_bf16_f32 v18, v132, v133
v_cvt_pk_bf16_f32 v19, v134, v135
v_cvt_pk_bf16_f32 v20, v136, v137
v_cvt_pk_bf16_f32 v21, v138, v139
v_mfma_f32_16x16x32_bf16 v[28:31], v[24:27], v[16:19], 0
s_nop 0
v_mfma_f32_16x16x16_bf16 v[64:67], v[24:25], v[20:21], 0
v_mfma_f32_16x16x32_bf16 v[32:35], v[96:99], v[16:19], 0
v_mfma_f32_16x16x32_bf16 v[36:39], v[100:103], v[16:19], 0
v_mfma_f32_16x16x32_bf16 v[40:43], v[104:107], v[16:19], 0
v_mfma_f32_16x16x32_bf16 v[44:47], v[108:111], v[16:19], 0
v_mfma_f32_16x16x32_bf16 v[48:51], v[112:115], v[16:19], 0
v_mfma_f32_16x16x32_bf16 v[52:55], v[116:119], v[16:19], 0
v_mfma_f32_16x16x32_bf16 v[56:59], v[120:123], v[16:19], 0
v_mfma_f32_16x16x32_bf16 v[60:63], v[124:127], v[16:19], 0
s_branch L_tg_vw
L_tg_v:
buffer_load_dwordx4 v[80:83], v3, s[4:7], s78 offen offset:1024 sc1
buffer_load_dwordx4 v[84:87], v3, s[4:7], s78 offen offset:3072 sc1
buffer_load_dwordx4 v[88:91], v3, s[4:7], s79 offen offset:1024 sc1
buffer_load_dwordx4 v[92:95], v3, s[4:7], s79 offen offset:3072 sc1
L_tg_vw:
s_waitcnt vmcnt(0)
v_max3_u32 v141, v80, v84, v88
s_add_u32 s57, s57, 1
v_max_u32 v141, v141, v92
s_cmp_ge_u32 s57, 524288
v_cmp_eq_u32 vcc, -1, v141
s_cbranch_scc1 L_end
s_cbranch_vccnz L_tg_v
v_mfma_f32_16x16x16_bf16 v[32:35], v[80:81], v[20:21], v[32:35]
v_mfma_f32_16x16x16_bf16 v[36:39], v[82:83], v[20:21], v[36:39]
v_mfma_f32_16x16x16_bf16 v[40:43], v[84:85], v[20:21], v[40:43]
v_mfma_f32_16x16x16_bf16 v[44:47], v[86:87], v[20:21], v[44:47]
v_mfma_f32_16x16x16_bf16 v[48:51], v[88:89], v[20:21], v[48:51]
v_mfma_f32_16x16x16_bf16 v[52:55], v[90:91], v[20:21], v[52:55]
v_mfma_f32_16x16x16_bf16 v[56:59], v[92:93], v[20:21], v[56:59]
v_mfma_f32_16x16x16_bf16 v[60:63], v[94:95], v[20:21], v[60:63]
v_fma_f32 v28, v64, 0.5, v28
v_rcp_f32 v28, v28
s_lshl_b32 s66, s64, 12
s_add_u32 s66, s66, s63
s_lshl_b32 s56, s60, 5
s_add_u32 s56, s56, s64
s_lshl_b32 s67, s56, 2
s_add_u32 s67, s67, 7168
v_pk_mul_f32 v[32:33], v[32:33], v[28:29] op_sel_hi:[1,0]
v_pk_mul_f32 v[34:35], v[34:35], v[28:29] op_sel_hi:[1,0]
v_pk_mul_f32 v[36:37], v[36:37], v[28:29] op_sel_hi:[1,0]
v_pk_mul_f32 v[38:39], v[38:39], v[28:29] op_sel_hi:[1,0]
v_cvt_pk_bf16_f32 v32, v32, v33
v_cvt_pk_bf16_f32 v33, v34, v35
v_cvt_pk_bf16_f32 v34, v36, v37
v_cvt_pk_bf16_f32 v35, v38, v39
v_pk_mul_f32 v[40:41], v[40:41], v[28:29] op_sel_hi:[1,0]
v_pk_mul_f32 v[42:43], v[42:43], v[28:29] op_sel_hi:[1,0]
v_pk_mul_f32 v[44:45], v[44:45], v[28:29] op_sel_hi:[1,0]
v_pk_mul_f32 v[46:47], v[46:47], v[28:29] op_sel_hi:[1,0]
v_cvt_pk_bf16_f32 v40, v40, v41
v_cvt_pk_bf16_f32 v41, v42, v43
v_cvt_pk_bf16_f32 v42, v44, v45
v_cvt_pk_bf16_f32 v43, v46, v47
v_pk_mul_f32 v[48:49], v[48:49], v[28:29] op_sel_hi:[1,0]
v_pk_mul_f32 v[50:51], v[50:51], v[28:29] op_sel_hi:[1,0]
v_pk_mul_f32 v[52:53], v[52:53], v[28:29] op_sel_hi:[1,0]
v_pk_mul_f32 v[54:55], v[54:55], v[28:29] op_sel_hi:[1,0]
v_cvt_pk_bf16_f32 v48, v48, v49
v_cvt_pk_bf16_f32 v49, v50, v51
v_cvt_pk_bf16_f32 v50, v52, v53
v_cvt_pk_bf16_f32 v51, v54, v55
v_pk_mul_f32 v[56:57], v[56:57], v[28:29] op_sel_hi:[1,0]
v_pk_mul_f32 v[58:59], v[58:59], v[28:29] op_sel_hi:[1,0]
v_pk_mul_f32 v[60:61], v[60:61], v[28:29] op_sel_hi:[1,0]
v_pk_mul_f32 v[62:63], v[62:63], v[28:29] op_sel_hi:[1,0]
v_cvt_pk_bf16_f32 v56, v56, v57
v_cvt_pk_bf16_f32 v57, v58, v59
v_cvt_pk_bf16_f32 v58, v60, v61
v_cvt_pk_bf16_f32 v59, v62, v63
v_mov_b32 v141, 1
v_lshlrev_b32 v140, 2, v3
s_cmp_eq_u32 s43, 0
s_cbranch_scc1 L_ofar_54
s_cmp_lt_u32 s60, 124
s_cbranch_scc1 L_ofull_56
s_sub_u32 s56, s66, 128
s_mov_b64 exec, s[44:45]
buffer_store_dwordx4 v[32:35], v6, s[4:7], s56 offen offset:0
buffer_store_dwordx4 v[40:43], v6, s[4:7], s56 offen offset:128
buffer_store_dwordx4 v[48:51], v6, s[4:7], s56 offen offset:1024
buffer_store_dwordx4 v[56:59], v6, s[4:7], s56 offen offset:1152
s_mov_b64 exec, -1
s_branch L_ojoin_57
L_ofull_56:
buffer_store_dwordx4 v[32:35], v3, s[4:7], s66 offen offset:0
buffer_store_dwordx4 v[40:43], v3, s[4:7], s66 offen offset:1024
buffer_store_dwordx4 v[48:51], v3, s[4:7], s66 offen offset:2048
buffer_store_dwordx4 v[56:59], v3, s[4:7], s66 offen offset:3072
L_ojoin_57:
buffer_load_dword v140, v140, s[4:7], s66 offen sc1
s_waitcnt vmcnt(0)
s_mov_b64 exec, 1
buffer_store_dword v141, off, s[4:7], s67
s_mov_b64 exec, -1
s_branch L_odone_55
L_ofar_54:
s_cmp_lt_u32 s60, 124
s_cbranch_scc1 L_ofull_58
s_sub_u32 s56, s66, 128
s_mov_b64 exec, s[44:45]
buffer_store_dwordx4 v[32:35], v6, s[4:7], s56 offen offset:0 sc1
buffer_store_dwordx4 v[40:43], v6, s[4:7], s56 offen offset:128 sc1
buffer_store_dwordx4 v[48:51], v6, s[4:7], s56 offen offset:1024 sc1
buffer_store_dwordx4 v[56:59], v6, s[4:7], s56 offen offset:1152 sc1
s_mov_b64 exec, -1
s_branch L_ojoin_59
L_ofull_58:
buffer_store_dwordx4 v[32:35], v3, s[4:7], s66 offen offset:0 sc1
buffer_store_dwordx4 v[40:43], v3, s[4:7], s66 offen offset:1024 sc1
buffer_store_dwordx4 v[48:51], v3, s[4:7], s66 offen offset:2048 sc1
buffer_store_dwordx4 v[56:59], v3, s[4:7], s66 offen offset:3072 sc1
L_ojoin_59:
s_waitcnt vmcnt(0)
s_mov_b64 exec, 1
buffer_store_dword v141, off, s[4:7], s67 sc1
s_mov_b64 exec, -1
L_odone_55:
s_branch L_s2_att
L_s2_ready:
s_lshl_b32 s56, s61, 5
s_add_u32 s56, s56, s64
s_lshl_b32 s65, s56, 13
s_lshl_b32 s58, s62, 10
s_add_u32 s66, s65, s58
s_add_u32 s66, s66, 16777216
s_add_u32 s67, s66, 0x1000
s_add_u32 s68, s65, 33554432
s_add_u32 s69, s68, 0x1000
s_add_u32 s72, s65, 50331648
s_add_u32 s73, s72, 0x1000
buffer_load_dwordx4 v[16:19], v3, s[4:7], s66 offen offset:0 sc1
buffer_load_dwordx4 v[20:23], v3, s[4:7], s66 offen offset:2048 sc1
buffer_load_dwordx4 v[24:27], v3, s[4:7], s67 offen offset:0 sc1
buffer_load_dwordx4 v[28:31], v3, s[4:7], s67 offen offset:2048 sc1
buffer_load_dwordx4 v[32:35], v3, s[4:7], s68 offen offset:0 sc1
buffer_load_dwordx4 v[36:39], v3, s[4:7], s68 offen offset:1024 sc1
buffer_load_dwordx4 v[40:43], v3, s[4:7], s68 offen offset:2048 sc1
buffer_load_dwordx4 v[44:47], v3, s[4:7], s68 offen offset:3072 sc1
buffer_load_dwordx4 v[48:51], v3, s[4:7], s69 offen offset:0 sc1
buffer_load_dwordx4 v[52:55], v3, s[4:7], s69 offen offset:1024 sc1
buffer_load_dwordx4 v[56:59], v3, s[4:7], s69 offen offset:2048 sc1
buffer_load_dwordx4 v[60:63], v3, s[4:7], s69 offen offset:3072 sc1
s_add_u32 s78, s65, 100925440
s_add_u32 s79, s78, 0x1000
buffer_load_dwordx4 v[64:67], v6, s[4:7], s78 offen offset:0 sc1
buffer_load_dwordx4 v[68:71], v6, s[4:7], s78 offen offset:2048 sc1
buffer_load_dwordx4 v[72:75], v6, s[4:7], s79 offen offset:0 sc1
buffer_load_dwordx4 v[76:79], v6, s[4:7], s79 offen offset:2048 sc1
buffer_load_dwordx4 v[96:99], v3, s[4:7], s72 offen offset:0 sc1
buffer_load_dwordx4 v[100:103], v3, s[4:7], s72 offen offset:1024 sc1
buffer_load_dwordx4 v[104:107], v3, s[4:7], s72 offen offset:2048 sc1
buffer_load_dwordx4 v[108:111], v3, s[4:7], s72 offen offset:3072 sc1
buffer_load_dwordx4 v[112:115], v3, s[4:7], s73 offen offset:0 sc1
buffer_load_dwordx4 v[116:119], v3, s[4:7], s73 offen offset:1024 sc1
buffer_load_dwordx4 v[120:123], v3, s[4:7], s73 offen offset:2048 sc1
buffer_load_dwordx4 v[124:127], v3, s[4:7], s73 offen offset:3072 sc1
buffer_load_dwordx4 v[80:83], v3, s[4:7], s78 offen offset:1024 sc1
buffer_load_dwordx4 v[84:87], v3, s[4:7], s78 offen offset:3072 sc1
buffer_load_dwordx4 v[88:91], v3, s[4:7], s79 offen offset:1024 sc1
buffer_load_dwordx4 v[92:95], v3, s[4:7], s79 offen offset:3072 sc1
s_lshl_b32 s56, s62, 4
v_lshlrev_b32 v140, 2, v2
v_sub_u32 v140, v1, v140
v_add_u32 v140, s56, v140
v_mov_b32 v141, 0xf149f2ca
s_waitcnt vmcnt(16)
v_mfma_f32_16x16x32_bf16 v[128:131], v[32:35], v[16:19], 0
v_mfma_f32_16x16x32_bf16 v[132:135], v[36:39], v[16:19], 0
v_mfma_f32_16x16x32_bf16 v[128:131], v[40:43], v[20:23], v[128:131]
v_mfma_f32_16x16x32_bf16 v[132:135], v[44:47], v[20:23], v[132:135]
v_mfma_f32_16x16x32_bf16 v[128:131], v[48:51], v[24:27], v[128:131]
v_mfma_f32_16x16x32_bf16 v[132:135], v[52:55], v[24:27], v[132:135]
v_mfma_f32_16x16x32_bf16 v[128:131], v[56:59], v[28:31], v[128:131]
v_mfma_f32_16x16x32_bf16 v[132:135], v[60:63], v[28:31], v[132:135]
v_cmp_le_i32 vcc, 0, v140
s_nop 2
v_cndmask_b32 v128, v141, v128, vcc
v_cmp_le_i32 vcc, 1, v140
s_nop 1
v_cndmask_b32 v129, v141, v129, vcc
v_cmp_le_i32 vcc, 2, v140
s_nop 1
v_cndmask_b32 v130, v141, v130, vcc
v_cmp_le_i32 vcc, 3, v140
s_nop 1
v_cndmask_b32 v131, v141, v131, vcc
v_cmp_le_i32 vcc, 16, v140
s_nop 1
v_cndmask_b32 v132, v141, v132, vcc
v_cmp_le_i32 vcc, 17, v140
s_nop 1
v_cndmask_b32 v133, v141, v133, vcc
v_cmp_le_i32 vcc, 18, v140
s_nop 1
v_cndmask_b32 v134, v141, v134, vcc
v_cmp_le_i32 vcc, 19, v140
s_nop 1
v_cndmask_b32 v135, v141, v135, vcc
s_waitcnt vmcnt(12)
v_mfma_f32_16x16x32_bf16 v[136:139], v[64:67], v[16:19], 0
v_mfma_f32_16x16x32_bf16 v[136:139], v[68:71], v[20:23], v[136:139]
v_mfma_f32_16x16x32_bf16 v[136:139], v[72:75], v[24:27], v[136:139]
v_mfma_f32_16x16x32_bf16 v[136:139], v[76:79], v[28:31], v[136:139]
v_max3_f32 v140, v128, v129, v130
v_max3_f32 v141, v131, v132, v133
v_max3_f32 v140, v140, v134, v135
v_max_f32 v140, v140, v141
s_nop 3
v_max3_f32 v141, v136, v137, v138
v_max3_f32 v140, v140, v141, v139
v_mov_b32 v141, v140
s_nop 1
v_permlane16_swap_b32 v140, v141
v_max_f32 v140, v140, v141
v_mov_b32 v141, v140
s_nop 1
v_permlane32_swap_b32 v140, v141
v_max_f32 v140, v140, v141
s_mov_b32 s56, 0x3e0293ee
v_mul_f32 v140, s56, v140
v_fma_f32 v128, v128, s56, -v140
v_fma_f32 v129, v129, s56, -v140
v_fma_f32 v130, v130, s56, -v140
v_fma_f32 v131, v131, s56, -v140
v_fma_f32 v132, v132, s56, -v140
v_fma_f32 v133, v133, s56, -v140
v_fma_f32 v134, v134, s56, -v140
v_fma_f32 v135, v135, s56, -v140
v_fma_f32 v136, v136, s56, -v140
v_fma_f32 v137, v137, s56, -v140
v_fma_f32 v138, v138, s56, -v140
v_fma_f32 v139, v139, s56, -v140
v_exp_f32 v128, v128
v_exp_f32 v129, v129
v_exp_f32 v130, v130
v_exp_f32 v131, v131
v_exp_f32 v132, v132
v_exp_f32 v133, v133
v_exp_f32 v134, v134
v_exp_f32 v135, v135
v_exp_f32 v136, v136
v_exp_f32 v137, v137
v_exp_f32 v138, v138
v_exp_f32 v139, v139
v_mov_b32 v24, 0x3f803f80
v_mov_b32 v25, 0x3f803f80
v_mov_b32 v26, 0x3f803f80
v_mov_b32 v27, 0x3f803f80
v_cvt_pk_bf16_f32 v16, v128, v129
v_cvt_pk_bf16_f32 v17, v130, v131
v_cvt_pk_bf16_f32 v18, v132, v133
v_cvt_pk_bf16_f32 v19, v134, v135
v_cvt_pk_bf16_f32 v20, v136, v137
v_cvt_pk_bf16_f32 v21, v138, v139
s_waitcnt vmcnt(0)
v_mfma_f32_16x16x32_bf16 v[28:31], v[24:27], v[16:19], 0
v_mfma_f32_16x16x16_bf16 v[64:67], v[24:25], v[20:21], 0
v_mfma_f32_16x16x32_bf16 v[32:35], v[96:99], v[16:19], 0
v_mfma_f32_16x16x32_bf16 v[36:39], v[100:103], v[16:19], 0
v_mfma_f32_16x16x32_bf16 v[40:43], v[104:107], v[16:19], 0
v_mfma_f32_16x16x32_bf16 v[44:47], v[108:111], v[16:19], 0
v_mfma_f32_16x16x32_bf16 v[48:51], v[112:115], v[16:19], 0
v_mfma_f32_16x16x32_bf16 v[52:55], v[116:119], v[16:19], 0
v_mfma_f32_16x16x32_bf16 v[56:59], v[120:123], v[16:19], 0
v_mfma_f32_16x16x32_bf16 v[60:63], v[124:127], v[16:19], 0
v_mfma_f32_16x16x16_bf16 v[32:35], v[80:81], v[20:21], v[32:35]
v_mfma_f32_16x16x16_bf16 v[36:39], v[82:83], v[20:21], v[36:39]
v_mfma_f32_16x16x16_bf16 v[40:43], v[84:85], v[20:21], v[40:43]
v_mfma_f32_16x16x16_bf16 v[44:47], v[86:87], v[20:21], v[44:47]
v_mfma_f32_16x16x16_bf16 v[48:51], v[88:89], v[20:21], v[48:51]
v_mfma_f32_16x16x16_bf16 v[52:55], v[90:91], v[20:21], v[52:55]
v_mfma_f32_16x16x16_bf16 v[56:59], v[92:93], v[20:21], v[56:59]
v_mfma_f32_16x16x16_bf16 v[60:63], v[94:95], v[20:21], v[60:63]
v_fma_f32 v28, v64, 0.5, v28
v_rcp_f32 v28, v28
s_lshl_b32 s66, s64, 12
s_add_u32 s66, s66, s63
s_lshl_b32 s56, s60, 5
s_add_u32 s56, s56, s64
s_lshl_b32 s67, s56, 2
s_add_u32 s67, s67, 7168
v_pk_mul_f32 v[32:33], v[32:33], v[28:29] op_sel_hi:[1,0]
v_pk_mul_f32 v[34:35], v[34:35], v[28:29] op_sel_hi:[1,0]
v_pk_mul_f32 v[36:37], v[36:37], v[28:29] op_sel_hi:[1,0]
v_pk_mul_f32 v[38:39], v[38:39], v[28:29] op_sel_hi:[1,0]
v_cvt_pk_bf16_f32 v32, v32, v33
v_cvt_pk_bf16_f32 v33, v34, v35
v_cvt_pk_bf16_f32 v34, v36, v37
v_cvt_pk_bf16_f32 v35, v38, v39
v_pk_mul_f32 v[40:41], v[40:41], v[28:29] op_sel_hi:[1,0]
v_pk_mul_f32 v[42:43], v[42:43], v[28:29] op_sel_hi:[1,0]
v_pk_mul_f32 v[44:45], v[44:45], v[28:29] op_sel_hi:[1,0]
v_pk_mul_f32 v[46:47], v[46:47], v[28:29] op_sel_hi:[1,0]
v_cvt_pk_bf16_f32 v40, v40, v41
v_cvt_pk_bf16_f32 v41, v42, v43
v_cvt_pk_bf16_f32 v42, v44, v45
v_cvt_pk_bf16_f32 v43, v46, v47
v_pk_mul_f32 v[48:49], v[48:49], v[28:29] op_sel_hi:[1,0]
v_pk_mul_f32 v[50:51], v[50:51], v[28:29] op_sel_hi:[1,0]
v_pk_mul_f32 v[52:53], v[52:53], v[28:29] op_sel_hi:[1,0]
v_pk_mul_f32 v[54:55], v[54:55], v[28:29] op_sel_hi:[1,0]
v_cvt_pk_bf16_f32 v48, v48, v49
v_cvt_pk_bf16_f32 v49, v50, v51
v_cvt_pk_bf16_f32 v50, v52, v53
v_cvt_pk_bf16_f32 v51, v54, v55
v_pk_mul_f32 v[56:57], v[56:57], v[28:29] op_sel_hi:[1,0]
v_pk_mul_f32 v[58:59], v[58:59], v[28:29] op_sel_hi:[1,0]
v_pk_mul_f32 v[60:61], v[60:61], v[28:29] op_sel_hi:[1,0]
v_pk_mul_f32 v[62:63], v[62:63], v[28:29] op_sel_hi:[1,0]
v_cvt_pk_bf16_f32 v56, v56, v57
v_cvt_pk_bf16_f32 v57, v58, v59
v_cvt_pk_bf16_f32 v58, v60, v61
v_cvt_pk_bf16_f32 v59, v62, v63
v_mov_b32 v141, 1
v_lshlrev_b32 v140, 2, v3
s_cmp_eq_u32 s43, 0
s_cbranch_scc1 L_ofar_60
buffer_store_dwordx4 v[32:35], v3, s[4:7], s66 offen offset:0
buffer_store_dwordx4 v[40:43], v3, s[4:7], s66 offen offset:1024
buffer_store_dwordx4 v[48:51], v3, s[4:7], s66 offen offset:2048
buffer_store_dwordx4 v[56:59], v3, s[4:7], s66 offen offset:3072
buffer_load_dword v140, v140, s[4:7], s66 offen sc1
s_mul_i32 s77, s41, 56
s_mul_i32 s56, s38, 14
s_add_u32 s77, s77, s56
s_lshl_b32 s77, s77, 10
s_add_u32 s77, s77, 83886080
buffer_load_dwordx4 v[72:75], v3, s[4:7], s77 offen offset:0 sc1
buffer_load_dwordx4 v[76:79], v3, s[4:7], s77 offen offset:1024 sc1
buffer_load_dwordx4 v[80:83], v3, s[4:7], s77 offen offset:2048 sc1
buffer_load_dwordx4 v[84:87], v3, s[4:7], s77 offen offset:3072 sc1
s_add_u32 s77, s77, 0x1000
buffer_load_dwordx4 v[88:91], v3, s[4:7], s77 offen offset:0 sc1
buffer_load_dwordx4 v[92:95], v3, s[4:7], s77 offen offset:1024 sc1
buffer_load_dwordx4 v[96:99], v3, s[4:7], s77 offen offset:2048 sc1
buffer_load_dwordx4 v[100:103], v3, s[4:7], s77 offen offset:3072 sc1
s_add_u32 s77, s77, 0x1000
buffer_load_dwordx4 v[104:107], v3, s[4:7], s77 offen offset:0 sc1
buffer_load_dwordx4 v[108:111], v3, s[4:7], s77 offen offset:1024 sc1
buffer_load_dwordx4 v[112:115], v3, s[4:7], s77 offen offset:2048 sc1
buffer_load_dwordx4 v[116:119], v3, s[4:7], s77 offen offset:3072 sc1
s_add_u32 s77, s77, 0x1000
buffer_load_dwordx4 v[120:123], v3, s[4:7], s77 offen offset:0 sc1
buffer_load_dwordx4 v[124:127], v3, s[4:7], s77 offen offset:1024 sc1
s_waitcnt vmcnt(14)
s_mov_b64 exec, 1
buffer_store_dword v141, off, s[4:7], s67
s_mov_b64 exec, -1
s_branch L_odone_61
L_ofar_60:
buffer_store_dwordx4 v[32:35], v3, s[4:7], s66 offen offset:0 sc1
buffer_store_dwordx4 v[40:43], v3, s[4:7], s66 offen offset:1024 sc1
buffer_store_dwordx4 v[48:51], v3, s[4:7], s66 offen offset:2048 sc1
buffer_store_dwordx4 v[56:59], v3, s[4:7], s66 offen offset:3072 sc1
s_mul_i32 s77, s41, 56
s_mul_i32 s56, s38, 14
s_add_u32 s77, s77, s56
s_lshl_b32 s77, s77, 10
s_add_u32 s77, s77, 83886080
buffer_load_dwordx4 v[72:75], v3, s[4:7], s77 offen offset:0 sc1
buffer_load_dwordx4 v[76:79], v3, s[4:7], s77 offen offset:1024 sc1
buffer_load_dwordx4 v[80:83], v3, s[4:7], s77 offen offset:2048 sc1
buffer_load_dwordx4 v[84:87], v3, s[4:7], s77 offen offset:3072 sc1
s_add_u32 s77, s77, 0x1000
buffer_load_dwordx4 v[88:91], v3, s[4:7], s77 offen offset:0 sc1
buffer_load_dwordx4 v[92:95], v3, s[4:7], s77 offen offset:1024 sc1
buffer_load_dwordx4 v[96:99], v3, s[4:7], s77 offen offset:2048 sc1
buffer_load_dwordx4 v[100:103], v3, s[4:7], s77 offen offset:3072 sc1
s_add_u32 s77, s77, 0x1000
buffer_load_dwordx4 v[104:107], v3, s[4:7], s77 offen offset:0 sc1
buffer_load_dwordx4 v[108:111], v3, s[4:7], s77 offen offset:1024 sc1
buffer_load_dwordx4 v[112:115], v3, s[4:7], s77 offen offset:2048 sc1
buffer_load_dwordx4 v[116:119], v3, s[4:7], s77 offen offset:3072 sc1
s_add_u32 s77, s77, 0x1000
buffer_load_dwordx4 v[120:123], v3, s[4:7], s77 offen offset:0 sc1
buffer_load_dwordx4 v[124:127], v3, s[4:7], s77 offen offset:1024 sc1
s_waitcnt vmcnt(14)
s_mov_b64 exec, 1
buffer_store_dword v141, off, s[4:7], s67 sc1
s_mov_b64 exec, -1
L_odone_61:
s_waitcnt vmcnt(14)
v_mfma_f32_16x16x32_bf16 v[8:11], v[144:147], v[72:75], 0
v_mfma_f32_16x16x32_bf16 v[12:15], v[148:151], v[72:75], 0
s_waitcnt vmcnt(13)
v_mfma_f32_16x16x32_bf16 v[8:11], v[152:155], v[76:79], v[8:11]
v_mfma_f32_16x16x32_bf16 v[12:15], v[156:159], v[76:79], v[12:15]
s_waitcnt vmcnt(12)
v_mfma_f32_16x16x32_bf16 v[8:11], v[160:163], v[80:83], v[8:11]
v_mfma_f32_16x16x32_bf16 v[12:15], v[164:167], v[80:83], v[12:15]
s_waitcnt vmcnt(11)
v_mfma_f32_16x16x32_bf16 v[8:11], v[168:171], v[84:87], v[8:11]
v_mfma_f32_16x16x32_bf16 v[12:15], v[172:175], v[84:87], v[12:15]
s_waitcnt vmcnt(10)
v_mfma_f32_16x16x32_bf16 v[8:11], v[176:179], v[88:91], v[8:11]
v_mfma_f32_16x16x32_bf16 v[12:15], v[180:183], v[88:91], v[12:15]
s_waitcnt vmcnt(9)
v_mfma_f32_16x16x32_bf16 v[8:11], v[184:187], v[92:95], v[8:11]
v_mfma_f32_16x16x32_bf16 v[12:15], v[188:191], v[92:95], v[12:15]
s_waitcnt vmcnt(8)
v_mfma_f32_16x16x32_bf16 v[8:11], v[192:195], v[96:99], v[8:11]
v_mfma_f32_16x16x32_bf16 v[12:15], v[196:199], v[96:99], v[12:15]
s_waitcnt vmcnt(7)
v_mfma_f32_16x16x32_bf16 v[8:11], v[200:203], v[100:103], v[8:11]
v_mfma_f32_16x16x32_bf16 v[12:15], v[204:207], v[100:103], v[12:15]
s_waitcnt vmcnt(6)
v_mfma_f32_16x16x32_bf16 v[8:11], v[208:211], v[104:107], v[8:11]
v_mfma_f32_16x16x32_bf16 v[12:15], v[212:215], v[104:107], v[12:15]
s_waitcnt vmcnt(5)
v_mfma_f32_16x16x32_bf16 v[8:11], v[216:219], v[108:111], v[8:11]
v_mfma_f32_16x16x32_bf16 v[12:15], v[220:223], v[108:111], v[12:15]
s_waitcnt vmcnt(4)
v_mfma_f32_16x16x32_bf16 v[8:11], v[224:227], v[112:115], v[8:11]
v_mfma_f32_16x16x32_bf16 v[12:15], v[228:231], v[112:115], v[12:15]
s_waitcnt vmcnt(3)
v_mfma_f32_16x16x32_bf16 v[8:11], v[232:235], v[116:119], v[8:11]
v_mfma_f32_16x16x32_bf16 v[12:15], v[236:239], v[116:119], v[12:15]
s_waitcnt vmcnt(2)
v_mfma_f32_16x16x32_bf16 v[8:11], v[240:243], v[120:123], v[8:11]
v_mfma_f32_16x16x32_bf16 v[12:15], v[244:247], v[120:123], v[12:15]
s_waitcnt vmcnt(1)
v_mfma_f32_16x16x32_bf16 v[8:11], v[248:251], v[124:127], v[8:11]
v_mfma_f32_16x16x32_bf16 v[12:15], v[252:255], v[124:127], v[12:15]
s_branch L_s2_att
L_s2_noatt:
s_mul_i32 s77, s41, 56
s_mul_i32 s56, s38, 14
s_add_u32 s77, s77, s56
s_lshl_b32 s77, s77, 10
s_add_u32 s77, s77, 83886080
buffer_load_dwordx4 v[16:19], v3, s[4:7], s77 offen offset:0 sc1
buffer_load_dwordx4 v[20:23], v3, s[4:7], s77 offen offset:1024 sc1
buffer_load_dwordx4 v[24:27], v3, s[4:7], s77 offen offset:2048 sc1
buffer_load_dwordx4 v[28:31], v3, s[4:7], s77 offen offset:3072 sc1
s_add_u32 s77, s77, 0x1000
buffer_load_dwordx4 v[32:35], v3, s[4:7], s77 offen offset:0 sc1
buffer_load_dwordx4 v[36:39], v3, s[4:7], s77 offen offset:1024 sc1
buffer_load_dwordx4 v[40:43], v3, s[4:7], s77 offen offset:2048 sc1
buffer_load_dwordx4 v[44:47], v3, s[4:7], s77 offen offset:3072 sc1
s_add_u32 s77, s77, 0x1000
buffer_load_dwordx4 v[48:51], v3, s[4:7], s77 offen offset:0 sc1
buffer_load_dwordx4 v[52:55], v3, s[4:7], s77 offen offset:1024 sc1
buffer_load_dwordx4 v[56:59], v3, s[4:7], s77 offen offset:2048 sc1
buffer_load_dwordx4 v[60:63], v3, s[4:7], s77 offen offset:3072 sc1
s_add_u32 s77, s77, 0x1000
buffer_load_dwordx4 v[64:67], v3, s[4:7], s77 offen offset:0 sc1
buffer_load_dwordx4 v[68:71], v3, s[4:7], s77 offen offset:1024 sc1
s_waitcnt vmcnt(13)
v_mfma_f32_16x16x32_bf16 v[8:11], v[144:147], v[16:19], 0
v_mfma_f32_16x16x32_bf16 v[12:15], v[148:151], v[16:19], 0
s_waitcnt vmcnt(12)
v_mfma_f32_16x16x32_bf16 v[8:11], v[152:155], v[20:23], v[8:11]
v_mfma_f32_16x16x32_bf16 v[12:15], v[156:159], v[20:23], v[12:15]
s_waitcnt vmcnt(11)
v_mfma_f32_16x16x32_bf16 v[8:11], v[160:163], v[24:27], v[8:11]
v_mfma_f32_16x16x32_bf16 v[12:15], v[164:167], v[24:27], v[12:15]
s_waitcnt vmcnt(10)
v_mfma_f32_16x16x32_bf16 v[8:11], v[168:171], v[28:31], v[8:11]
v_mfma_f32_16x16x32_bf16 v[12:15], v[172:175], v[28:31], v[12:15]
s_waitcnt vmcnt(9)
v_mfma_f32_16x16x32_bf16 v[8:11], v[176:179], v[32:35], v[8:11]
v_mfma_f32_16x16x32_bf16 v[12:15], v[180:183], v[32:35], v[12:15]
s_waitcnt vmcnt(8)
v_mfma_f32_16x16x32_bf16 v[8:11], v[184:187], v[36:39], v[8:11]
v_mfma_f32_16x16x32_bf16 v[12:15], v[188:191], v[36:39], v[12:15]
s_waitcnt vmcnt(7)
v_mfma_f32_16x16x32_bf16 v[8:11], v[192:195], v[40:43], v[8:11]
v_mfma_f32_16x16x32_bf16 v[12:15], v[196:199], v[40:43], v[12:15]
s_waitcnt vmcnt(6)
v_mfma_f32_16x16x32_bf16 v[8:11], v[200:203], v[44:47], v[8:11]
v_mfma_f32_16x16x32_bf16 v[12:15], v[204:207], v[44:47], v[12:15]
s_waitcnt vmcnt(5)
v_mfma_f32_16x16x32_bf16 v[8:11], v[208:211], v[48:51], v[8:11]
v_mfma_f32_16x16x32_bf16 v[12:15], v[212:215], v[48:51], v[12:15]
s_waitcnt vmcnt(4)
v_mfma_f32_16x16x32_bf16 v[8:11], v[216:219], v[52:55], v[8:11]
v_mfma_f32_16x16x32_bf16 v[12:15], v[220:223], v[52:55], v[12:15]
s_waitcnt vmcnt(3)
v_mfma_f32_16x16x32_bf16 v[8:11], v[224:227], v[56:59], v[8:11]
v_mfma_f32_16x16x32_bf16 v[12:15], v[228:231], v[56:59], v[12:15]
s_waitcnt vmcnt(2)
v_mfma_f32_16x16x32_bf16 v[8:11], v[232:235], v[60:63], v[8:11]
v_mfma_f32_16x16x32_bf16 v[12:15], v[236:239], v[60:63], v[12:15]
s_waitcnt vmcnt(1)
v_mfma_f32_16x16x32_bf16 v[8:11], v[240:243], v[64:67], v[8:11]
v_mfma_f32_16x16x32_bf16 v[12:15], v[244:247], v[64:67], v[12:15]
s_waitcnt vmcnt(0)
v_mfma_f32_16x16x32_bf16 v[8:11], v[248:251], v[68:71], v[8:11]
v_mfma_f32_16x16x32_bf16 v[12:15], v[252:255], v[68:71], v[12:15]
L_s2_att:
s_lshl_b32 s56, s60, 7
s_lshl_b32 s58, s38, 5
s_add_u32 s56, s56, s58
s_add_u32 s58, s56, 7168
s_lshl_b32 s65, s38, 15
s_add_u32 s65, s65, s63
s_lshl_b32 s66, s41, 14
s_cmp_ge_u32 s60, 124
s_cbranch_scc1 L_s2_half
s_mov_b32 s57, 0
L_wf_62:
buffer_load_dword v140, v7, s[4:7], s58 offen offset:0 sc1
s_add_u32 s57, s57, 1
s_cmp_ge_u32 s57, 524288
s_cbranch_scc1 L_end
s_waitcnt vmcnt(0)
v_cmp_ge_u32 vcc, 0, v140
s_cbranch_vccnz L_wf_62
s_lshr_b32 s58, s42, 4
s_lshl_b32 s58, s58, 7
buffer_load_dwordx4 v[16:19], v3, s[4:7], s65 offen offset:0 sc1
buffer_load_dwordx4 v[20:23], v3, s[4:7], s65 offen offset:1024 sc1
buffer_load_dwordx4 v[24:27], v3, s[4:7], s65 offen offset:2048 sc1
buffer_load_dwordx4 v[28:31], v3, s[4:7], s65 offen offset:3072 sc1
s_add_u32 s65, s65, 0x1000
buffer_load_dwordx4 v[32:35], v3, s[4:7], s65 offen offset:0 sc1
buffer_load_dwordx4 v[36:39], v3, s[4:7], s65 offen offset:1024 sc1
buffer_load_dwordx4 v[40:43], v3, s[4:7], s65 offen offset:2048 sc1
buffer_load_dwordx4 v[44:47], v3, s[4:7], s65 offen offset:3072 sc1
s_add_u32 s65, s65, 0x1000
buffer_load_dwordx4 v[48:51], v3, s[4:7], s65 offen offset:0 sc1
buffer_load_dwordx4 v[52:55], v3, s[4:7], s65 offen offset:1024 sc1
buffer_load_dwordx4 v[56:59], v3, s[4:7], s65 offen offset:2048 sc1
buffer_load_dwordx4 v[60:63], v3, s[4:7], s65 offen offset:3072 sc1
s_add_u32 s65, s65, 0x1000
buffer_load_dwordx4 v[64:67], v3, s[4:7], s65 offen offset:0 sc1
buffer_load_dwordx4 v[68:71], v3, s[4:7], s65 offen offset:1024 sc1
buffer_load_dwordx4 v[72:75], v3, s[4:7], s65 offen offset:2048 sc1
buffer_load_dwordx4 v[76:79], v3, s[4:7], s65 offen offset:3072 sc1
s_add_u32 s65, s65, 0x1000
buffer_load_dwordx4 v[80:83], v3, s[4:7], s65 offen offset:0 sc1
buffer_load_dwordx4 v[84:87], v3, s[4:7], s65 offen offset:1024 sc1
buffer_load_dwordx4 v[88:91], v3, s[4:7], s65 offen offset:2048 sc1
buffer_load_dwordx4 v[92:95], v3, s[4:7], s65 offen offset:3072 sc1
s_add_u32 s65, s65, 0x1000
buffer_load_dwordx4 v[96:99], v3, s[4:7], s65 offen offset:0 sc1
buffer_load_dwordx4 v[100:103], v3, s[4:7], s65 offen offset:1024 sc1
buffer_load_dwordx4 v[104:107], v3, s[4:7], s65 offen offset:2048 sc1
buffer_load_dwordx4 v[108:111], v3, s[4:7], s65 offen offset:3072 sc1
s_add_u32 s65, s65, 0x1000
buffer_load_dwordx4 v[112:115], v3, s[4:7], s65 offen offset:0 sc1
buffer_load_dwordx4 v[116:119], v3, s[4:7], s65 offen offset:1024 sc1
buffer_load_dwordx4 v[120:123], v3, s[4:7], s65 offen offset:2048 sc1
buffer_load_dwordx4 v[124:127], v3, s[4:7], s65 offen offset:3072 sc1
buffer_load_dwordx4 v[128:131], v5, s[8:11], s66 offen
buffer_load_dword v143, off, s[4:7], s58 offset:2048 sc1
s_waitcnt vmcnt(29)
v_mfma_f32_16x16x32_bf16 v[8:11], a[0:3], v[16:19], v[8:11]
v_mfma_f32_16x16x32_bf16 v[12:15], a[4:7], v[16:19], v[12:15]
s_add_u32 s65, s65, 0x1000
buffer_load_dwordx4 v[16:19], v3, s[4:7], s65 offen offset:0 sc1
s_waitcnt vmcnt(29)
v_mfma_f32_16x16x32_bf16 v[8:11], a[8:11], v[20:23], v[8:11]
v_mfma_f32_16x16x32_bf16 v[12:15], a[12:15], v[20:23], v[12:15]
buffer_load_dwordx4 v[20:23], v3, s[4:7], s65 offen offset:1024 sc1
s_waitcnt vmcnt(29)
v_mfma_f32_16x16x32_bf16 v[8:11], a[16:19], v[24:27], v[8:11]
v_mfma_f32_16x16x32_bf16 v[12:15], a[20:23], v[24:27], v[12:15]
buffer_load_dwordx4 v[24:27], v3, s[4:7], s65 offen offset:2048 sc1
s_waitcnt vmcnt(29)
v_mfma_f32_16x16x32_bf16 v[8:11], a[24:27], v[28:31], v[8:11]
v_mfma_f32_16x16x32_bf16 v[12:15], a[28:31], v[28:31], v[12:15]
buffer_load_dwordx4 v[28:31], v3, s[4:7], s65 offen offset:3072 sc1
s_waitcnt vmcnt(29)
v_mfma_f32_16x16x32_bf16 v[8:11], a[32:35], v[32:35], v[8:11]
v_mfma_f32_16x16x32_bf16 v[12:15], a[36:39], v[32:35], v[12:15]
s_waitcnt vmcnt(28)
v_mfma_f32_16x16x32_bf16 v[8:11], a[40:43], v[36:39], v[8:11]
v_mfma_f32_16x16x32_bf16 v[12:15], a[44:47], v[36:39], v[12:15]
s_waitcnt vmcnt(27)
v_mfma_f32_16x16x32_bf16 v[8:11], a[48:51], v[40:43], v[8:11]
v_mfma_f32_16x16x32_bf16 v[12:15], a[52:55], v[40:43], v[12:15]
s_waitcnt vmcnt(26)
v_mfma_f32_16x16x32_bf16 v[8:11], a[56:59], v[44:47], v[8:11]
v_mfma_f32_16x16x32_bf16 v[12:15], a[60:63], v[44:47], v[12:15]
s_waitcnt vmcnt(25)
v_mfma_f32_16x16x32_bf16 v[8:11], a[64:67], v[48:51], v[8:11]
v_mfma_f32_16x16x32_bf16 v[12:15], a[68:71], v[48:51], v[12:15]
s_waitcnt vmcnt(24)
v_mfma_f32_16x16x32_bf16 v[8:11], a[72:75], v[52:55], v[8:11]
v_mfma_f32_16x16x32_bf16 v[12:15], a[76:79], v[52:55], v[12:15]
s_waitcnt vmcnt(23)
v_mfma_f32_16x16x32_bf16 v[8:11], a[80:83], v[56:59], v[8:11]
v_mfma_f32_16x16x32_bf16 v[12:15], a[84:87], v[56:59], v[12:15]
s_waitcnt vmcnt(22)
v_mfma_f32_16x16x32_bf16 v[8:11], a[88:91], v[60:63], v[8:11]
v_mfma_f32_16x16x32_bf16 v[12:15], a[92:95], v[60:63], v[12:15]
s_waitcnt vmcnt(21)
v_mfma_f32_16x16x32_bf16 v[8:11], a[96:99], v[64:67], v[8:11]
v_mfma_f32_16x16x32_bf16 v[12:15], a[100:103], v[64:67], v[12:15]
s_waitcnt vmcnt(20)
v_mfma_f32_16x16x32_bf16 v[8:11], a[104:107], v[68:71], v[8:11]
v_mfma_f32_16x16x32_bf16 v[12:15], a[108:111], v[68:71], v[12:15]
s_waitcnt vmcnt(19)
v_mfma_f32_16x16x32_bf16 v[8:11], a[112:115], v[72:75], v[8:11]
v_mfma_f32_16x16x32_bf16 v[12:15], a[116:119], v[72:75], v[12:15]
s_waitcnt vmcnt(18)
v_mfma_f32_16x16x32_bf16 v[8:11], a[120:123], v[76:79], v[8:11]
v_mfma_f32_16x16x32_bf16 v[12:15], a[124:127], v[76:79], v[12:15]
s_waitcnt vmcnt(17)
v_mfma_f32_16x16x32_bf16 v[8:11], a[128:131], v[80:83], v[8:11]
v_mfma_f32_16x16x32_bf16 v[12:15], a[132:135], v[80:83], v[12:15]
s_waitcnt vmcnt(16)
v_mfma_f32_16x16x32_bf16 v[8:11], a[136:139], v[84:87], v[8:11]
v_mfma_f32_16x16x32_bf16 v[12:15], a[140:143], v[84:87], v[12:15]
s_waitcnt vmcnt(15)
v_mfma_f32_16x16x32_bf16 v[8:11], a[144:147], v[88:91], v[8:11]
v_mfma_f32_16x16x32_bf16 v[12:15], a[148:151], v[88:91], v[12:15]
s_waitcnt vmcnt(14)
v_mfma_f32_16x16x32_bf16 v[8:11], a[152:155], v[92:95], v[8:11]
v_mfma_f32_16x16x32_bf16 v[12:15], a[156:159], v[92:95], v[12:15]
s_waitcnt vmcnt(13)
v_mfma_f32_16x16x32_bf16 v[8:11], a[160:163], v[96:99], v[8:11]
v_mfma_f32_16x16x32_bf16 v[12:15], a[164:167], v[96:99], v[12:15]
s_waitcnt vmcnt(12)
v_mfma_f32_16x16x32_bf16 v[8:11], a[168:171], v[100:103], v[8:11]
v_mfma_f32_16x16x32_bf16 v[12:15], a[172:175], v[100:103], v[12:15]
s_waitcnt vmcnt(11)
v_mfma_f32_16x16x32_bf16 v[8:11], a[176:179], v[104:107], v[8:11]
v_mfma_f32_16x16x32_bf16 v[12:15], a[180:183], v[104:107], v[12:15]
s_waitcnt vmcnt(10)
v_mfma_f32_16x16x32_bf16 v[8:11], a[184:187], v[108:111], v[8:11]
v_mfma_f32_16x16x32_bf16 v[12:15], a[188:191], v[108:111], v[12:15]
s_waitcnt vmcnt(9)
v_mfma_f32_16x16x32_bf16 v[8:11], a[192:195], v[112:115], v[8:11]
v_mfma_f32_16x16x32_bf16 v[12:15], a[196:199], v[112:115], v[12:15]
s_waitcnt vmcnt(8)
v_mfma_f32_16x16x32_bf16 v[8:11], a[200:203], v[116:119], v[8:11]
v_mfma_f32_16x16x32_bf16 v[12:15], a[204:207], v[116:119], v[12:15]
s_waitcnt vmcnt(7)
v_mfma_f32_16x16x32_bf16 v[8:11], a[208:211], v[120:123], v[8:11]
v_mfma_f32_16x16x32_bf16 v[12:15], a[212:215], v[120:123], v[12:15]
s_waitcnt vmcnt(6)
v_mfma_f32_16x16x32_bf16 v[8:11], a[216:219], v[124:127], v[8:11]
v_mfma_f32_16x16x32_bf16 v[12:15], a[220:223], v[124:127], v[12:15]
s_waitcnt vmcnt(3)
v_mfma_f32_16x16x32_bf16 v[8:11], a[224:227], v[16:19], v[8:11]
v_mfma_f32_16x16x32_bf16 v[12:15], a[228:231], v[16:19], v[12:15]
s_waitcnt vmcnt(2)
v_mfma_f32_16x16x32_bf16 v[8:11], a[232:235], v[20:23], v[8:11]
v_mfma_f32_16x16x32_bf16 v[12:15], a[236:239], v[20:23], v[12:15]
s_waitcnt vmcnt(1)
v_mfma_f32_16x16x32_bf16 v[8:11], a[240:243], v[24:27], v[8:11]
v_mfma_f32_16x16x32_bf16 v[12:15], a[244:247], v[24:27], v[12:15]
s_waitcnt vmcnt(0)
v_mfma_f32_16x16x32_bf16 v[8:11], a[248:251], v[28:31], v[8:11]
v_mfma_f32_16x16x32_bf16 v[12:15], a[252:255], v[28:31], v[12:15]
v_readfirstlane_b32 s76, v143
L_s2_sum:
s_xor_b32 s63, s63, 0x20000
s_cmp_eq_u32 s38, 0
s_cbranch_scc1 L_s2_w0a
s_nop 2
ds_write_b128 v142, v[8:11]
ds_write_b128 v142, v[12:15] offset:1024
s_waitcnt lgkmcnt(0)
L_s2_w0a:
s_barrier
s_cmp_lg_u32 s38, 0
s_cbranch_scc1 L_s2_w0b
ds_read_b128 v[16:19], v3 offset:2048
ds_read_b128 v[20:23], v3 offset:3072
ds_read_b128 v[24:27], v3 offset:4096
ds_read_b128 v[28:31], v3 offset:5120
ds_read_b128 v[32:35], v3 offset:6144
ds_read_b128 v[36:39], v3 offset:7168
v_lshlrev_b32 v40, 16, v128
v_and_b32 v44, 0xffff0000, v128
v_lshlrev_b32 v41, 16, v129
v_and_b32 v45, 0xffff0000, v129
v_lshlrev_b32 v42, 16, v130
v_and_b32 v46, 0xffff0000, v130
v_lshlrev_b32 v43, 16, v131
v_and_b32 v47, 0xffff0000, v131
v_add_f32 v8, v8, v40
v_add_f32 v9, v9, v41
v_add_f32 v10, v10, v42
v_add_f32 v11, v11, v43
v_add_f32 v12, v12, v44
v_add_f32 v13, v13, v45
v_add_f32 v14, v14, v46
v_add_f32 v15, v15, v47
s_waitcnt lgkmcnt(0)
v_add_f32 v8, v8, v16
v_add_f32 v9, v9, v17
v_add_f32 v10, v10, v18
v_add_f32 v11, v11, v19
v_add_f32 v12, v12, v20
v_add_f32 v13, v13, v21
v_add_f32 v14, v14, v22
v_add_f32 v15, v15, v23
v_add_f32 v8, v8, v24
v_add_f32 v9, v9, v25
v_add_f32 v10, v10, v26
v_add_f32 v11, v11, v27
v_add_f32 v12, v12, v28
v_add_f32 v13, v13, v29
v_add_f32 v14, v14, v30
v_add_f32 v15, v15, v31
v_add_f32 v8, v8, v32
v_add_f32 v9, v9, v33
v_add_f32 v10, v10, v34
v_add_f32 v11, v11, v35
v_add_f32 v12, v12, v36
v_add_f32 v13, v13, v37
v_add_f32 v14, v14, v38
v_add_f32 v15, v15, v39
v_cvt_pk_bf16_f32 v16, v8, v12
v_cvt_pk_bf16_f32 v17, v9, v13
v_cvt_pk_bf16_f32 v18, v10, v14
v_cvt_pk_bf16_f32 v19, v11, v15
buffer_store_dwordx4 v[16:19], v5, s[12:15], s66 offen sc1
L_s2_w0b:
s_mov_b64 exec, -1
s_barrier
s_add_u32 s60, s60, 12
s_cmp_lt_u32 s60, 132
s_cbranch_scc1 L_s2_item
s_branch L_nos2
L_s2_half:
s_cmp_ge_u32 s60, 128
s_cselect_b64 vcc, -1, 0
v_cndmask_b32 v96, 0, v8, vcc
v_cndmask_b32 v8, v8, 0, vcc
v_cndmask_b32 v97, 0, v9, vcc
v_cndmask_b32 v9, v9, 0, vcc
v_cndmask_b32 v98, 0, v10, vcc
v_cndmask_b32 v10, v10, 0, vcc
v_cndmask_b32 v99, 0, v11, vcc
v_cndmask_b32 v11, v11, 0, vcc
v_cndmask_b32 v100, 0, v12, vcc
v_cndmask_b32 v12, v12, 0, vcc
v_cndmask_b32 v101, 0, v13, vcc
v_cndmask_b32 v13, v13, 0, vcc
v_cndmask_b32 v102, 0, v14, vcc
v_cndmask_b32 v14, v14, 0, vcc
v_cndmask_b32 v103, 0, v15, vcc
v_cndmask_b32 v15, v15, 0, vcc
s_cselect_b32 s56, 0x2000, 0
s_add_u32 s66, s66, s56
s_mov_b32 s57, 0
L_wf_63:
buffer_load_dword v140, v7, s[4:7], s58 offen offset:0 sc1
s_add_u32 s57, s57, 1
s_cmp_ge_u32 s57, 524288
s_cbranch_scc1 L_end
s_waitcnt vmcnt(0)
v_cmp_ge_u32 vcc, 0, v140
s_cbranch_vccnz L_wf_63
buffer_load_dwordx4 v[16:19], v3, s[4:7], s65 offen offset:0 sc1
buffer_load_dwordx4 v[20:23], v3, s[4:7], s65 offen offset:1024 sc1
s_add_u32 s65, s65, 0x1000
buffer_load_dwordx4 v[24:27], v3, s[4:7], s65 offen offset:0 sc1
buffer_load_dwordx4 v[28:31], v3, s[4:7], s65 offen offset:1024 sc1
s_add_u32 s65, s65, 0x1000
buffer_load_dwordx4 v[32:35], v3, s[4:7], s65 offen offset:0 sc1
buffer_load_dwordx4 v[36:39], v3, s[4:7], s65 offen offset:1024 sc1
s_add_u32 s65, s65, 0x1000
buffer_load_dwordx4 v[40:43], v3, s[4:7], s65 offen offset:0 sc1
buffer_load_dwordx4 v[44:47], v3, s[4:7], s65 offen offset:1024 sc1
s_add_u32 s65, s65, 0x1000
buffer_load_dwordx4 v[48:51], v3, s[4:7], s65 offen offset:0 sc1
buffer_load_dwordx4 v[52:55], v3, s[4:7], s65 offen offset:1024 sc1
s_add_u32 s65, s65, 0x1000
buffer_load_dwordx4 v[56:59], v3, s[4:7], s65 offen offset:0 sc1
buffer_load_dwordx4 v[60:63], v3, s[4:7], s65 offen offset:1024 sc1
s_add_u32 s65, s65, 0x1000
buffer_load_dwordx4 v[64:67], v3, s[4:7], s65 offen offset:0 sc1
buffer_load_dwordx4 v[68:71], v3, s[4:7], s65 offen offset:1024 sc1
s_add_u32 s65, s65, 0x1000
buffer_load_dwordx4 v[72:75], v3, s[4:7], s65 offen offset:0 sc1
buffer_load_dwordx4 v[76:79], v3, s[4:7], s65 offen offset:1024 sc1
s_mov_b32 vcc_lo, 0x00ff00ff
s_mov_b32 vcc_hi, 0x00ff00ff
s_waitcnt vmcnt(15)
v_mfma_f32_16x16x32_bf16 v[8:11], a[0:3], v[16:19], v[8:11]
v_mfma_f32_16x16x32_bf16 v[12:15], a[4:7], v[16:19], v[12:15]
v_mfma_f32_16x16x32_bf16 v[96:99], a[8:11], v[16:19], v[96:99]
v_mfma_f32_16x16x32_bf16 v[100:103], a[12:15], v[16:19], v[100:103]
s_waitcnt vmcnt(14)
v_mfma_f32_16x16x32_bf16 v[8:11], a[16:19], v[20:23], v[8:11]
v_mfma_f32_16x16x32_bf16 v[12:15], a[20:23], v[20:23], v[12:15]
v_mfma_f32_16x16x32_bf16 v[96:99], a[24:27], v[20:23], v[96:99]
v_mfma_f32_16x16x32_bf16 v[100:103], a[28:31], v[20:23], v[100:103]
s_waitcnt vmcnt(13)
v_mfma_f32_16x16x32_bf16 v[8:11], a[32:35], v[24:27], v[8:11]
v_mfma_f32_16x16x32_bf16 v[12:15], a[36:39], v[24:27], v[12:15]
v_mfma_f32_16x16x32_bf16 v[96:99], a[40:43], v[24:27], v[96:99]
v_mfma_f32_16x16x32_bf16 v[100:103], a[44:47], v[24:27], v[100:103]
s_waitcnt vmcnt(12)
v_mfma_f32_16x16x32_bf16 v[8:11], a[48:51], v[28:31], v[8:11]
v_mfma_f32_16x16x32_bf16 v[12:15], a[52:55], v[28:31], v[12:15]
v_mfma_f32_16x16x32_bf16 v[96:99], a[56:59], v[28:31], v[96:99]
v_mfma_f32_16x16x32_bf16 v[100:103], a[60:63], v[28:31], v[100:103]
s_waitcnt vmcnt(11)
v_mfma_f32_16x16x32_bf16 v[8:11], a[64:67], v[32:35], v[8:11]
v_mfma_f32_16x16x32_bf16 v[12:15], a[68:71], v[32:35], v[12:15]
v_mfma_f32_16x16x32_bf16 v[96:99], a[72:75], v[32:35], v[96:99]
v_mfma_f32_16x16x32_bf16 v[100:103], a[76:79], v[32:35], v[100:103]
s_waitcnt vmcnt(10)
v_mfma_f32_16x16x32_bf16 v[8:11], a[80:83], v[36:39], v[8:11]
v_mfma_f32_16x16x32_bf16 v[12:15], a[84:87], v[36:39], v[12:15]
v_mfma_f32_16x16x32_bf16 v[96:99], a[88:91], v[36:39], v[96:99]
v_mfma_f32_16x16x32_bf16 v[100:103], a[92:95], v[36:39], v[100:103]
s_waitcnt vmcnt(9)
v_mfma_f32_16x16x32_bf16 v[8:11], a[96:99], v[40:43], v[8:11]
v_mfma_f32_16x16x32_bf16 v[12:15], a[100:103], v[40:43], v[12:15]
v_mfma_f32_16x16x32_bf16 v[96:99], a[104:107], v[40:43], v[96:99]
v_mfma_f32_16x16x32_bf16 v[100:103], a[108:111], v[40:43], v[100:103]
s_waitcnt vmcnt(8)
v_mfma_f32_16x16x32_bf16 v[8:11], a[112:115], v[44:47], v[8:11]
v_mfma_f32_16x16x32_bf16 v[12:15], a[116:119], v[44:47], v[12:15]
v_mfma_f32_16x16x32_bf16 v[96:99], a[120:123], v[44:47], v[96:99]
v_mfma_f32_16x16x32_bf16 v[100:103], a[124:127], v[44:47], v[100:103]
s_waitcnt vmcnt(7)
v_mfma_f32_16x16x32_bf16 v[8:11], a[128:131], v[48:51], v[8:11]
v_mfma_f32_16x16x32_bf16 v[12:15], a[132:135], v[48:51], v[12:15]
v_mfma_f32_16x16x32_bf16 v[96:99], a[136:139], v[48:51], v[96:99]
v_mfma_f32_16x16x32_bf16 v[100:103], a[140:143], v[48:51], v[100:103]
s_waitcnt vmcnt(6)
v_mfma_f32_16x16x32_bf16 v[8:11], a[144:147], v[52:55], v[8:11]
v_mfma_f32_16x16x32_bf16 v[12:15], a[148:151], v[52:55], v[12:15]
v_mfma_f32_16x16x32_bf16 v[96:99], a[152:155], v[52:55], v[96:99]
v_mfma_f32_16x16x32_bf16 v[100:103], a[156:159], v[52:55], v[100:103]
s_waitcnt vmcnt(5)
v_mfma_f32_16x16x32_bf16 v[8:11], a[160:163], v[56:59], v[8:11]
v_mfma_f32_16x16x32_bf16 v[12:15], a[164:167], v[56:59], v[12:15]
v_mfma_f32_16x16x32_bf16 v[96:99], a[168:171], v[56:59], v[96:99]
v_mfma_f32_16x16x32_bf16 v[100:103], a[172:175], v[56:59], v[100:103]
s_waitcnt vmcnt(4)
v_mfma_f32_16x16x32_bf16 v[8:11], a[176:179], v[60:63], v[8:11]
v_mfma_f32_16x16x32_bf16 v[12:15], a[180:183], v[60:63], v[12:15]
v_mfma_f32_16x16x32_bf16 v[96:99], a[184:187], v[60:63], v[96:99]
v_mfma_f32_16x16x32_bf16 v[100:103], a[188:191], v[60:63], v[100:103]
s_waitcnt vmcnt(3)
v_mfma_f32_16x16x32_bf16 v[8:11], a[192:195], v[64:67], v[8:11]
v_mfma_f32_16x16x32_bf16 v[12:15], a[196:199], v[64:67], v[12:15]
v_mfma_f32_16x16x32_bf16 v[96:99], a[200:203], v[64:67], v[96:99]
v_mfma_f32_16x16x32_bf16 v[100:103], a[204:207], v[64:67], v[100:103]
s_waitcnt vmcnt(2)
v_mfma_f32_16x16x32_bf16 v[8:11], a[208:211], v[68:71], v[8:11]
v_mfma_f32_16x16x32_bf16 v[12:15], a[212:215], v[68:71], v[12:15]
v_mfma_f32_16x16x32_bf16 v[96:99], a[216:219], v[68:71], v[96:99]
v_mfma_f32_16x16x32_bf16 v[100:103], a[220:223], v[68:71], v[100:103]
s_waitcnt vmcnt(1)
v_mfma_f32_16x16x32_bf16 v[8:11], a[224:227], v[72:75], v[8:11]
v_mfma_f32_16x16x32_bf16 v[12:15], a[228:231], v[72:75], v[12:15]
v_mfma_f32_16x16x32_bf16 v[96:99], a[232:235], v[72:75], v[96:99]
v_mfma_f32_16x16x32_bf16 v[100:103], a[236:239], v[72:75], v[100:103]
s_waitcnt vmcnt(0)
v_mfma_f32_16x16x32_bf16 v[8:11], a[240:243], v[76:79], v[8:11]
v_mfma_f32_16x16x32_bf16 v[12:15], a[244:247], v[76:79], v[12:15]
v_mfma_f32_16x16x32_bf16 v[96:99], a[248:251], v[76:79], v[96:99]
v_mfma_f32_16x16x32_bf16 v[100:103], a[252:255], v[76:79], v[100:103]
s_nop 7
v_cndmask_b32 v8, v100, v8, vcc
v_cndmask_b32 v96, v96, v12, vcc
v_cndmask_b32 v9, v101, v9, vcc
v_cndmask_b32 v97, v97, v13, vcc
v_cndmask_b32 v10, v102, v10, vcc
v_cndmask_b32 v98, v98, v14, vcc
v_cndmask_b32 v11, v103, v11, vcc
v_cndmask_b32 v99, v99, v15, vcc
v_add_f32_dpp v8, v96, v8 row_ror:8 row_mask:0xf bank_mask:0xf
v_add_f32_dpp v9, v97, v9 row_ror:8 row_mask:0xf bank_mask:0xf
v_add_f32_dpp v10, v98, v10 row_ror:8 row_mask:0xf bank_mask:0xf
v_add_f32_dpp v11, v99, v11 row_ror:8 row_mask:0xf bank_mask:0xf
s_cmp_eq_u32 s38, 0
s_cbranch_scc1 L_s2_h0
ds_write_b128 v142, v[8:11]
s_waitcnt lgkmcnt(0)
s_barrier
s_branch L_nos2
L_s2_h0:
s_barrier
ds_read_b128 v[16:19], v3 offset:2048
ds_read_b128 v[20:23], v3 offset:4096
ds_read_b128 v[24:27], v3 offset:6144
s_waitcnt lgkmcnt(2)
v_add_f32 v8, v8, v16
v_add_f32 v9, v9, v17
v_add_f32 v10, v10, v18
v_add_f32 v11, v11, v19
s_waitcnt lgkmcnt(1)
v_add_f32 v8, v8, v20
v_add_f32 v9, v9, v21
v_add_f32 v10, v10, v22
v_add_f32 v11, v11, v23
s_waitcnt lgkmcnt(0)
v_add_f32 v8, v8, v24
v_add_f32 v9, v9, v25
v_add_f32 v10, v10, v26
v_add_f32 v11, v11, v27
v_mov_b32_dpp v12, v8 row_ror:8 row_mask:0xf bank_mask:0xf
v_mov_b32_dpp v13, v9 row_ror:8 row_mask:0xf bank_mask:0xf
v_mov_b32_dpp v14, v10 row_ror:8 row_mask:0xf bank_mask:0xf
v_mov_b32_dpp v15, v11 row_ror:8 row_mask:0xf bank_mask:0xf
v_cvt_pk_bf16_f32 v16, v8, v12
v_cvt_pk_bf16_f32 v17, v9, v13
v_cvt_pk_bf16_f32 v18, v10, v14
v_cvt_pk_bf16_f32 v19, v11, v15
s_mov_b64 exec, vcc
buffer_store_dwordx4 v[16:19], v5, s[12:15], s66 offen
s_mov_b64 exec, -1
s_branch L_nos2
L_nos2:
s_endpgm
L_surplus:
v_mov_b32 v2, 40
global_atomic_add v4, v2, v3, s[36:37] sc0 sc1
s_waitcnt vmcnt(0)
v_readfirstlane_b32 s43, v4
s_mov_b64 exec, 0x1ff
v_lshlrev_b32 v2, 2, v0
v_cmp_eq_u32 vcc, 0, v0
v_mov_b32 v5, 128
s_nop 0
v_cndmask_b32 v2, v2, v5, vcc
s_mov_b32 s57, 0
L_surp:
global_load_dword v4, v2, s[36:37] sc1
s_add_u32 s57, s57, 1
s_cmp_ge_u32 s57, 524288
s_cbranch_scc1 L_end
s_waitcnt vmcnt(0)
s_mov_b32 s58, 0
v_readlane_b32 s59, v4, 0
s_add_u32 s58, s58, s59
v_readlane_b32 s59, v4, 1
s_add_u32 s58, s58, s59
v_readlane_b32 s59, v4, 2
s_add_u32 s58, s58, s59
v_readlane_b32 s59, v4, 3
s_add_u32 s58, s58, s59
v_readlane_b32 s59, v4, 4
s_add_u32 s58, s58, s59
v_readlane_b32 s59, v4, 5
s_add_u32 s58, s58, s59
v_readlane_b32 s59, v4, 6
s_add_u32 s58, s58, s59
v_readlane_b32 s59, v4, 7
s_add_u32 s58, s58, s59
v_readlane_b32 s59, v4, 8
s_add_u32 s58, s58, s59
s_cmp_lt_u32 s58, 256
s_cbranch_scc1 L_surp
v_readlane_b32 s59, v4, 0
s_min_u32 s59, s59, 32
s_add_u32 s39, s59, s43
s_add_u32 s39, s39, 0
s_sub_u32 s59, 32, s59
s_cmp_lt_u32 s43, s59
s_cbranch_scc1 L_surp_ok
s_sub_u32 s43, s43, s59
v_readlane_b32 s59, v4, 1
s_min_u32 s59, s59, 32
s_add_u32 s39, s59, s43
s_add_u32 s39, s39, 32
s_sub_u32 s59, 32, s59
s_cmp_lt_u32 s43, s59
s_cbranch_scc1 L_surp_ok
s_sub_u32 s43, s43, s59
v_readlane_b32 s59, v4, 2
s_min_u32 s59, s59, 32
s_add_u32 s39, s59, s43
s_add_u32 s39, s39, 64
s_sub_u32 s59, 32, s59
s_cmp_lt_u32 s43, s59
s_cbranch_scc1 L_surp_ok
s_sub_u32 s43, s43, s59
v_readlane_b32 s59, v4, 3
s_min_u32 s59, s59, 32
s_add_u32 s39, s59, s43
s_add_u32 s39, s39, 96
s_sub_u32 s59, 32, s59
s_cmp_lt_u32 s43, s59
s_cbranch_scc1 L_surp_ok
s_sub_u32 s43, s43, s59
v_readlane_b32 s59, v4, 4
s_min_u32 s59, s59, 32
s_add_u32 s39, s59, s43
s_add_u32 s39, s39, 128
s_sub_u32 s59, 32, s59
s_cmp_lt_u32 s43, s59
s_cbranch_scc1 L_surp_ok
s_sub_u32 s43, s43, s59
v_readlane_b32 s59, v4, 5
s_min_u32 s59, s59, 32
s_add_u32 s39, s59, s43
s_add_u32 s39, s39, 160
s_sub_u32 s59, 32, s59
s_cmp_lt_u32 s43, s59
s_cbranch_scc1 L_surp_ok
s_sub_u32 s43, s43, s59
v_readlane_b32 s59, v4, 6
s_min_u32 s59, s59, 32
s_add_u32 s39, s59, s43
s_add_u32 s39, s39, 192
s_sub_u32 s59, 32, s59
s_cmp_lt_u32 s43, s59
s_cbranch_scc1 L_surp_ok
s_sub_u32 s43, s43, s59
v_readlane_b32 s59, v4, 7
s_min_u32 s59, s59, 32
s_add_u32 s39, s59, s43
s_add_u32 s39, s39, 224
s_sub_u32 s59, 32, s59
s_cmp_lt_u32 s43, s59
s_cbranch_scc1 L_surp_ok
s_sub_u32 s43, s43, s59
s_mov_b32 s39, 0x1000
L_surp_ok:
s_mov_b64 exec, 1
s_cmp_ge_u32 s39, 32
s_cbranch_scc1 L_role_ok
v_mov_b32 v2, 136
global_atomic_add v2, v3, s[36:37] sc1
s_waitcnt vmcnt(0)
s_branch L_role_ok
L_end:
s_endpgm
.section .rodata,"a"
.p2align 6
.amdhsa_kernel parallel_sum__memory_aug_recurrent_mem_tr__dense_activation_relu__prompt_kernel
  .amdhsa_next_free_vgpr 512
  .amdhsa_next_free_sgpr 102
  .amdhsa_accum_offset 256
  .amdhsa_group_segment_fixed_size 0
  .amdhsa_kernarg_size 104
  .amdhsa_user_sgpr_count 2
  .amdhsa_user_sgpr_kernarg_segment_ptr 1
  .amdhsa_system_sgpr_workgroup_id_x 1
.end_amdhsa_kernel
```
